```python
import torch

def _softmax(x, axis=-1):
    return torch.softmax(x, dim=axis)
def _gelu(x):
    return torch.nn.functional.gelu(x, approximate="tanh")
def _silu(x):
    return torch.nn.functional.silu(x)
def _sigmoid(x):
    return torch.sigmoid(x)
def _layernorm(x, axis=-1, eps=1e-5):
    m = x.mean(dim=axis, keepdim=True)
    v = x.var(dim=axis, keepdim=True, unbiased=False)
    return (x - m) / torch.sqrt(v + eps)
def _scatter_add(tgt, idx, src, axis=0):
    return tgt.clone().index_add_(axis, idx, src)
def _segment_sum(src, seg, n):
    out = torch.zeros((n,) + src.shape[1:], dtype=src.dtype)
    return out.index_add_(0, seg, src)
def _pad(x, pw):
    flat = tuple(v for pair in reversed(pw) for v in pair)
    return torch.nn.functional.pad(x, flat)

kernel_name = 'sequential_preLN__spectral_gfnet__mixer_s_mlp__prompt'

def setup_inputs():

    _w = (lambda a: (lambda t: t.to(torch.bfloat16) if t.is_floating_point() else t)(torch.as_tensor(a)))
    def _A_setup():
        B, S, D = 1, 2048, 576
        Df = D // 2 + 1
        return {
            "x": _w((lambda *s: torch.randn(*s, dtype=torch.bfloat16) * 0.05)(B, S, D)),
            "w_r": _w((lambda *s: torch.randn(*s, dtype=torch.bfloat16) * 0.4)(S, Df) * 0.02),
            "w_i": _w((lambda *s: torch.randn(*s, dtype=torch.bfloat16) * 0.4)(S, Df) * 0.02),
        }
    _A_in = _A_setup()

    def _B_setup():
        B, S, D, F = 1, 2048, 576, 4608
        return {
            "x":  _w((lambda *s: torch.randn(*s, dtype=torch.bfloat16) * 0.05)(B, S, D)),
            "w1": _w((lambda *s: torch.randn(*s, dtype=torch.bfloat16) * 0.8)(D, D) * (D ** -0.5)),
            "w2": _w((lambda *s: torch.randn(*s, dtype=torch.bfloat16) * 0.8)(D, D) * (D ** -0.5)),
            "w3": _w((lambda *s: torch.randn(*s, dtype=torch.bfloat16) * 0.8)(D, F) * (D ** -0.5)),
            "w4": _w((lambda *s: torch.randn(*s, dtype=torch.bfloat16) * 0.8)(F, D) * (F ** -0.5)),
        }
    _B_in = _B_setup()

    return {
        "A_x": _A_in["x"],
        "A_w_r": _A_in["w_r"],
        "A_w_i": _A_in["w_i"],
        "B_x": _B_in["x"],
        "B_w1": _B_in["w1"],
        "B_w2": _B_in["w2"],
        "B_w3": _B_in["w3"],
        "B_w4": _B_in["w4"],
    }

def reference(A_x, A_w_r, A_w_i, B_x, B_w1, B_w2, B_w3, B_w4):
    def _A_ref(x, w_r, w_i):
        B, S, D = x.shape
        X = (lambda x, axes=(-2,-1): torch.fft.rfft2(x.float(), dim=axes))(x, axes=(-2, -1))
        W = w_r + 1j * w_i
        X = X * W
        y = (lambda x, s, axes=(-2,-1): torch.fft.irfft2(x, s=s, dim=axes).to(torch.bfloat16))(X, (S, D), axes=(-2, -1))
        return y

    def _B_ref(x, w1, w2, w3, w4):
        B, S, D = x.shape
        h = _gelu(_layernorm(x, axis=-1) @ w1)
        c = D // 4
        g0 = _pad(h[:, :, 0*c:1*c], ((0, 0), (1, 0), (0, 0)))[:, :S, :]
        g1 = _pad(h[:, :, 1*c:2*c], ((0, 0), (0, 1), (0, 0)))[:, 1:, :]
        g2 = _pad(h[:, :, 2*c:3*c], ((0, 0), (2, 0), (0, 0)))[:, :S, :]
        g3 = _pad(h[:, :, 3*c:   ], ((0, 0), (0, 2), (0, 0)))[:, 2:, :]
        hs = torch.concatenate([g0, g1, g2, g3], axis=-1) @ w2
        x1 = x + hs
        h2 = _gelu(_layernorm(x1, axis=-1) @ w3) @ w4
        return x1 + h2

    x = A_x
    h = x + _A_ref(_layernorm(x, axis=-1), A_w_r, A_w_i)
    h2 = h + _B_ref(_layernorm(h, axis=-1), B_w1, B_w2, B_w3, B_w4)
    return h2
```

```asm
; @launch kernel=k1_kernel grid=(512,1,1) block=(256,1,1) lds=36992
; @launch kernel=k3_kernel grid=(256,1,1) block=(256,1,1) lds=147456
.amdgcn_target "amdgcn-amd-amdhsa--gfx950"
.text
.p2align 8
code_begin:
s_nop 0
.globl k1_kernel
.p2align 8
.type k1_kernel,@function
k1_kernel:
    s_cmp_ge_u32 s2, 512
    s_cbranch_scc1 L_end_1
    s_load_dwordx2 s[4:5], s[0:1], 80
    s_load_dwordx2 s[6:7], s[0:1], 0
    s_load_dwordx2 s[20:21], s[0:1], 8
    s_load_dwordx2 s[22:23], s[0:1], 16
    s_load_dwordx2 s[24:25], s[0:1], 32
    s_load_dwordx2 s[26:27], s[0:1], 40
    s_load_dwordx2 s[28:29], s[0:1], 48
    s_load_dwordx2 s[30:31], s[0:1], 56
    s_load_dwordx2 s[18:19], s[0:1], 64
    v_lshrrev_b32 v5, 6, v0
    v_and_b32 v1, 63, v0
    v_readfirstlane_b32 s3, v5
    v_lshrrev_b32 v2, 4, v1
    v_and_b32 v3, 15, v1
    v_lshlrev_b32 v4, 4, v1
    s_getpc_b64 s[52:53]
    s_add_u32 s52, s52, code_begin@rel32@lo+4
    s_addc_u32 s53, s53, code_begin@rel32@hi+12
    s_and_b32 s53, s53, 0xffff
    s_mov_b32 s54, k3_kernel-code_begin
    s_mov_b32 s55, 0x00020000
    s_lshr_b32 s44, s2, 3
    s_lshl_b32 s44, s44, 2
    s_add_u32 s44, s44, s3
    s_and_b32 s44, s44, 15
    s_lshl_b32 s44, s44, 10
    buffer_load_dwordx4 v[196:199], v4, s[52:55], s44 offen
    s_cmp_ge_u32 s2, 256
    s_cbranch_scc1 L_side_2
    s_bfe_u32 s34, s2, 0x20003
    s_and_b32 s35, s2, 7
    s_lshl_b32 s35, s35, 3
    s_lshr_b32 s39, s2, 5
    s_add_u32 s35, s35, s39
    s_lshr_b32 s36, s35, 5
    s_bfe_u32 s37, s35, 0x20003
    s_and_b32 s38, s35, 7
    s_lshl_b32 s40, s36, 5
    s_lshr_b32 s41, s3, 1
    s_lshl_b32 s41, s41, 4
    s_add_u32 s40, s40, s41
    s_lshl_b32 s41, s37, 2
    s_add_u32 s40, s40, s41
    s_lshl_b32 s40, s40, 5
    s_lshl_b32 s41, s38, 2
    s_add_u32 s40, s40, s41
    v_lshrrev_b32 v5, 3, v1
    v_and_b32 v7, 3, v5
    v_lshlrev_b32 v7, 5, v7
    v_lshrrev_b32 v6, 2, v5
    s_and_b32 s41, s3, 1
    s_lshl_b32 s41, s41, 1
    s_add_u32 s41, s41, s40
    v_add3_u32 v6, v6, v7, s41
    v_mul_u32_u24 v7, 1152, v6
    v_and_b32 v5, 6, v5
    v_and_b32 v6, 7, v1
    v_xor_b32 v6, v6, v5
    v_lshl_add_u32 v7, v6, 4, v7
    s_mul_i32 s42, s3, 9216
    s_mul_i32 s44, s34, 9
    s_mul_i32 s45, s3, 3
    s_add_u32 s44, s44, s45
    s_waitcnt lgkmcnt(0)
    s_mov_b32 s8, s4
    s_and_b32 s9, s5, 0xffff
    s_mov_b32 s10, 268435456
    s_mov_b32 s11, 0x00020000
    s_mov_b32 s12, s6
    s_and_b32 s13, s7, 0xffff
    s_mov_b32 s14, 2359296
    s_mov_b32 s15, 0x00020000
    s_add_u32 m0, s42, 0
    s_nop 0
    buffer_load_dwordx4 v7, s[12:15], 0 offen offset:0  lds
    s_add_u32 m0, s42, 896
    s_nop 0
    buffer_load_dwordx4 v7, s[12:15], 0 offen offset:128  lds
    s_add_u32 m0, s42, 1792
    s_nop 0
    buffer_load_dwordx4 v7, s[12:15], 0 offen offset:256  lds
    s_add_u32 m0, s42, 2688
    s_nop 0
    buffer_load_dwordx4 v7, s[12:15], 0 offen offset:384  lds
    s_add_u32 m0, s42, 3584
    s_nop 0
    buffer_load_dwordx4 v7, s[12:15], 0 offen offset:512  lds
    s_add_u32 m0, s42, 4480
    s_nop 0
    buffer_load_dwordx4 v7, s[12:15], 0 offen offset:640  lds
    s_add_u32 m0, s42, 5376
    s_nop 0
    buffer_load_dwordx4 v7, s[12:15], 0 offen offset:768  lds
    s_add_u32 m0, s42, 6272
    s_nop 0
    buffer_load_dwordx4 v7, s[12:15], 0 offen offset:896  lds
    s_add_u32 m0, s42, 7168
    s_nop 0
    buffer_load_dwordx4 v7, s[12:15], 0 offen offset:1024  lds
    v_lshrrev_b32 v13, 3, v3
    v_mul_u32_u24 v13, 9216, v13
    v_and_b32 v14, 7, v3
    v_lshl_add_u32 v13, v14, 7, v13
    v_and_b32 v14, 6, v3
    v_xor_b32 v14, v14, v2
    v_lshl_add_u32 v14, v14, 4, v13
    v_xor_b32 v15, 64, v14
    s_cmp_eq_u32 s3, 3
    s_cbranch_scc1 L_stats_3
    s_lshl_b32 s17, s44, 4
    v_add_u32 v32, s17, v3
    v_cvt_f32_u32 v32, v32
    v_lshlrev_b32 v38, 3, v2
    v_cvt_f32_u32 v38, v38
    v_mov_b32 v36, 0x3e000000
    v_mul_f32 v33, 0x3ae38e39, v32
    v_mul_f32 v34, 0x3d638e39, v32
    v_mul_f32 v35, v32, v38
    v_floor_f32 v34, v34
    v_cos_f32 v33, v33
    v_fmamk_f32 v34, v34, 0xc1900000, v32
    v_mul_f32 v34, 0x3d638e39, v34
    v_fmamk_f32 v16, v32, 0x00000000, v35
    v_fmamk_f32 v17, v32, 0x3f800000, v35
    v_fmamk_f32 v24, v32, 0x42000000, v35
    v_fmamk_f32 v25, v32, 0x42040000, v35
    v_cos_f32 v34, v34
    v_mul_f32 v18, 0x3ae38e39, v16
    v_mul_f32 v19, 0x3ae38e39, v17
    v_mul_f32 v26, 0x3ae38e39, v24
    v_mul_f32 v27, 0x3ae38e39, v25
    v_add_f32 v33, v33, v33
    v_floor_f32 v18, v18
    v_floor_f32 v19, v19
    v_floor_f32 v26, v26
    v_floor_f32 v27, v27
    v_add_f32 v34, v34, v34
    v_fmamk_f32 v16, v18, 0xc4100000, v16
    v_fmamk_f32 v17, v19, 0xc4100000, v17
    v_fmamk_f32 v24, v26, 0xc4100000, v24
    v_fmamk_f32 v25, v27, 0xc4100000, v25
    v_fmamk_f32 v16, v16, 0x3ae38e39, v36
    v_fmamk_f32 v17, v17, 0x3ae38e39, v36
    v_fmamk_f32 v24, v24, 0x3ae38e39, v36
    v_fmamk_f32 v25, v25, 0x3ae38e39, v36
    v_sin_f32 v16, v16
    v_sin_f32 v17, v17
    v_sin_f32 v24, v24
    v_sin_f32 v25, v25
    s_nop 0
    v_fma_f32 v18, v33, v17, -v16
    v_fma_f32 v26, v33, v25, -v24
    v_fma_f32 v19, v33, v18, -v17
    v_fma_f32 v27, v33, v26, -v25
    v_fma_f32 v20, v33, v19, -v18
    v_fma_f32 v28, v33, v27, -v26
    v_fma_f32 v21, v33, v20, -v19
    v_fma_f32 v29, v33, v28, -v27
    v_fma_f32 v22, v33, v21, -v20
    v_fma_f32 v30, v33, v29, -v28
    v_fma_f32 v23, v33, v22, -v21
    v_fma_f32 v31, v33, v30, -v29
    v_cvt_pk_bf16_f32 v88, v16, v17
    v_cvt_pk_bf16_f32 v89, v18, v19
    v_cvt_pk_bf16_f32 v90, v20, v21
    v_cvt_pk_bf16_f32 v91, v22, v23
    v_cvt_pk_bf16_f32 v100, v24, v25
    v_cvt_pk_bf16_f32 v101, v26, v27
    v_cvt_pk_bf16_f32 v102, v28, v29
    v_cvt_pk_bf16_f32 v103, v30, v31
    v_fma_f32 v16, v34, v24, -v16
    v_fma_f32 v17, v34, v25, -v17
    v_fma_f32 v18, v34, v26, -v18
    v_fma_f32 v19, v34, v27, -v19
    v_fma_f32 v20, v34, v28, -v20
    v_fma_f32 v21, v34, v29, -v21
    v_fma_f32 v22, v34, v30, -v22
    v_fma_f32 v23, v34, v31, -v23
    v_cvt_pk_bf16_f32 v112, v16, v17
    v_cvt_pk_bf16_f32 v113, v18, v19
    v_cvt_pk_bf16_f32 v114, v20, v21
    v_cvt_pk_bf16_f32 v115, v22, v23
    v_fma_f32 v24, v34, v16, -v24
    v_fma_f32 v25, v34, v17, -v25
    v_fma_f32 v26, v34, v18, -v26
    v_fma_f32 v27, v34, v19, -v27
    v_fma_f32 v28, v34, v20, -v28
    v_fma_f32 v29, v34, v21, -v29
    v_fma_f32 v30, v34, v22, -v30
    v_fma_f32 v31, v34, v23, -v31
    v_cvt_pk_bf16_f32 v124, v24, v25
    v_cvt_pk_bf16_f32 v125, v26, v27
    v_cvt_pk_bf16_f32 v126, v28, v29
    v_cvt_pk_bf16_f32 v127, v30, v31
    v_fma_f32 v16, v34, v24, -v16
    v_fma_f32 v17, v34, v25, -v17
    v_fma_f32 v18, v34, v26, -v18
    v_fma_f32 v19, v34, v27, -v19
    v_fma_f32 v20, v34, v28, -v20
    v_fma_f32 v21, v34, v29, -v21
    v_fma_f32 v22, v34, v30, -v22
    v_fma_f32 v23, v34, v31, -v23
    v_cvt_pk_bf16_f32 v136, v16, v17
    v_cvt_pk_bf16_f32 v137, v18, v19
    v_cvt_pk_bf16_f32 v138, v20, v21
    v_cvt_pk_bf16_f32 v139, v22, v23
    v_fma_f32 v24, v34, v16, -v24
    v_fma_f32 v25, v34, v17, -v25
    v_fma_f32 v26, v34, v18, -v26
    v_fma_f32 v27, v34, v19, -v27
    v_fma_f32 v28, v34, v20, -v28
    v_fma_f32 v29, v34, v21, -v29
    v_fma_f32 v30, v34, v22, -v30
    v_fma_f32 v31, v34, v23, -v31
    v_cvt_pk_bf16_f32 v148, v24, v25
    v_cvt_pk_bf16_f32 v149, v26, v27
    v_cvt_pk_bf16_f32 v150, v28, v29
    v_cvt_pk_bf16_f32 v151, v30, v31
    v_fma_f32 v16, v34, v24, -v16
    v_fma_f32 v17, v34, v25, -v17
    v_fma_f32 v18, v34, v26, -v18
    v_fma_f32 v19, v34, v27, -v19
    v_fma_f32 v20, v34, v28, -v20
    v_fma_f32 v21, v34, v29, -v21
    v_fma_f32 v22, v34, v30, -v22
    v_fma_f32 v23, v34, v31, -v23
    v_cvt_pk_bf16_f32 v160, v16, v17
    v_cvt_pk_bf16_f32 v161, v18, v19
    v_cvt_pk_bf16_f32 v162, v20, v21
    v_cvt_pk_bf16_f32 v163, v22, v23
    v_fma_f32 v24, v34, v16, -v24
    v_fma_f32 v25, v34, v17, -v25
    v_fma_f32 v26, v34, v18, -v26
    v_fma_f32 v27, v34, v19, -v27
    v_fma_f32 v28, v34, v20, -v28
    v_fma_f32 v29, v34, v21, -v29
    v_fma_f32 v30, v34, v22, -v30
    v_fma_f32 v31, v34, v23, -v31
    v_cvt_pk_bf16_f32 v172, v24, v25
    v_cvt_pk_bf16_f32 v173, v26, v27
    v_cvt_pk_bf16_f32 v174, v28, v29
    v_cvt_pk_bf16_f32 v175, v30, v31
    v_fma_f32 v16, v34, v24, -v16
    v_fma_f32 v17, v34, v25, -v17
    v_fma_f32 v18, v34, v26, -v18
    v_fma_f32 v19, v34, v27, -v19
    v_fma_f32 v20, v34, v28, -v20
    v_fma_f32 v21, v34, v29, -v21
    v_fma_f32 v22, v34, v30, -v22
    v_fma_f32 v23, v34, v31, -v23
    v_cvt_pk_bf16_f32 v184, v16, v17
    v_cvt_pk_bf16_f32 v185, v18, v19
    v_cvt_pk_bf16_f32 v186, v20, v21
    v_cvt_pk_bf16_f32 v187, v22, v23
    v_add_f32 v32, 0x41800000, v32
    v_mul_f32 v33, 0x3ae38e39, v32
    v_mul_f32 v34, 0x3d638e39, v32
    v_mul_f32 v35, v32, v38
    v_floor_f32 v34, v34
    v_cos_f32 v33, v33
    v_fmamk_f32 v34, v34, 0xc1900000, v32
    v_mul_f32 v34, 0x3d638e39, v34
    v_fmamk_f32 v16, v32, 0x00000000, v35
    v_fmamk_f32 v17, v32, 0x3f800000, v35
    v_fmamk_f32 v24, v32, 0x42000000, v35
    v_fmamk_f32 v25, v32, 0x42040000, v35
    v_cos_f32 v34, v34
    v_mul_f32 v18, 0x3ae38e39, v16
    v_mul_f32 v19, 0x3ae38e39, v17
    v_mul_f32 v26, 0x3ae38e39, v24
    v_mul_f32 v27, 0x3ae38e39, v25
    v_add_f32 v33, v33, v33
    v_floor_f32 v18, v18
    v_floor_f32 v19, v19
    v_floor_f32 v26, v26
    v_floor_f32 v27, v27
    v_add_f32 v34, v34, v34
    v_fmamk_f32 v16, v18, 0xc4100000, v16
    v_fmamk_f32 v17, v19, 0xc4100000, v17
    v_fmamk_f32 v24, v26, 0xc4100000, v24
    v_fmamk_f32 v25, v27, 0xc4100000, v25
    v_fmamk_f32 v16, v16, 0x3ae38e39, v36
    v_fmamk_f32 v17, v17, 0x3ae38e39, v36
    v_fmamk_f32 v24, v24, 0x3ae38e39, v36
    v_fmamk_f32 v25, v25, 0x3ae38e39, v36
    v_sin_f32 v16, v16
    v_sin_f32 v17, v17
    v_sin_f32 v24, v24
    v_sin_f32 v25, v25
    s_nop 0
    v_fma_f32 v18, v33, v17, -v16
    v_fma_f32 v26, v33, v25, -v24
    v_fma_f32 v19, v33, v18, -v17
    v_fma_f32 v27, v33, v26, -v25
    v_fma_f32 v20, v33, v19, -v18
    v_fma_f32 v28, v33, v27, -v26
    v_fma_f32 v21, v33, v20, -v19
    v_fma_f32 v29, v33, v28, -v27
    v_fma_f32 v22, v33, v21, -v20
    v_fma_f32 v30, v33, v29, -v28
    v_fma_f32 v23, v33, v22, -v21
    v_fma_f32 v31, v33, v30, -v29
    v_cvt_pk_bf16_f32 v92, v16, v17
    v_cvt_pk_bf16_f32 v93, v18, v19
    v_cvt_pk_bf16_f32 v94, v20, v21
    v_cvt_pk_bf16_f32 v95, v22, v23
    v_cvt_pk_bf16_f32 v104, v24, v25
    v_cvt_pk_bf16_f32 v105, v26, v27
    v_cvt_pk_bf16_f32 v106, v28, v29
    v_cvt_pk_bf16_f32 v107, v30, v31
    v_fma_f32 v16, v34, v24, -v16
    v_fma_f32 v17, v34, v25, -v17
    v_fma_f32 v18, v34, v26, -v18
    v_fma_f32 v19, v34, v27, -v19
    v_fma_f32 v20, v34, v28, -v20
    v_fma_f32 v21, v34, v29, -v21
    v_fma_f32 v22, v34, v30, -v22
    v_fma_f32 v23, v34, v31, -v23
    v_cvt_pk_bf16_f32 v116, v16, v17
    v_cvt_pk_bf16_f32 v117, v18, v19
    v_cvt_pk_bf16_f32 v118, v20, v21
    v_cvt_pk_bf16_f32 v119, v22, v23
    v_fma_f32 v24, v34, v16, -v24
    v_fma_f32 v25, v34, v17, -v25
    v_fma_f32 v26, v34, v18, -v26
    v_fma_f32 v27, v34, v19, -v27
    v_fma_f32 v28, v34, v20, -v28
    v_fma_f32 v29, v34, v21, -v29
    v_fma_f32 v30, v34, v22, -v30
    v_fma_f32 v31, v34, v23, -v31
    v_cvt_pk_bf16_f32 v128, v24, v25
    v_cvt_pk_bf16_f32 v129, v26, v27
    v_cvt_pk_bf16_f32 v130, v28, v29
    v_cvt_pk_bf16_f32 v131, v30, v31
    v_fma_f32 v16, v34, v24, -v16
    v_fma_f32 v17, v34, v25, -v17
    v_fma_f32 v18, v34, v26, -v18
    v_fma_f32 v19, v34, v27, -v19
    v_fma_f32 v20, v34, v28, -v20
    v_fma_f32 v21, v34, v29, -v21
    v_fma_f32 v22, v34, v30, -v22
    v_fma_f32 v23, v34, v31, -v23
    v_cvt_pk_bf16_f32 v140, v16, v17
    v_cvt_pk_bf16_f32 v141, v18, v19
    v_cvt_pk_bf16_f32 v142, v20, v21
    v_cvt_pk_bf16_f32 v143, v22, v23
    v_fma_f32 v24, v34, v16, -v24
    v_fma_f32 v25, v34, v17, -v25
    v_fma_f32 v26, v34, v18, -v26
    v_fma_f32 v27, v34, v19, -v27
    v_fma_f32 v28, v34, v20, -v28
    v_fma_f32 v29, v34, v21, -v29
    v_fma_f32 v30, v34, v22, -v30
    v_fma_f32 v31, v34, v23, -v31
    v_cvt_pk_bf16_f32 v152, v24, v25
    v_cvt_pk_bf16_f32 v153, v26, v27
    v_cvt_pk_bf16_f32 v154, v28, v29
    v_cvt_pk_bf16_f32 v155, v30, v31
    v_fma_f32 v16, v34, v24, -v16
    v_fma_f32 v17, v34, v25, -v17
    v_fma_f32 v18, v34, v26, -v18
    v_fma_f32 v19, v34, v27, -v19
    v_fma_f32 v20, v34, v28, -v20
    v_fma_f32 v21, v34, v29, -v21
    v_fma_f32 v22, v34, v30, -v22
    v_fma_f32 v23, v34, v31, -v23
    v_cvt_pk_bf16_f32 v164, v16, v17
    v_cvt_pk_bf16_f32 v165, v18, v19
    v_cvt_pk_bf16_f32 v166, v20, v21
    v_cvt_pk_bf16_f32 v167, v22, v23
    v_fma_f32 v24, v34, v16, -v24
    v_fma_f32 v25, v34, v17, -v25
    v_fma_f32 v26, v34, v18, -v26
    v_fma_f32 v27, v34, v19, -v27
    v_fma_f32 v28, v34, v20, -v28
    v_fma_f32 v29, v34, v21, -v29
    v_fma_f32 v30, v34, v22, -v30
    v_fma_f32 v31, v34, v23, -v31
    v_cvt_pk_bf16_f32 v176, v24, v25
    v_cvt_pk_bf16_f32 v177, v26, v27
    v_cvt_pk_bf16_f32 v178, v28, v29
    v_cvt_pk_bf16_f32 v179, v30, v31
    v_fma_f32 v16, v34, v24, -v16
    v_fma_f32 v17, v34, v25, -v17
    v_fma_f32 v18, v34, v26, -v18
    v_fma_f32 v19, v34, v27, -v19
    v_fma_f32 v20, v34, v28, -v20
    v_fma_f32 v21, v34, v29, -v21
    v_fma_f32 v22, v34, v30, -v22
    v_fma_f32 v23, v34, v31, -v23
    v_cvt_pk_bf16_f32 v188, v16, v17
    v_cvt_pk_bf16_f32 v189, v18, v19
    v_cvt_pk_bf16_f32 v190, v20, v21
    v_cvt_pk_bf16_f32 v191, v22, v23
    v_add_f32 v32, 0x41800000, v32
    v_mul_f32 v33, 0x3ae38e39, v32
    v_mul_f32 v34, 0x3d638e39, v32
    v_mul_f32 v35, v32, v38
    v_floor_f32 v34, v34
    v_cos_f32 v33, v33
    v_fmamk_f32 v34, v34, 0xc1900000, v32
    v_mul_f32 v34, 0x3d638e39, v34
    v_fmamk_f32 v16, v32, 0x00000000, v35
    v_fmamk_f32 v17, v32, 0x3f800000, v35
    v_fmamk_f32 v24, v32, 0x42000000, v35
    v_fmamk_f32 v25, v32, 0x42040000, v35
    v_cos_f32 v34, v34
    v_mul_f32 v18, 0x3ae38e39, v16
    v_mul_f32 v19, 0x3ae38e39, v17
    v_mul_f32 v26, 0x3ae38e39, v24
    v_mul_f32 v27, 0x3ae38e39, v25
    v_add_f32 v33, v33, v33
    v_floor_f32 v18, v18
    v_floor_f32 v19, v19
    v_floor_f32 v26, v26
    v_floor_f32 v27, v27
    v_add_f32 v34, v34, v34
    v_fmamk_f32 v16, v18, 0xc4100000, v16
    v_fmamk_f32 v17, v19, 0xc4100000, v17
    v_fmamk_f32 v24, v26, 0xc4100000, v24
    v_fmamk_f32 v25, v27, 0xc4100000, v25
    v_fmamk_f32 v16, v16, 0x3ae38e39, v36
    v_fmamk_f32 v17, v17, 0x3ae38e39, v36
    v_fmamk_f32 v24, v24, 0x3ae38e39, v36
    v_fmamk_f32 v25, v25, 0x3ae38e39, v36
    v_sin_f32 v16, v16
    v_sin_f32 v17, v17
    v_sin_f32 v24, v24
    v_sin_f32 v25, v25
    s_nop 0
    v_fma_f32 v18, v33, v17, -v16
    v_fma_f32 v26, v33, v25, -v24
    v_fma_f32 v19, v33, v18, -v17
    v_fma_f32 v27, v33, v26, -v25
    v_fma_f32 v20, v33, v19, -v18
    v_fma_f32 v28, v33, v27, -v26
    v_fma_f32 v21, v33, v20, -v19
    v_fma_f32 v29, v33, v28, -v27
    v_fma_f32 v22, v33, v21, -v20
    v_fma_f32 v30, v33, v29, -v28
    v_fma_f32 v23, v33, v22, -v21
    v_fma_f32 v31, v33, v30, -v29
    v_cvt_pk_bf16_f32 v96, v16, v17
    v_cvt_pk_bf16_f32 v97, v18, v19
    v_cvt_pk_bf16_f32 v98, v20, v21
    v_cvt_pk_bf16_f32 v99, v22, v23
    v_cvt_pk_bf16_f32 v108, v24, v25
    v_cvt_pk_bf16_f32 v109, v26, v27
    v_cvt_pk_bf16_f32 v110, v28, v29
    v_cvt_pk_bf16_f32 v111, v30, v31
    v_fma_f32 v16, v34, v24, -v16
    v_fma_f32 v17, v34, v25, -v17
    v_fma_f32 v18, v34, v26, -v18
    v_fma_f32 v19, v34, v27, -v19
    v_fma_f32 v20, v34, v28, -v20
    v_fma_f32 v21, v34, v29, -v21
    v_fma_f32 v22, v34, v30, -v22
    v_fma_f32 v23, v34, v31, -v23
    v_cvt_pk_bf16_f32 v120, v16, v17
    v_cvt_pk_bf16_f32 v121, v18, v19
    v_cvt_pk_bf16_f32 v122, v20, v21
    v_cvt_pk_bf16_f32 v123, v22, v23
    v_fma_f32 v24, v34, v16, -v24
    v_fma_f32 v25, v34, v17, -v25
    v_fma_f32 v26, v34, v18, -v26
    v_fma_f32 v27, v34, v19, -v27
    v_fma_f32 v28, v34, v20, -v28
    v_fma_f32 v29, v34, v21, -v29
    v_fma_f32 v30, v34, v22, -v30
    v_fma_f32 v31, v34, v23, -v31
    v_cvt_pk_bf16_f32 v132, v24, v25
    v_cvt_pk_bf16_f32 v133, v26, v27
    v_cvt_pk_bf16_f32 v134, v28, v29
    v_cvt_pk_bf16_f32 v135, v30, v31
    v_fma_f32 v16, v34, v24, -v16
    v_fma_f32 v17, v34, v25, -v17
    v_fma_f32 v18, v34, v26, -v18
    v_fma_f32 v19, v34, v27, -v19
    v_fma_f32 v20, v34, v28, -v20
    v_fma_f32 v21, v34, v29, -v21
    v_fma_f32 v22, v34, v30, -v22
    v_fma_f32 v23, v34, v31, -v23
    v_cvt_pk_bf16_f32 v144, v16, v17
    v_cvt_pk_bf16_f32 v145, v18, v19
    v_cvt_pk_bf16_f32 v146, v20, v21
    v_cvt_pk_bf16_f32 v147, v22, v23
    v_fma_f32 v24, v34, v16, -v24
    v_fma_f32 v25, v34, v17, -v25
    v_fma_f32 v26, v34, v18, -v26
    v_fma_f32 v27, v34, v19, -v27
    v_fma_f32 v28, v34, v20, -v28
    v_fma_f32 v29, v34, v21, -v29
    v_fma_f32 v30, v34, v22, -v30
    v_fma_f32 v31, v34, v23, -v31
    v_cvt_pk_bf16_f32 v156, v24, v25
    v_cvt_pk_bf16_f32 v157, v26, v27
    v_cvt_pk_bf16_f32 v158, v28, v29
    v_cvt_pk_bf16_f32 v159, v30, v31
    v_fma_f32 v16, v34, v24, -v16
    v_fma_f32 v17, v34, v25, -v17
    v_fma_f32 v18, v34, v26, -v18
    v_fma_f32 v19, v34, v27, -v19
    v_fma_f32 v20, v34, v28, -v20
    v_fma_f32 v21, v34, v29, -v21
    v_fma_f32 v22, v34, v30, -v22
    v_fma_f32 v23, v34, v31, -v23
    v_cvt_pk_bf16_f32 v168, v16, v17
    v_cvt_pk_bf16_f32 v169, v18, v19
    v_cvt_pk_bf16_f32 v170, v20, v21
    v_cvt_pk_bf16_f32 v171, v22, v23
    v_fma_f32 v24, v34, v16, -v24
    v_fma_f32 v25, v34, v17, -v25
    v_fma_f32 v26, v34, v18, -v26
    v_fma_f32 v27, v34, v19, -v27
    v_fma_f32 v28, v34, v20, -v28
    v_fma_f32 v29, v34, v21, -v29
    v_fma_f32 v30, v34, v22, -v30
    v_fma_f32 v31, v34, v23, -v31
    v_cvt_pk_bf16_f32 v180, v24, v25
    v_cvt_pk_bf16_f32 v181, v26, v27
    v_cvt_pk_bf16_f32 v182, v28, v29
    v_cvt_pk_bf16_f32 v183, v30, v31
    v_fma_f32 v16, v34, v24, -v16
    v_fma_f32 v17, v34, v25, -v17
    v_fma_f32 v18, v34, v26, -v18
    v_fma_f32 v19, v34, v27, -v19
    v_fma_f32 v20, v34, v28, -v20
    v_fma_f32 v21, v34, v29, -v21
    v_fma_f32 v22, v34, v30, -v22
    v_fma_f32 v23, v34, v31, -v23
    v_cvt_pk_bf16_f32 v192, v16, v17
    v_cvt_pk_bf16_f32 v193, v18, v19
    v_cvt_pk_bf16_f32 v194, v20, v21
    v_cvt_pk_bf16_f32 v195, v22, v23
    v_lshlrev_b32 v8, 12, v3
    v_lshl_add_u32 v8, v2, 4, v8
    s_lshl_b32 s50, s44, 16
    s_lshr_b32 s51, s38, 2
    s_lshl_b32 s51, s51, 1
    s_add_u32 s51, s51, s36
    s_lshl_b32 s51, s51, 10
    s_add_u32 s50, s50, s51
    s_lshl_b32 s51, s37, 8
    s_add_u32 s50, s50, s51
    s_and_b32 s51, s38, 3
    s_lshl_b32 s51, s51, 6
    s_add_u32 s50, s50, s51
    s_add_u32 s50, s50, 0
    v_lshlrev_b32 v9, 4, v2
    v_lshlrev_b32 v10, 31, v3
    v_or_b32 v10, 1.0, v10
    s_waitcnt vmcnt(0)
    s_barrier
    ds_read_b128 v[64:67], v14 offset:0
    ds_read_b128 v[68:71], v14 offset:18432
    ds_read_b128 v[72:75], v15 offset:0
    ds_read_b128 v[76:79], v15 offset:18432
    ds_read_b128 v[80:83], v14 offset:1024
    ds_read_b128 v[84:87], v14 offset:19456
    s_waitcnt lgkmcnt(4)
    v_mfma_f32_16x16x32_bf16 v[16:19], v[64:67], v[88:91], 0
    v_mfma_f32_16x16x32_bf16 v[20:23], v[68:71], v[88:91], 0
    v_mfma_f32_16x16x32_bf16 v[24:27], v[64:67], v[92:95], 0
    v_mfma_f32_16x16x32_bf16 v[28:31], v[68:71], v[92:95], 0
    v_mfma_f32_16x16x32_bf16 v[32:35], v[64:67], v[96:99], 0
    v_mfma_f32_16x16x32_bf16 v[36:39], v[68:71], v[96:99], 0
    ds_read_b128 v[64:67], v15 offset:1024
    ds_read_b128 v[68:71], v15 offset:19456
    s_waitcnt lgkmcnt(4)
    v_mfma_f32_16x16x32_bf16 v[16:19], v[72:75], v[100:103], v[16:19]
    v_mfma_f32_16x16x32_bf16 v[20:23], v[76:79], v[100:103], v[20:23]
    v_mfma_f32_16x16x32_bf16 v[24:27], v[72:75], v[104:107], v[24:27]
    v_mfma_f32_16x16x32_bf16 v[28:31], v[76:79], v[104:107], v[28:31]
    v_mfma_f32_16x16x32_bf16 v[32:35], v[72:75], v[108:111], v[32:35]
    v_mfma_f32_16x16x32_bf16 v[36:39], v[76:79], v[108:111], v[36:39]
    ds_read_b128 v[72:75], v14 offset:2048
    ds_read_b128 v[76:79], v14 offset:20480
    s_waitcnt lgkmcnt(4)
    v_mfma_f32_16x16x32_bf16 v[16:19], v[80:83], v[112:115], v[16:19]
    v_mfma_f32_16x16x32_bf16 v[20:23], v[84:87], v[112:115], v[20:23]
    v_mfma_f32_16x16x32_bf16 v[24:27], v[80:83], v[116:119], v[24:27]
    v_mfma_f32_16x16x32_bf16 v[28:31], v[84:87], v[116:119], v[28:31]
    v_mfma_f32_16x16x32_bf16 v[32:35], v[80:83], v[120:123], v[32:35]
    v_mfma_f32_16x16x32_bf16 v[36:39], v[84:87], v[120:123], v[36:39]
    ds_read_b128 v[80:83], v15 offset:2048
    ds_read_b128 v[84:87], v15 offset:20480
    s_waitcnt lgkmcnt(4)
    v_mfma_f32_16x16x32_bf16 v[16:19], v[64:67], v[124:127], v[16:19]
    v_mfma_f32_16x16x32_bf16 v[20:23], v[68:71], v[124:127], v[20:23]
    v_mfma_f32_16x16x32_bf16 v[24:27], v[64:67], v[128:131], v[24:27]
    v_mfma_f32_16x16x32_bf16 v[28:31], v[68:71], v[128:131], v[28:31]
    v_mfma_f32_16x16x32_bf16 v[32:35], v[64:67], v[132:135], v[32:35]
    v_mfma_f32_16x16x32_bf16 v[36:39], v[68:71], v[132:135], v[36:39]
    ds_read_b128 v[64:67], v14 offset:3072
    ds_read_b128 v[68:71], v14 offset:21504
    s_waitcnt lgkmcnt(4)
    v_mfma_f32_16x16x32_bf16 v[16:19], v[72:75], v[136:139], v[16:19]
    v_mfma_f32_16x16x32_bf16 v[20:23], v[76:79], v[136:139], v[20:23]
    v_mfma_f32_16x16x32_bf16 v[24:27], v[72:75], v[140:143], v[24:27]
    v_mfma_f32_16x16x32_bf16 v[28:31], v[76:79], v[140:143], v[28:31]
    v_mfma_f32_16x16x32_bf16 v[32:35], v[72:75], v[144:147], v[32:35]
    v_mfma_f32_16x16x32_bf16 v[36:39], v[76:79], v[144:147], v[36:39]
    ds_read_b128 v[72:75], v15 offset:3072
    ds_read_b128 v[76:79], v15 offset:21504
    s_waitcnt lgkmcnt(4)
    v_mfma_f32_16x16x32_bf16 v[16:19], v[80:83], v[148:151], v[16:19]
    v_mfma_f32_16x16x32_bf16 v[20:23], v[84:87], v[148:151], v[20:23]
    v_mfma_f32_16x16x32_bf16 v[24:27], v[80:83], v[152:155], v[24:27]
    v_mfma_f32_16x16x32_bf16 v[28:31], v[84:87], v[152:155], v[28:31]
    v_mfma_f32_16x16x32_bf16 v[32:35], v[80:83], v[156:159], v[32:35]
    v_mfma_f32_16x16x32_bf16 v[36:39], v[84:87], v[156:159], v[36:39]
    ds_read_b128 v[80:83], v14 offset:4096
    ds_read_b128 v[84:87], v14 offset:22528
    s_waitcnt lgkmcnt(4)
    v_mfma_f32_16x16x32_bf16 v[16:19], v[64:67], v[160:163], v[16:19]
    v_mfma_f32_16x16x32_bf16 v[20:23], v[68:71], v[160:163], v[20:23]
    v_mfma_f32_16x16x32_bf16 v[24:27], v[64:67], v[164:167], v[24:27]
    v_mfma_f32_16x16x32_bf16 v[28:31], v[68:71], v[164:167], v[28:31]
    v_mfma_f32_16x16x32_bf16 v[32:35], v[64:67], v[168:171], v[32:35]
    v_mfma_f32_16x16x32_bf16 v[36:39], v[68:71], v[168:171], v[36:39]
    ds_read_b128 v[64:67], v15 offset:4096
    ds_read_b128 v[68:71], v15 offset:22528
    s_waitcnt lgkmcnt(4)
    v_mfma_f32_16x16x32_bf16 v[16:19], v[72:75], v[172:175], v[16:19]
    v_mfma_f32_16x16x32_bf16 v[20:23], v[76:79], v[172:175], v[20:23]
    v_mfma_f32_16x16x32_bf16 v[24:27], v[72:75], v[176:179], v[24:27]
    v_mfma_f32_16x16x32_bf16 v[28:31], v[76:79], v[176:179], v[28:31]
    v_mfma_f32_16x16x32_bf16 v[32:35], v[72:75], v[180:183], v[32:35]
    v_mfma_f32_16x16x32_bf16 v[36:39], v[76:79], v[180:183], v[36:39]
    ds_read_b128 v[72:75], v14 offset:5120
    ds_read_b128 v[76:79], v14 offset:23552
    s_waitcnt lgkmcnt(4)
    v_mfma_f32_16x16x32_bf16 v[16:19], v[80:83], v[184:187], v[16:19]
    v_mfma_f32_16x16x32_bf16 v[20:23], v[84:87], v[184:187], v[20:23]
    v_mfma_f32_16x16x32_bf16 v[24:27], v[80:83], v[188:191], v[24:27]
    v_mfma_f32_16x16x32_bf16 v[28:31], v[84:87], v[188:191], v[28:31]
    v_mfma_f32_16x16x32_bf16 v[32:35], v[80:83], v[192:195], v[32:35]
    v_mfma_f32_16x16x32_bf16 v[36:39], v[84:87], v[192:195], v[36:39]
    ds_read_b128 v[80:83], v15 offset:5120
    ds_read_b128 v[84:87], v15 offset:23552
    s_waitcnt lgkmcnt(4)
    v_mfma_f32_16x16x32_bf16 v[40:43], v[64:67], v[88:91], 0
    v_mfma_f32_16x16x32_bf16 v[44:47], v[68:71], v[88:91], 0
    v_mfma_f32_16x16x32_bf16 v[48:51], v[64:67], v[92:95], 0
    v_mfma_f32_16x16x32_bf16 v[52:55], v[68:71], v[92:95], 0
    v_mfma_f32_16x16x32_bf16 v[56:59], v[64:67], v[96:99], 0
    v_mfma_f32_16x16x32_bf16 v[60:63], v[68:71], v[96:99], 0
    ds_read_b128 v[64:67], v14 offset:6144
    ds_read_b128 v[68:71], v14 offset:24576
    s_waitcnt lgkmcnt(4)
    v_mfma_f32_16x16x32_bf16 v[40:43], v[72:75], v[100:103], v[40:43]
    v_mfma_f32_16x16x32_bf16 v[44:47], v[76:79], v[100:103], v[44:47]
    v_mfma_f32_16x16x32_bf16 v[48:51], v[72:75], v[104:107], v[48:51]
    v_mfma_f32_16x16x32_bf16 v[52:55], v[76:79], v[104:107], v[52:55]
    v_mfma_f32_16x16x32_bf16 v[56:59], v[72:75], v[108:111], v[56:59]
    v_mfma_f32_16x16x32_bf16 v[60:63], v[76:79], v[108:111], v[60:63]
    ds_read_b128 v[72:75], v15 offset:6144
    ds_read_b128 v[76:79], v15 offset:24576
    s_waitcnt lgkmcnt(4)
    v_mfma_f32_16x16x32_bf16 v[40:43], v[80:83], v[112:115], v[40:43]
    v_mfma_f32_16x16x32_bf16 v[44:47], v[84:87], v[112:115], v[44:47]
    v_mfma_f32_16x16x32_bf16 v[48:51], v[80:83], v[116:119], v[48:51]
    v_mfma_f32_16x16x32_bf16 v[52:55], v[84:87], v[116:119], v[52:55]
    v_mfma_f32_16x16x32_bf16 v[56:59], v[80:83], v[120:123], v[56:59]
    v_mfma_f32_16x16x32_bf16 v[60:63], v[84:87], v[120:123], v[60:63]
    ds_read_b128 v[80:83], v14 offset:7168
    ds_read_b128 v[84:87], v14 offset:25600
    s_waitcnt lgkmcnt(4)
    v_mfma_f32_16x16x32_bf16 v[40:43], v[64:67], v[124:127], v[40:43]
    v_mfma_f32_16x16x32_bf16 v[44:47], v[68:71], v[124:127], v[44:47]
    v_mfma_f32_16x16x32_bf16 v[48:51], v[64:67], v[128:131], v[48:51]
    v_mfma_f32_16x16x32_bf16 v[52:55], v[68:71], v[128:131], v[52:55]
    v_mfma_f32_16x16x32_bf16 v[56:59], v[64:67], v[132:135], v[56:59]
    v_mfma_f32_16x16x32_bf16 v[60:63], v[68:71], v[132:135], v[60:63]
    ds_read_b128 v[64:67], v15 offset:7168
    ds_read_b128 v[68:71], v15 offset:25600
    s_waitcnt lgkmcnt(4)
    v_mfma_f32_16x16x32_bf16 v[40:43], v[72:75], v[136:139], v[40:43]
    v_mfma_f32_16x16x32_bf16 v[44:47], v[76:79], v[136:139], v[44:47]
    v_mfma_f32_16x16x32_bf16 v[48:51], v[72:75], v[140:143], v[48:51]
    v_mfma_f32_16x16x32_bf16 v[52:55], v[76:79], v[140:143], v[52:55]
    v_mfma_f32_16x16x32_bf16 v[56:59], v[72:75], v[144:147], v[56:59]
    v_mfma_f32_16x16x32_bf16 v[60:63], v[76:79], v[144:147], v[60:63]
    ds_read_b128 v[72:75], v14 offset:8192
    ds_read_b128 v[76:79], v14 offset:26624
    s_waitcnt lgkmcnt(4)
    v_mfma_f32_16x16x32_bf16 v[40:43], v[80:83], v[148:151], v[40:43]
    v_mfma_f32_16x16x32_bf16 v[44:47], v[84:87], v[148:151], v[44:47]
    v_mfma_f32_16x16x32_bf16 v[48:51], v[80:83], v[152:155], v[48:51]
    v_mfma_f32_16x16x32_bf16 v[52:55], v[84:87], v[152:155], v[52:55]
    v_mfma_f32_16x16x32_bf16 v[56:59], v[80:83], v[156:159], v[56:59]
    v_mfma_f32_16x16x32_bf16 v[60:63], v[84:87], v[156:159], v[60:63]
    ds_read_b128 v[80:83], v15 offset:8192
    ds_read_b128 v[84:87], v15 offset:26624
    s_waitcnt lgkmcnt(4)
    v_mfma_f32_16x16x32_bf16 v[40:43], v[64:67], v[160:163], v[40:43]
    v_mfma_f32_16x16x32_bf16 v[44:47], v[68:71], v[160:163], v[44:47]
    v_mfma_f32_16x16x32_bf16 v[48:51], v[64:67], v[164:167], v[48:51]
    v_mfma_f32_16x16x32_bf16 v[52:55], v[68:71], v[164:167], v[52:55]
    v_mfma_f32_16x16x32_bf16 v[56:59], v[64:67], v[168:171], v[56:59]
    v_mfma_f32_16x16x32_bf16 v[60:63], v[68:71], v[168:171], v[60:63]
    s_waitcnt lgkmcnt(2)
    v_mfma_f32_16x16x32_bf16 v[40:43], v[72:75], v[172:175], v[40:43]
    v_mfma_f32_16x16x32_bf16 v[44:47], v[76:79], v[172:175], v[44:47]
    v_mfma_f32_16x16x32_bf16 v[48:51], v[72:75], v[176:179], v[48:51]
    v_mfma_f32_16x16x32_bf16 v[52:55], v[76:79], v[176:179], v[52:55]
    v_mfma_f32_16x16x32_bf16 v[56:59], v[72:75], v[180:183], v[56:59]
    v_mfma_f32_16x16x32_bf16 v[60:63], v[76:79], v[180:183], v[60:63]
    s_waitcnt lgkmcnt(0)
    v_mfma_f32_16x16x32_bf16 v[40:43], v[80:83], v[184:187], v[40:43]
    v_mfma_f32_16x16x32_bf16 v[44:47], v[84:87], v[184:187], v[44:47]
    v_mfma_f32_16x16x32_bf16 v[48:51], v[80:83], v[188:191], v[48:51]
    v_mfma_f32_16x16x32_bf16 v[52:55], v[84:87], v[188:191], v[52:55]
    v_mfma_f32_16x16x32_bf16 v[56:59], v[80:83], v[192:195], v[56:59]
    v_mfma_f32_16x16x32_bf16 v[60:63], v[84:87], v[192:195], v[60:63]
    s_barrier
    ds_read_b128 v[76:79], v9 offset:36864
    ds_read_b128 v[80:83], v9 offset:36928
    s_nop 3
    v_fmac_f32 v16, v40, v10
    v_fmac_f32 v17, v41, v10
    v_fmac_f32 v18, v42, v10
    v_fmac_f32 v19, v43, v10
    v_fmac_f32 v20, v44, v10
    v_fmac_f32 v21, v45, v10
    v_fmac_f32 v22, v46, v10
    v_fmac_f32 v23, v47, v10
    s_waitcnt lgkmcnt(0)
    v_mul_f32 v16, v16, v76
    v_mul_f32 v17, v17, v77
    v_mul_f32 v18, v18, v78
    v_mul_f32 v19, v19, v79
    v_mul_f32 v20, v20, v80
    v_mul_f32 v21, v21, v81
    v_mul_f32 v22, v22, v82
    v_mul_f32 v23, v23, v83
    v_cvt_pk_bf16_f32 v64, v16, v17
    v_cvt_pk_bf16_f32 v65, v18, v19
    v_cvt_pk_bf16_f32 v66, v20, v21
    v_cvt_pk_bf16_f32 v67, v22, v23
    buffer_store_dwordx4 v[64:67], v8, s[8:11], s50 offen
    s_add_u32 s50, s50, 65536
    v_fmac_f32 v24, v48, v10
    v_fmac_f32 v25, v49, v10
    v_fmac_f32 v26, v50, v10
    v_fmac_f32 v27, v51, v10
    v_fmac_f32 v28, v52, v10
    v_fmac_f32 v29, v53, v10
    v_fmac_f32 v30, v54, v10
    v_fmac_f32 v31, v55, v10
    v_mul_f32 v24, v24, v76
    v_mul_f32 v25, v25, v77
    v_mul_f32 v26, v26, v78
    v_mul_f32 v27, v27, v79
    v_mul_f32 v28, v28, v80
    v_mul_f32 v29, v29, v81
    v_mul_f32 v30, v30, v82
    v_mul_f32 v31, v31, v83
    v_cvt_pk_bf16_f32 v68, v24, v25
    v_cvt_pk_bf16_f32 v69, v26, v27
    v_cvt_pk_bf16_f32 v70, v28, v29
    v_cvt_pk_bf16_f32 v71, v30, v31
    buffer_store_dwordx4 v[68:71], v8, s[8:11], s50 offen
    s_add_u32 s50, s50, 65536
    v_fmac_f32 v32, v56, v10
    v_fmac_f32 v33, v57, v10
    v_fmac_f32 v34, v58, v10
    v_fmac_f32 v35, v59, v10
    v_fmac_f32 v36, v60, v10
    v_fmac_f32 v37, v61, v10
    v_fmac_f32 v38, v62, v10
    v_fmac_f32 v39, v63, v10
    v_mul_f32 v32, v32, v76
    v_mul_f32 v33, v33, v77
    v_mul_f32 v34, v34, v78
    v_mul_f32 v35, v35, v79
    v_mul_f32 v36, v36, v80
    v_mul_f32 v37, v37, v81
    v_mul_f32 v38, v38, v82
    v_mul_f32 v39, v39, v83
    v_cvt_pk_bf16_f32 v72, v32, v33
    v_cvt_pk_bf16_f32 v73, v34, v35
    v_cvt_pk_bf16_f32 v74, v36, v37
    v_cvt_pk_bf16_f32 v75, v38, v39
    buffer_store_dwordx4 v[72:75], v8, s[8:11], s50 offen
    s_branch L_ep_4
L_stats_3:
    v_mov_b32 v36, 0x3f803f80
    v_mov_b32 v37, 0x3f803f80
    v_mov_b32 v38, 0x3f803f80
    v_mov_b32 v39, 0x3f803f80
    v_lshrrev_b32 v8, 2, v3
    v_and_b32 v9, 3, v3
    s_waitcnt vmcnt(0)
    s_barrier
    s_getpc_b64 s[52:53]
    s_add_u32 s52, s52, code_begin@rel32@lo+4
    s_addc_u32 s53, s53, code_begin@rel32@hi+12
    s_and_b32 s53, s53, 0xffff
    s_mov_b32 s54, code_end-code_begin
    s_mov_b32 s55, 0x00020000
    s_lshr_b32 s44, s2, 3
    s_mul_i32 s44, s44, 3072
    buffer_load_dwordx4 v[100:103], v4, s[52:55], s44 offen offset:0
    buffer_load_dwordx4 v[104:107], v4, s[52:55], s44 offen offset:1024
    buffer_load_dwordx4 v[108:111], v4, s[52:55], s44 offen offset:2048
    ds_read_b128 v[64:67], v14 offset:0
    ds_read_b128 v[68:71], v15 offset:0
    ds_read_b128 v[72:75], v14 offset:1024
    ds_read_b128 v[76:79], v15 offset:1024
    ds_read_b128 v[80:83], v14 offset:2048
    ds_read_b128 v[84:87], v15 offset:2048
    s_waitcnt lgkmcnt(5)
    v_mfma_f32_16x16x32_bf16 v[16:19], v[64:67], v[36:39], 0
    v_mfma_f32_16x16x32_bf16 v[20:23], v[64:67], v[64:67], 0
    ds_read_b128 v[64:67], v14 offset:3072
    s_waitcnt lgkmcnt(5)
    v_mfma_f32_16x16x32_bf16 v[16:19], v[68:71], v[36:39], v[16:19]
    v_mfma_f32_16x16x32_bf16 v[20:23], v[68:71], v[68:71], v[20:23]
    ds_read_b128 v[68:71], v15 offset:3072
    s_waitcnt lgkmcnt(5)
    v_mfma_f32_16x16x32_bf16 v[16:19], v[72:75], v[36:39], v[16:19]
    v_mfma_f32_16x16x32_bf16 v[20:23], v[72:75], v[72:75], v[20:23]
    ds_read_b128 v[72:75], v14 offset:4096
    s_waitcnt lgkmcnt(5)
    v_mfma_f32_16x16x32_bf16 v[16:19], v[76:79], v[36:39], v[16:19]
    v_mfma_f32_16x16x32_bf16 v[20:23], v[76:79], v[76:79], v[20:23]
    ds_read_b128 v[76:79], v15 offset:4096
    s_waitcnt lgkmcnt(5)
    v_mfma_f32_16x16x32_bf16 v[16:19], v[80:83], v[36:39], v[16:19]
    v_mfma_f32_16x16x32_bf16 v[20:23], v[80:83], v[80:83], v[20:23]
    ds_read_b128 v[80:83], v14 offset:5120
    s_waitcnt lgkmcnt(5)
    v_mfma_f32_16x16x32_bf16 v[16:19], v[84:87], v[36:39], v[16:19]
    v_mfma_f32_16x16x32_bf16 v[20:23], v[84:87], v[84:87], v[20:23]
    ds_read_b128 v[84:87], v15 offset:5120
    s_waitcnt lgkmcnt(5)
    v_mfma_f32_16x16x32_bf16 v[16:19], v[64:67], v[36:39], v[16:19]
    v_mfma_f32_16x16x32_bf16 v[20:23], v[64:67], v[64:67], v[20:23]
    ds_read_b128 v[64:67], v14 offset:6144
    s_waitcnt lgkmcnt(5)
    v_mfma_f32_16x16x32_bf16 v[16:19], v[68:71], v[36:39], v[16:19]
    v_mfma_f32_16x16x32_bf16 v[20:23], v[68:71], v[68:71], v[20:23]
    ds_read_b128 v[68:71], v15 offset:6144
    s_waitcnt lgkmcnt(5)
    v_mfma_f32_16x16x32_bf16 v[16:19], v[72:75], v[36:39], v[16:19]
    v_mfma_f32_16x16x32_bf16 v[20:23], v[72:75], v[72:75], v[20:23]
    ds_read_b128 v[72:75], v14 offset:7168
    s_waitcnt lgkmcnt(5)
    v_mfma_f32_16x16x32_bf16 v[16:19], v[76:79], v[36:39], v[16:19]
    v_mfma_f32_16x16x32_bf16 v[20:23], v[76:79], v[76:79], v[20:23]
    ds_read_b128 v[76:79], v15 offset:7168
    s_waitcnt lgkmcnt(5)
    v_mfma_f32_16x16x32_bf16 v[16:19], v[80:83], v[36:39], v[16:19]
    v_mfma_f32_16x16x32_bf16 v[20:23], v[80:83], v[80:83], v[20:23]
    ds_read_b128 v[80:83], v14 offset:8192
    s_waitcnt lgkmcnt(5)
    v_mfma_f32_16x16x32_bf16 v[16:19], v[84:87], v[36:39], v[16:19]
    v_mfma_f32_16x16x32_bf16 v[20:23], v[84:87], v[84:87], v[20:23]
    ds_read_b128 v[84:87], v15 offset:8192
    s_waitcnt lgkmcnt(5)
    v_mfma_f32_16x16x32_bf16 v[16:19], v[64:67], v[36:39], v[16:19]
    v_mfma_f32_16x16x32_bf16 v[20:23], v[64:67], v[64:67], v[20:23]
    ds_read_b128 v[64:67], v14 offset:18432
    s_waitcnt lgkmcnt(5)
    v_mfma_f32_16x16x32_bf16 v[16:19], v[68:71], v[36:39], v[16:19]
    v_mfma_f32_16x16x32_bf16 v[20:23], v[68:71], v[68:71], v[20:23]
    ds_read_b128 v[68:71], v15 offset:18432
    s_waitcnt lgkmcnt(5)
    v_mfma_f32_16x16x32_bf16 v[16:19], v[72:75], v[36:39], v[16:19]
    v_mfma_f32_16x16x32_bf16 v[20:23], v[72:75], v[72:75], v[20:23]
    ds_read_b128 v[72:75], v14 offset:19456
    s_waitcnt lgkmcnt(5)
    v_mfma_f32_16x16x32_bf16 v[16:19], v[76:79], v[36:39], v[16:19]
    v_mfma_f32_16x16x32_bf16 v[20:23], v[76:79], v[76:79], v[20:23]
    ds_read_b128 v[76:79], v15 offset:19456
    s_waitcnt lgkmcnt(5)
    v_mfma_f32_16x16x32_bf16 v[16:19], v[80:83], v[36:39], v[16:19]
    v_mfma_f32_16x16x32_bf16 v[20:23], v[80:83], v[80:83], v[20:23]
    ds_read_b128 v[80:83], v14 offset:20480
    s_waitcnt lgkmcnt(5)
    v_mfma_f32_16x16x32_bf16 v[16:19], v[84:87], v[36:39], v[16:19]
    v_mfma_f32_16x16x32_bf16 v[20:23], v[84:87], v[84:87], v[20:23]
    ds_read_b128 v[84:87], v15 offset:20480
    s_waitcnt lgkmcnt(5)
    v_mfma_f32_16x16x32_bf16 v[24:27], v[64:67], v[36:39], 0
    v_mfma_f32_16x16x32_bf16 v[28:31], v[64:67], v[64:67], 0
    ds_read_b128 v[64:67], v14 offset:21504
    s_waitcnt lgkmcnt(5)
    v_mfma_f32_16x16x32_bf16 v[24:27], v[68:71], v[36:39], v[24:27]
    v_mfma_f32_16x16x32_bf16 v[28:31], v[68:71], v[68:71], v[28:31]
    ds_read_b128 v[68:71], v15 offset:21504
    s_waitcnt lgkmcnt(5)
    v_mfma_f32_16x16x32_bf16 v[24:27], v[72:75], v[36:39], v[24:27]
    v_mfma_f32_16x16x32_bf16 v[28:31], v[72:75], v[72:75], v[28:31]
    ds_read_b128 v[72:75], v14 offset:22528
    s_waitcnt lgkmcnt(5)
    v_mfma_f32_16x16x32_bf16 v[24:27], v[76:79], v[36:39], v[24:27]
    v_mfma_f32_16x16x32_bf16 v[28:31], v[76:79], v[76:79], v[28:31]
    ds_read_b128 v[76:79], v15 offset:22528
    s_waitcnt lgkmcnt(5)
    v_mfma_f32_16x16x32_bf16 v[24:27], v[80:83], v[36:39], v[24:27]
    v_mfma_f32_16x16x32_bf16 v[28:31], v[80:83], v[80:83], v[28:31]
    ds_read_b128 v[80:83], v14 offset:23552
    s_waitcnt lgkmcnt(5)
    v_mfma_f32_16x16x32_bf16 v[24:27], v[84:87], v[36:39], v[24:27]
    v_mfma_f32_16x16x32_bf16 v[28:31], v[84:87], v[84:87], v[28:31]
    ds_read_b128 v[84:87], v15 offset:23552
    s_waitcnt lgkmcnt(5)
    v_mfma_f32_16x16x32_bf16 v[24:27], v[64:67], v[36:39], v[24:27]
    v_mfma_f32_16x16x32_bf16 v[28:31], v[64:67], v[64:67], v[28:31]
    ds_read_b128 v[64:67], v14 offset:24576
    s_waitcnt lgkmcnt(5)
    v_mfma_f32_16x16x32_bf16 v[24:27], v[68:71], v[36:39], v[24:27]
    v_mfma_f32_16x16x32_bf16 v[28:31], v[68:71], v[68:71], v[28:31]
    ds_read_b128 v[68:71], v15 offset:24576
    s_waitcnt lgkmcnt(5)
    v_mfma_f32_16x16x32_bf16 v[24:27], v[72:75], v[36:39], v[24:27]
    v_mfma_f32_16x16x32_bf16 v[28:31], v[72:75], v[72:75], v[28:31]
    ds_read_b128 v[72:75], v14 offset:25600
    s_waitcnt lgkmcnt(5)
    v_mfma_f32_16x16x32_bf16 v[24:27], v[76:79], v[36:39], v[24:27]
    v_mfma_f32_16x16x32_bf16 v[28:31], v[76:79], v[76:79], v[28:31]
    ds_read_b128 v[76:79], v15 offset:25600
    s_waitcnt lgkmcnt(5)
    v_mfma_f32_16x16x32_bf16 v[24:27], v[80:83], v[36:39], v[24:27]
    v_mfma_f32_16x16x32_bf16 v[28:31], v[80:83], v[80:83], v[28:31]
    ds_read_b128 v[80:83], v14 offset:26624
    s_waitcnt lgkmcnt(5)
    v_mfma_f32_16x16x32_bf16 v[24:27], v[84:87], v[36:39], v[24:27]
    v_mfma_f32_16x16x32_bf16 v[28:31], v[84:87], v[84:87], v[28:31]
    ds_read_b128 v[84:87], v15 offset:26624
    s_waitcnt lgkmcnt(5)
    v_mfma_f32_16x16x32_bf16 v[24:27], v[64:67], v[36:39], v[24:27]
    v_mfma_f32_16x16x32_bf16 v[28:31], v[64:67], v[64:67], v[28:31]
    s_waitcnt lgkmcnt(4)
    v_mfma_f32_16x16x32_bf16 v[24:27], v[68:71], v[36:39], v[24:27]
    v_mfma_f32_16x16x32_bf16 v[28:31], v[68:71], v[68:71], v[28:31]
    s_waitcnt lgkmcnt(3)
    v_mfma_f32_16x16x32_bf16 v[24:27], v[72:75], v[36:39], v[24:27]
    v_mfma_f32_16x16x32_bf16 v[28:31], v[72:75], v[72:75], v[28:31]
    s_waitcnt lgkmcnt(2)
    v_mfma_f32_16x16x32_bf16 v[24:27], v[76:79], v[36:39], v[24:27]
    v_mfma_f32_16x16x32_bf16 v[28:31], v[76:79], v[76:79], v[28:31]
    s_waitcnt lgkmcnt(1)
    v_mfma_f32_16x16x32_bf16 v[24:27], v[80:83], v[36:39], v[24:27]
    v_mfma_f32_16x16x32_bf16 v[28:31], v[80:83], v[80:83], v[28:31]
    s_waitcnt lgkmcnt(0)
    v_mfma_f32_16x16x32_bf16 v[24:27], v[84:87], v[36:39], v[24:27]
    v_mfma_f32_16x16x32_bf16 v[28:31], v[84:87], v[84:87], v[28:31]
    v_cmp_eq_u32 s[40:41], 1, v9
    v_cmp_eq_u32 s[42:43], 2, v9
    v_cmp_eq_u32 s[46:47], 3, v9
    v_cmp_eq_u32 s[48:49], v8, v2
    s_nop 4
    v_cndmask_b32 v16, v16, v17, s[40:41]
    v_cndmask_b32 v16, v16, v18, s[42:43]
    v_cndmask_b32 v16, v16, v19, s[46:47]
    v_cndmask_b32 v20, v20, v21, s[40:41]
    v_cndmask_b32 v20, v20, v22, s[42:43]
    v_cndmask_b32 v20, v20, v23, s[46:47]
    v_cndmask_b32 v24, v24, v25, s[40:41]
    v_cndmask_b32 v24, v24, v26, s[42:43]
    v_cndmask_b32 v24, v24, v27, s[46:47]
    v_cndmask_b32 v28, v28, v29, s[40:41]
    v_cndmask_b32 v28, v28, v30, s[42:43]
    v_cndmask_b32 v28, v28, v31, s[46:47]
    v_mov_b32 v32, 0x3ae38e39
    v_mul_f32 v16, v32, v16
    v_mul_f32 v17, v16, v16
    v_fma_f32 v20, v20, v32, -v17
    v_max_f32 v20, 0, v20
    v_add_f32 v20, 0x3727c5ac, v20
    v_rsq_f32 v20, v20
    v_mul_f32 v24, v32, v24
    v_mul_f32 v25, v24, v24
    v_fma_f32 v28, v28, v32, -v25
    v_max_f32 v28, 0, v28
    v_add_f32 v28, 0x3727c5ac, v28
    v_rsq_f32 v28, v28
    v_lshlrev_b32 v33, 2, v3
    s_lshl_b32 s45, s35, 7
    s_add_u32 s45, s45, 47351808
    s_mov_b64 exec, s[48:49]
    ds_write_b32 v33, v20 offset:36864
    ds_write_b32 v33, v28 offset:36928
    s_cmp_lg_u32 s34, 0
    s_cbranch_scc1 L_nost_5
    buffer_store_dword v16, v33, s[8:11], s45 offen
    buffer_store_dword v24, v33, s[8:11], s45 offen offset:64
L_nost_5:
    s_waitcnt lgkmcnt(0)
    s_barrier
    s_branch L_ep_4
L_side_2:
    s_sub_u32 s32, s2, 256
    s_cmp_eq_u32 s3, 3
    s_cbranch_scc1 L_end_1
    s_waitcnt lgkmcnt(0)
    s_cmp_eq_u32 s3, 1
    s_cbranch_scc1 L_wv1_13
    s_lshl_b32 s32, s32, 1
    s_lshr_b32 s33, s3, 1
    s_add_u32 s32, s32, s33
    s_branch L_wt_6
L_wv1_13:
    s_cmp_lt_u32 s32, 108
    s_cbranch_scc1 L_pk_12
    s_sub_u32 s32, s32, 108
    s_cmp_lt_u32 s32, 72
    s_cbranch_scc1 L_rm_7
    s_add_u32 s32, s32, 440
    s_cmp_lt_u32 s32, 576
    s_cbranch_scc1 L_wt_6
    s_branch L_end_1
L_pk_12:
    s_waitcnt lgkmcnt(0)
    s_mov_b32 s8, s4
    s_and_b32 s9, s5, 0xffff
    s_mov_b32 s10, 268435456
    s_mov_b32 s11, 0x00020000
    s_cmp_ge_u32 s32, 54
    s_cbranch_scc1 L_w2_8
    s_mov_b32 s12, s24
    s_and_b32 s13, s25, 0xffff
    s_mov_b32 s14, 663552
    s_mov_b32 s15, 0x00020000
    s_mov_b32 s39, 46006272
    s_branch L_go_9
L_w2_8:
    s_sub_u32 s32, s32, 54
    s_mov_b32 s12, s26
    s_and_b32 s13, s27, 0xffff
    s_mov_b32 s14, 663552
    s_mov_b32 s15, 0x00020000
    s_mov_b32 s39, 46669824
L_go_9:
    s_mul_hi_u32 s34, s32, 1431655766
    s_mul_i32 s40, s34, 3
    s_sub_u32 s35, s32, s40
    s_mov_b32 s33, 1152
    s_lshl_b32 s36, s34, 10
    s_add_u32 s36, s36, s39
    s_mov_b32 s37, 8
    s_mov_b32 s38, 4
    s_mov_b32 s39, 8
    s_lshl_b32 s34, s34, 5
    s_mul_i32 s40, s35, 221184
    s_add_u32 s36, s36, s40
    s_mul_i32 s40, s34, s33
    s_mul_i32 s41, s35, 384
    s_add_u32 s40, s40, s41
    v_lshrrev_b32 v6, 3, v1
    v_mul_lo_u32 v6, v6, s33
    v_and_b32 v7, 7, v1
    v_lshl_add_u32 v6, v7, 4, v6
    s_lshl_b32 s41, s33, 3
    s_mul_i32 s39, s39, s33
    s_mul_i32 s42, s3, 12288
    s_add_u32 m0, s42, 0
    s_nop 0
    buffer_load_dwordx4 v6, s[12:15], s40 offen offset:0 nt lds
    s_add_u32 m0, s42, 3968
    s_nop 0
    buffer_load_dwordx4 v6, s[12:15], s40 offen offset:128 nt lds
    s_add_u32 m0, s42, 7936
    s_nop 0
    buffer_load_dwordx4 v6, s[12:15], s40 offen offset:256 nt lds
    s_add_u32 m0, s42, 1024
    s_add_u32 s40, s40, s41
    buffer_load_dwordx4 v6, s[12:15], s40 offen offset:0 nt lds
    s_add_u32 m0, s42, 4992
    s_nop 0
    buffer_load_dwordx4 v6, s[12:15], s40 offen offset:128 nt lds
    s_add_u32 m0, s42, 8960
    s_nop 0
    buffer_load_dwordx4 v6, s[12:15], s40 offen offset:256 nt lds
    s_add_u32 m0, s42, 2048
    s_add_u32 s40, s40, s39
    buffer_load_dwordx4 v6, s[12:15], s40 offen offset:0 nt lds
    s_add_u32 m0, s42, 6016
    s_nop 0
    buffer_load_dwordx4 v6, s[12:15], s40 offen offset:128 nt lds
    s_add_u32 m0, s42, 9984
    s_nop 0
    buffer_load_dwordx4 v6, s[12:15], s40 offen offset:256 nt lds
    s_add_u32 m0, s42, 3072
    s_add_u32 s40, s40, s41
    buffer_load_dwordx4 v6, s[12:15], s40 offen offset:0 nt lds
    s_add_u32 m0, s42, 7040
    s_nop 0
    buffer_load_dwordx4 v6, s[12:15], s40 offen offset:128 nt lds
    s_add_u32 m0, s42, 11008
    s_nop 0
    buffer_load_dwordx4 v6, s[12:15], s40 offen offset:256 nt lds
    v_mul_lo_u32 v7, v2, s37
    v_lshrrev_b32 v8, 2, v3
    v_add_u32 v7, v7, v8
    v_lshlrev_b32 v7, 7, v7
    v_and_b32 v8, 3, v3
    v_lshl_add_u32 v7, v8, 3, v7
    v_add_u32 v7, s42, v7
    s_lshl_b32 s43, s38, 7
    v_add_u32 v8, s43, v7
    v_add_u32 v9, 18432, v4
    v_add_u32 v10, 36864, v4
    v_add_u32 v11, 55296, v4
    s_waitcnt vmcnt(0)
    ds_read_b64_tr_b16 v[16:17], v7 offset:0
    ds_read_b64_tr_b16 v[18:19], v8 offset:0
    ds_read_b64_tr_b16 v[20:21], v7 offset:32
    ds_read_b64_tr_b16 v[22:23], v8 offset:32
    ds_read_b64_tr_b16 v[24:25], v7 offset:64
    ds_read_b64_tr_b16 v[26:27], v8 offset:64
    ds_read_b64_tr_b16 v[28:29], v7 offset:96
    ds_read_b64_tr_b16 v[30:31], v8 offset:96
    s_waitcnt lgkmcnt(6)
    buffer_store_dwordx4 v[16:19], v4, s[8:11], s36 offen sc1
    s_waitcnt lgkmcnt(4)
    buffer_store_dwordx4 v[20:23], v9, s[8:11], s36 offen sc1
    s_waitcnt lgkmcnt(2)
    buffer_store_dwordx4 v[24:27], v10, s[8:11], s36 offen sc1
    s_waitcnt lgkmcnt(0)
    buffer_store_dwordx4 v[28:31], v11, s[8:11], s36 offen sc1
    s_add_u32 s36, s36, 73728
    ds_read_b64_tr_b16 v[32:33], v7 offset:4096
    ds_read_b64_tr_b16 v[34:35], v8 offset:4096
    ds_read_b64_tr_b16 v[36:37], v7 offset:4128
    ds_read_b64_tr_b16 v[38:39], v8 offset:4128
    ds_read_b64_tr_b16 v[40:41], v7 offset:4160
    ds_read_b64_tr_b16 v[42:43], v8 offset:4160
    ds_read_b64_tr_b16 v[44:45], v7 offset:4192
    ds_read_b64_tr_b16 v[46:47], v8 offset:4192
    s_waitcnt lgkmcnt(6)
    buffer_store_dwordx4 v[32:35], v4, s[8:11], s36 offen sc1
    s_waitcnt lgkmcnt(4)
    buffer_store_dwordx4 v[36:39], v9, s[8:11], s36 offen sc1
    s_waitcnt lgkmcnt(2)
    buffer_store_dwordx4 v[40:43], v10, s[8:11], s36 offen sc1
    s_waitcnt lgkmcnt(0)
    buffer_store_dwordx4 v[44:47], v11, s[8:11], s36 offen sc1
    s_add_u32 s36, s36, 73728
    ds_read_b64_tr_b16 v[48:49], v7 offset:8192
    ds_read_b64_tr_b16 v[50:51], v8 offset:8192
    ds_read_b64_tr_b16 v[52:53], v7 offset:8224
    ds_read_b64_tr_b16 v[54:55], v8 offset:8224
    ds_read_b64_tr_b16 v[56:57], v7 offset:8256
    ds_read_b64_tr_b16 v[58:59], v8 offset:8256
    ds_read_b64_tr_b16 v[60:61], v7 offset:8288
    ds_read_b64_tr_b16 v[62:63], v8 offset:8288
    s_waitcnt lgkmcnt(6)
    buffer_store_dwordx4 v[48:51], v4, s[8:11], s36 offen sc1
    s_waitcnt lgkmcnt(4)
    buffer_store_dwordx4 v[52:55], v9, s[8:11], s36 offen sc1
    s_waitcnt lgkmcnt(2)
    buffer_store_dwordx4 v[56:59], v10, s[8:11], s36 offen sc1
    s_waitcnt lgkmcnt(0)
    buffer_store_dwordx4 v[60:63], v11, s[8:11], s36 offen sc1
    s_branch L_ep_4
L_rm_7:
    s_mov_b32 s8, s4
    s_and_b32 s9, s5, 0xffff
    s_mov_b32 s10, 268435456
    s_mov_b32 s11, 0x00020000
    s_mov_b32 s12, s26
    s_and_b32 s13, s27, 0xffff
    s_mov_b32 s14, 663552
    s_mov_b32 s15, 0x00020000
    v_lshrrev_b32 v6, 3, v1
    v_mul_u32_u24 v7, 1152, v6
    v_and_b32 v8, 7, v1
    v_lshl_add_u32 v7, v8, 4, v7
    s_mul_i32 s33, s32, 9216
    s_mov_b32 s34, 0x3f803f80
    v_mov_b32 v9, 0
    buffer_load_dwordx4 v[16:19], v7, s[12:15], s33 offen offset:0
    buffer_load_dwordx4 v[20:23], v7, s[12:15], s33 offen offset:128
    buffer_load_dwordx4 v[24:27], v7, s[12:15], s33 offen offset:256
    buffer_load_dwordx4 v[28:31], v7, s[12:15], s33 offen offset:384
    buffer_load_dwordx4 v[32:35], v7, s[12:15], s33 offen offset:512
    buffer_load_dwordx4 v[36:39], v7, s[12:15], s33 offen offset:640
    buffer_load_dwordx4 v[40:43], v7, s[12:15], s33 offen offset:768
    buffer_load_dwordx4 v[44:47], v7, s[12:15], s33 offen offset:896
    buffer_load_dwordx4 v[48:51], v7, s[12:15], s33 offen offset:1024
    s_cmp_ge_u32 s32, 72
    s_cbranch_scc1 L_nz_14
    v_mov_b32 v56, 0
    v_mov_b32 v57, 0
    v_mov_b32 v58, 0
    v_mov_b32 v59, 0
    s_lshl_b32 s38, s32, 10
    s_add_u32 s38, s38, 47622144
    buffer_store_dwordx4 v[56:59], v4, s[8:11], s38 offen
L_nz_14:
    s_waitcnt vmcnt(0)
    v_dot2_f32_bf16 v9, v16, s34, v9
    v_dot2_f32_bf16 v9, v17, s34, v9
    v_dot2_f32_bf16 v9, v18, s34, v9
    v_dot2_f32_bf16 v9, v19, s34, v9
    v_dot2_f32_bf16 v9, v20, s34, v9
    v_dot2_f32_bf16 v9, v21, s34, v9
    v_dot2_f32_bf16 v9, v22, s34, v9
    v_dot2_f32_bf16 v9, v23, s34, v9
    v_dot2_f32_bf16 v9, v24, s34, v9
    v_dot2_f32_bf16 v9, v25, s34, v9
    v_dot2_f32_bf16 v9, v26, s34, v9
    v_dot2_f32_bf16 v9, v27, s34, v9
    v_dot2_f32_bf16 v9, v28, s34, v9
    v_dot2_f32_bf16 v9, v29, s34, v9
    v_dot2_f32_bf16 v9, v30, s34, v9
    v_dot2_f32_bf16 v9, v31, s34, v9
    v_dot2_f32_bf16 v9, v32, s34, v9
    v_dot2_f32_bf16 v9, v33, s34, v9
    v_dot2_f32_bf16 v9, v34, s34, v9
    v_dot2_f32_bf16 v9, v35, s34, v9
    v_dot2_f32_bf16 v9, v36, s34, v9
    v_dot2_f32_bf16 v9, v37, s34, v9
    v_dot2_f32_bf16 v9, v38, s34, v9
    v_dot2_f32_bf16 v9, v39, s34, v9
    v_dot2_f32_bf16 v9, v40, s34, v9
    v_dot2_f32_bf16 v9, v41, s34, v9
    v_dot2_f32_bf16 v9, v42, s34, v9
    v_dot2_f32_bf16 v9, v43, s34, v9
    v_dot2_f32_bf16 v9, v44, s34, v9
    v_dot2_f32_bf16 v9, v45, s34, v9
    v_dot2_f32_bf16 v9, v46, s34, v9
    v_dot2_f32_bf16 v9, v47, s34, v9
    v_dot2_f32_bf16 v9, v48, s34, v9
    v_dot2_f32_bf16 v9, v49, s34, v9
    v_dot2_f32_bf16 v9, v50, s34, v9
    v_dot2_f32_bf16 v9, v51, s34, v9
    s_nop 3
    v_add_f32_dpp v9, v9, v9 quad_perm:[1,0,3,2] row_mask:0xf bank_mask:0xf
    s_nop 1
    v_add_f32_dpp v9, v9, v9 quad_perm:[2,3,0,1] row_mask:0xf bank_mask:0xf
    s_nop 1
    v_add_f32_dpp v9, v9, v9 row_half_mirror row_mask:0xf bank_mask:0xf
    v_mul_f32 v9, 0x3ae38e39, v9
    v_cvt_pk_bf16_f32 v10, v9, v9
    v_and_b32 v11, 0xffff0000, v10
    v_sub_f32 v9, v9, v11
    v_cvt_pk_bf16_f32 v9, v9, v9
    v_lshlrev_b32 v6, 1, v6
    s_lshl_b32 s33, s32, 8
    s_add_u32 s33, s33, 47333376
    v_cmp_eq_u32 vcc, 0, v8
    s_nop 1
    s_and_saveexec_b64 s[36:37], vcc
    buffer_store_short v10, v6, s[8:11], s33 offen
    buffer_store_short v9, v6, s[8:11], s33 offen offset:16
    s_branch L_ep_4
L_wt_6:
    s_mov_b32 s8, s4
    s_and_b32 s9, s5, 0xffff
    s_mov_b32 s10, 268435456
    s_mov_b32 s11, 0x00020000
    s_mov_b32 s12, s20
    s_and_b32 s13, s21, 0xffff
    s_mov_b32 s14, 1183744
    s_mov_b32 s15, 0x00020000
    s_mov_b32 s16, s22
    s_and_b32 s17, s23, 0xffff
    s_mov_b32 s18, 1183744
    s_mov_b32 s19, 0x00020000
    s_and_b32 s45, s32, 3
    s_bfe_u32 s40, s32, 0x40002
    s_lshr_b32 s44, s32, 6
    s_lshl_b32 s46, s40, 2
    v_add_u32 v5, s46, v2
    v_mul_u32_u24 v5, 578, v5
    v_lshl_add_u32 v6, v3, 2, v5
    s_lshl_b32 s46, s44, 6
    s_add_u32 s46, s46, 2
    s_mul_i32 s41, s45, 147968
    s_add_u32 s46, s46, s41
    buffer_load_dword v64, v6, s[12:15], s46 offen nt
    buffer_load_dword v80, v6, s[16:19], s46 offen nt
    s_add_u32 s46, s46, 36992
    buffer_load_dword v65, v6, s[12:15], s46 offen nt
    buffer_load_dword v81, v6, s[16:19], s46 offen nt
    s_add_u32 s46, s46, 36992
    buffer_load_dword v66, v6, s[12:15], s46 offen nt
    buffer_load_dword v82, v6, s[16:19], s46 offen nt
    s_add_u32 s46, s46, 36992
    buffer_load_dword v67, v6, s[12:15], s46 offen nt
    buffer_load_dword v83, v6, s[16:19], s46 offen nt
    s_add_u32 s46, s46, 480896
    buffer_load_dword v68, v6, s[12:15], s46 offen nt
    buffer_load_dword v84, v6, s[16:19], s46 offen nt
    s_add_u32 s46, s46, 36992
    buffer_load_dword v69, v6, s[12:15], s46 offen nt
    buffer_load_dword v85, v6, s[16:19], s46 offen nt
    s_add_u32 s46, s46, 36992
    buffer_load_dword v70, v6, s[12:15], s46 offen nt
    buffer_load_dword v86, v6, s[16:19], s46 offen nt
    s_add_u32 s46, s46, 36992
    buffer_load_dword v71, v6, s[12:15], s46 offen nt
    buffer_load_dword v87, v6, s[16:19], s46 offen nt
    s_lshl_b32 s36, s44, 18
    s_lshr_b32 s41, s40, 2
    s_lshl_b32 s41, s41, 11
    s_add_u32 s36, s36, s41
    s_and_b32 s41, s40, 3
    s_lshl_b32 s41, s41, 7
    s_add_u32 s36, s36, s41
    s_lshl_b32 s41, s45, 9
    s_add_u32 s36, s36, s41
    s_add_u32 s36, s36, 11796480
    s_mov_b32 s40, 0x05040100
    s_mov_b32 s41, 0x07060302
    s_mul_i32 s42, s3, 12288
    v_lshlrev_b32 v5, 8, v3
    v_lshl_add_u32 v5, v2, 5, v5
    v_add_u32 v5, s42, v5
    v_add_u32 v8, s42, v4
    v_lshrrev_b32 v6, 3, v1
    v_lshlrev_b32 v6, 13, v6
    v_and_b32 v7, 7, v1
    v_lshl_add_u32 v6, v7, 4, v6
    s_waitcnt vmcnt(0)
    v_perm_b32 v16, v80, v64, s40
    v_perm_b32 v17, v81, v65, s40
    v_perm_b32 v18, v82, v66, s40
    v_perm_b32 v19, v83, v67, s40
    ds_write_b128 v5, v[16:19] offset:0
    v_perm_b32 v20, v84, v68, s40
    v_perm_b32 v21, v85, v69, s40
    v_perm_b32 v22, v86, v70, s40
    v_perm_b32 v23, v87, v71, s40
    ds_write_b128 v5, v[20:23] offset:16
    v_perm_b32 v24, v80, v64, s41
    v_perm_b32 v25, v81, v65, s41
    v_perm_b32 v26, v82, v66, s41
    v_perm_b32 v27, v83, v67, s41
    ds_write_b128 v5, v[24:27] offset:128
    v_perm_b32 v28, v84, v68, s41
    v_perm_b32 v29, v85, v69, s41
    v_perm_b32 v30, v86, v70, s41
    v_perm_b32 v31, v87, v71, s41
    ds_write_b128 v5, v[28:31] offset:144
    s_waitcnt lgkmcnt(0)
    ds_read_b128 v[64:67], v8 offset:0
    ds_read_b128 v[68:71], v8 offset:1024
    ds_read_b128 v[72:75], v8 offset:2048
    ds_read_b128 v[76:79], v8 offset:3072
    s_add_u32 s45, s36, 0
    s_waitcnt lgkmcnt(3)
    buffer_store_dwordx4 v[64:67], v6, s[8:11], s45 offen
    s_add_u32 s45, s36, 65536
    s_waitcnt lgkmcnt(2)
    buffer_store_dwordx4 v[68:71], v6, s[8:11], s45 offen
    s_add_u32 s45, s36, 131072
    s_waitcnt lgkmcnt(1)
    buffer_store_dwordx4 v[72:75], v6, s[8:11], s45 offen
    s_add_u32 s45, s36, 196608
    s_waitcnt lgkmcnt(0)
    buffer_store_dwordx4 v[76:79], v6, s[8:11], s45 offen
L_ep_4:
L_end_1:
    s_endpgm
.globl k3_kernel
.p2align 8
.type k3_kernel,@function
k3_kernel:
    s_cmp_ge_u32 s2, 256
    s_cbranch_scc1 L_end_15
    s_load_dwordx2 s[4:5], s[0:1], 80
    s_load_dwordx2 s[6:7], s[0:1], 0
    s_load_dwordx2 s[22:23], s[0:1], 64
    s_load_dwordx2 s[20:21], s[0:1], 56
    s_load_dwordx2 s[18:19], s[0:1], 48
    v_lshrrev_b32 v5, 6, v0
    v_and_b32 v1, 63, v0
    v_readfirstlane_b32 s3, v5
    v_lshrrev_b32 v2, 4, v1
    v_and_b32 v3, 15, v1
    v_lshlrev_b32 v4, 4, v1
    s_lshr_b32 s30, s2, 3
    s_and_b32 s31, s2, 7
    s_lshr_b32 s26, s31, 1
    s_lshl_b32 s26, s26, 3
    s_lshr_b32 s32, s30, 2
    s_add_u32 s26, s26, s32
    s_and_b32 s24, s30, 3
    s_and_b32 s29, s31, 1
    s_lshl_b32 s25, s26, 1
    s_add_u32 s25, s25, s29
    s_mul_i32 s27, s24, 9
    s_mul_i32 s32, s3, 3
    s_add_u32 s27, s27, s32
    s_lshl_b32 s28, s29, 2
    s_add_u32 s28, s28, s24
    s_cmp_ge_u32 s30, 18
    s_cbranch_scc1 L_pack_16
    s_lshl_b32 s34, s30, 3
    s_add_u32 s34, s34, s31
    s_mov_b32 s58, s34
    s_mov_b32 s56, 255
    s_mov_b32 s57, 0
    s_add_u32 s35, s34, 1
    s_sub_u32 s46, 287, s34
    s_cmp_eq_u32 s34, 143
    s_cselect_b32 s46, 288, s46
    s_cselect_b32 s14, 0, 268435456
    s_cselect_b32 s45, 0, s46
    s_lshl_b32 s39, s34, 13
    s_lshl_b32 s47, s46, 13
    s_lshl_b32 s40, s3, 11
    s_add_u32 s40, s40, 11796480
    s_add_u32 s39, s39, s40
    s_add_u32 s47, s47, s40
    s_sub_u32 s47, s47, 8192
    s_lshl_b32 s38, s35, 13
    s_lshl_b32 s45, s45, 13
    s_lshl_b32 s35, s35, 12
    s_lshl_b32 s46, s46, 12
    s_sub_u32 s36, 2359296, s35
    s_sub_u32 s37, 2359296, s46
    v_lshlrev_b32 v6, 5, v1
    s_cmp_eq_u32 s3, 1
    s_cselect_b32 s48, s36, s35
    s_cmp_eq_u32 s3, 2
    s_cselect_b32 s48, s46, s48
    s_cmp_eq_u32 s3, 3
    s_cselect_b32 s48, s37, s48
    s_cselect_b32 s14, s14, 268435456
    s_lshl_b32 s49, s3, 12
    s_add_u32 m0, s49, 16384
    s_waitcnt lgkmcnt(0)
    s_mov_b32 s8, s4
    s_and_b32 s9, s5, 0xffff
    s_mov_b32 s10, 268435456
    s_mov_b32 s11, 0x00020000
    s_mov_b32 s12, s8
    s_mov_b32 s13, s9
    s_mov_b32 s15, 0x00020000
    buffer_load_dwordx4 v4, s[12:15], s48 offen offset:0 lds
    buffer_load_dwordx4 v4, s[12:15], s48 offen offset:1024 lds
    buffer_load_dwordx4 v4, s[12:15], s48 offen offset:2048 lds
    buffer_load_dwordx4 v4, s[12:15], s48 offen offset:3072 lds
    buffer_load_dwordx4 v[48:51], v6, s[8:11], s39 offen
    buffer_load_dwordx4 v[52:55], v6, s[8:11], s39 offen offset:16
    buffer_load_dwordx4 v[200:203], v6, s[8:11], s47 offen
    buffer_load_dwordx4 v[204:207], v6, s[8:11], s47 offen offset:16
    s_lshl_b32 s40, s3, 4
    v_add_u32 v7, s40, v3
    v_cvt_f32_u32 v7, v7
    v_lshlrev_b32 v5, 2, v2
    v_cvt_f32_u32 v5, v5
    v_cvt_f32_u32 v6, v3
    s_mov_b32 s41, 0x80008000
    s_brev_b32 s42, 1
    v_and_b32 v0, 1, v3
    v_mul_lo_u32 v0, v0, s41
    v_mul_f32 v8, 0x3c800000, v7
    v_mul_f32 v9, v5, v8
    v_fmamk_f32 v136, v8, 0x00000000, v9
    v_fmamk_f32 v137, v8, 0x3f800000, v9
    v_fmamk_f32 v138, v8, 0x40000000, v9
    v_fmamk_f32 v139, v8, 0x40400000, v9
    v_fmamk_f32 v140, v8, 0x41800000, v9
    v_fmamk_f32 v141, v8, 0x41880000, v9
    v_fmamk_f32 v142, v8, 0x41900000, v9
    v_fmamk_f32 v143, v8, 0x41980000, v9
    v_fract_f32 v136, v136
    v_fract_f32 v137, v137
    v_fract_f32 v138, v138
    v_fract_f32 v139, v139
    v_fract_f32 v140, v140
    v_fract_f32 v141, v141
    v_fract_f32 v142, v142
    v_fract_f32 v143, v143
    v_sin_f32 v144, v136
    v_sin_f32 v145, v137
    v_sin_f32 v146, v138
    v_sin_f32 v147, v139
    v_sin_f32 v148, v140
    v_sin_f32 v149, v141
    v_sin_f32 v150, v142
    v_sin_f32 v151, v143
    v_cos_f32 v136, v136
    v_cos_f32 v137, v137
    v_cos_f32 v138, v138
    v_cos_f32 v139, v139
    v_cos_f32 v140, v140
    v_cos_f32 v141, v141
    v_cos_f32 v142, v142
    v_cos_f32 v143, v143
    v_cvt_pk_bf16_f32 v64, v144, v145
    v_cvt_pk_bf16_f32 v65, v146, v147
    v_cvt_pk_bf16_f32 v66, v148, v149
    v_cvt_pk_bf16_f32 v67, v150, v151
    v_cvt_pk_bf16_f32 v56, v136, v137
    v_cvt_pk_bf16_f32 v57, v138, v139
    v_cvt_pk_bf16_f32 v58, v140, v141
    v_cvt_pk_bf16_f32 v59, v142, v143
    v_xor_b32 v72, s41, v64
    v_xor_b32 v73, s41, v65
    v_xor_b32 v74, s41, v66
    v_xor_b32 v75, s41, v67
    v_xor_b32 v60, v0, v56
    v_xor_b32 v61, v0, v57
    v_xor_b32 v62, v0, v58
    v_xor_b32 v63, v0, v59
    v_xor_b32 v68, v0, v64
    v_xor_b32 v69, v0, v65
    v_xor_b32 v70, v0, v66
    v_xor_b32 v71, v0, v67
    v_xor_b32 v76, v0, v72
    v_xor_b32 v77, v0, v73
    v_xor_b32 v78, v0, v74
    v_xor_b32 v79, v0, v75
    v_mul_f32 v8, 0x3a000000, v7
    v_mul_f32 v9, v5, v8
    v_fmamk_f32 v104, v8, 0x00000000, v9
    v_fmamk_f32 v105, v8, 0x3f800000, v9
    v_fmamk_f32 v106, v8, 0x40000000, v9
    v_fmamk_f32 v107, v8, 0x40400000, v9
    v_fmamk_f32 v108, v8, 0x41800000, v9
    v_fmamk_f32 v109, v8, 0x41880000, v9
    v_fmamk_f32 v110, v8, 0x41900000, v9
    v_fmamk_f32 v111, v8, 0x41980000, v9
    v_sin_f32 v112, v104
    v_sin_f32 v113, v105
    v_sin_f32 v114, v106
    v_sin_f32 v115, v107
    v_sin_f32 v116, v108
    v_sin_f32 v117, v109
    v_sin_f32 v118, v110
    v_sin_f32 v119, v111
    v_cos_f32 v104, v104
    v_cos_f32 v105, v105
    v_cos_f32 v106, v106
    v_cos_f32 v107, v107
    v_cos_f32 v108, v108
    v_cos_f32 v109, v109
    v_cos_f32 v110, v110
    v_cos_f32 v111, v111
    v_mul_f32 v8, 0x3d000000, v6
    v_mul_f32 v9, v5, v8
    v_fmamk_f32 v120, v8, 0x00000000, v9
    v_fmamk_f32 v121, v8, 0x3f800000, v9
    v_fmamk_f32 v122, v8, 0x40000000, v9
    v_fmamk_f32 v123, v8, 0x40400000, v9
    v_fract_f32 v120, v120
    v_fract_f32 v121, v121
    v_fract_f32 v122, v122
    v_fract_f32 v123, v123
    v_sin_f32 v124, v120
    v_sin_f32 v125, v121
    v_sin_f32 v126, v122
    v_sin_f32 v127, v123
    v_cos_f32 v120, v120
    v_cos_f32 v121, v121
    v_cos_f32 v122, v122
    v_cos_f32 v123, v123
    v_cvt_pk_bf16_f32 v88, v124, v125
    v_cvt_pk_bf16_f32 v89, v126, v127
    v_cvt_pk_bf16_f32 v80, v120, v121
    v_cvt_pk_bf16_f32 v81, v122, v123
    v_xor_b32 v82, v0, v80
    v_xor_b32 v83, v0, v81
    v_xor_b32 v90, v0, v88
    v_xor_b32 v91, v0, v89
    v_xor_b32 v84, s42, v80
    v_xor_b32 v85, s42, v81
    v_xor_b32 v86, s42, v82
    v_xor_b32 v87, s42, v83
    v_xor_b32 v92, s42, v88
    v_xor_b32 v93, s42, v89
    v_xor_b32 v94, s42, v90
    v_xor_b32 v95, s42, v91
    v_xor_b32 v96, s41, v88
    v_xor_b32 v97, s41, v89
    v_xor_b32 v98, s41, v90
    v_xor_b32 v99, s41, v91
    v_xor_b32 v100, s41, v92
    v_xor_b32 v101, s41, v93
    v_xor_b32 v102, s41, v94
    v_xor_b32 v103, s41, v95
    s_mov_b32 s12, s18
    s_and_b32 s13, s19, 0xffff
    s_mov_b32 s14, 5308416
    s_mov_b32 s15, 0x00020000
    v_lshrrev_b32 v232, 3, v1
    v_and_b32 v233, 7, v1
    v_mul_u32_u24 v232, 9216, v232
    v_lshl_add_u32 v232, v233, 4, v232
    s_lshr_b32 s52, s34, 1
    s_mul_i32 s52, s52, 3
    s_and_b32 s53, s34, 1
    s_lshl_b32 s53, s53, 1
    s_add_u32 s55, s52, s53
    s_mul_hi_u32 s52, s55, 159072863
    s_mul_i32 s49, s52, 27
    s_sub_u32 s53, s55, s49
    s_mul_hi_u32 s54, s53, 1431655766
    s_mul_i32 s49, s54, 3
    s_sub_u32 s59, s53, s49
    s_mul_i32 s50, s52, 663552
    s_lshl_b32 s49, s54, 10
    s_add_u32 s50, s50, s49
    s_mul_i32 s49, s59, 221184
    s_add_u32 s50, s50, s49
    s_add_u32 s50, s50, 35389440
    s_lshl_b32 s54, s54, 2
    s_add_u32 s54, s54, s3
    s_mul_i32 s16, s54, 73728
    s_mul_i32 s52, s52, 1152
    s_add_u32 s16, s16, s52
    s_mul_i32 s59, s59, 384
    s_add_u32 s16, s16, s59
    s_add_u32 s55, s55, 1
    s_mul_hi_u32 s52, s55, 159072863
    s_mul_i32 s49, s52, 27
    s_sub_u32 s53, s55, s49
    s_mul_hi_u32 s54, s53, 1431655766
    s_mul_i32 s49, s54, 3
    s_sub_u32 s59, s53, s49
    s_mul_i32 s51, s52, 663552
    s_lshl_b32 s49, s54, 10
    s_add_u32 s51, s51, s49
    s_mul_i32 s49, s59, 221184
    s_add_u32 s51, s51, s49
    s_add_u32 s51, s51, 35389440
    s_lshl_b32 s54, s54, 2
    s_add_u32 s54, s54, s3
    s_mul_i32 s17, s54, 73728
    s_mul_i32 s52, s52, 1152
    s_add_u32 s17, s17, s52
    s_mul_i32 s59, s59, 384
    s_add_u32 s17, s17, s59
    s_lshl_b32 s52, s3, 10
    s_waitcnt vmcnt(4)
    s_barrier
    ds_read_b128 v[16:19], v4 offset:16384
    ds_read_b128 v[32:35], v4 offset:20480
    ds_read_b128 v[24:27], v4 offset:18432
    ds_read_b128 v[40:43], v4 offset:22528
    ds_read_b128 v[20:23], v4 offset:17408
    ds_read_b128 v[36:39], v4 offset:21504
    ds_read_b128 v[28:31], v4 offset:19456
    ds_read_b128 v[44:47], v4 offset:23552
    ds_read_b128 v[168:171], v4 offset:24576
    ds_read_b128 v[184:187], v4 offset:28672
    ds_read_b128 v[176:179], v4 offset:26624
    ds_read_b128 v[192:195], v4 offset:30720
    ds_read_b128 v[172:175], v4 offset:25600
    ds_read_b128 v[188:191], v4 offset:29696
    ds_read_b128 v[180:183], v4 offset:27648
    ds_read_b128 v[196:199], v4 offset:31744
    s_waitcnt lgkmcnt(8)
    v_mfma_f32_16x16x32_bf16 v[152:155], v[16:19], v[56:59], 0
    v_cvt_f32_u32 v0, s40
    v_add_f32 v0, v0, v5
    v_mfma_f32_16x16x32_bf16 v[156:159], v[24:27], v[56:59], 0
    v_mul_f32 v7, 0x3a000000, v6
    v_add_f32 v5, 0x3c000000, v7
    v_mfma_f32_16x16x32_bf16 v[160:163], v[32:35], v[56:59], 0
    v_mul_f32 v6, v0, v7
    v_mul_f32 v0, v0, v5
    v_mfma_f32_16x16x32_bf16 v[164:167], v[40:43], v[56:59], 0
    v_fmamk_f32 v120, v7, 0x00000000, v6
    v_fmamk_f32 v121, v7, 0x3f800000, v6
    v_mfma_f32_16x16x32_bf16 v[152:155], v[32:35], v[64:67], v[152:155]
    v_fmamk_f32 v122, v7, 0x40000000, v6
    v_fmamk_f32 v123, v7, 0x40400000, v6
    v_mfma_f32_16x16x32_bf16 v[156:159], v[40:43], v[64:67], v[156:159]
    v_fmamk_f32 v124, v5, 0x00000000, v0
    v_fmamk_f32 v125, v5, 0x3f800000, v0
    v_mfma_f32_16x16x32_bf16 v[160:163], v[16:19], v[72:75], v[160:163]
    v_fmamk_f32 v126, v5, 0x40000000, v0
    v_fmamk_f32 v127, v5, 0x40400000, v0
    v_mfma_f32_16x16x32_bf16 v[164:167], v[24:27], v[72:75], v[164:167]
    v_sin_f32 v128, v120
    v_sin_f32 v129, v121
    v_mfma_f32_16x16x32_bf16 v[152:155], v[20:23], v[60:63], v[152:155]
    v_sin_f32 v130, v122
    v_sin_f32 v131, v123
    v_mfma_f32_16x16x32_bf16 v[156:159], v[28:31], v[60:63], v[156:159]
    v_sin_f32 v132, v124
    v_sin_f32 v133, v125
    v_mfma_f32_16x16x32_bf16 v[160:163], v[36:39], v[60:63], v[160:163]
    v_sin_f32 v134, v126
    v_sin_f32 v135, v127
    v_mfma_f32_16x16x32_bf16 v[164:167], v[44:47], v[60:63], v[164:167]
    v_cos_f32 v120, v120
    v_cos_f32 v121, v121
    v_mfma_f32_16x16x32_bf16 v[152:155], v[36:39], v[68:71], v[152:155]
    v_cos_f32 v122, v122
    v_cos_f32 v123, v123
    v_mfma_f32_16x16x32_bf16 v[156:159], v[44:47], v[68:71], v[156:159]
    v_cos_f32 v124, v124
    v_cos_f32 v125, v125
    v_mfma_f32_16x16x32_bf16 v[160:163], v[20:23], v[76:79], v[160:163]
    v_cos_f32 v126, v126
    v_cos_f32 v127, v127
    v_mfma_f32_16x16x32_bf16 v[164:167], v[28:31], v[76:79], v[164:167]
    s_nop 7
    s_waitcnt lgkmcnt(0)
    v_mfma_f32_16x16x32_bf16 v[208:211], v[168:171], v[56:59], 0
    v_mul_f32 v136, v152, v104
    v_mul_f32 v137, v153, v105
    v_mfma_f32_16x16x32_bf16 v[212:215], v[176:179], v[56:59], 0
    v_mul_f32 v138, v154, v106
    v_mul_f32 v139, v155, v107
    v_mfma_f32_16x16x32_bf16 v[216:219], v[184:187], v[56:59], 0
    v_mul_f32 v140, v156, v108
    v_mul_f32 v141, v157, v109
    v_mfma_f32_16x16x32_bf16 v[220:223], v[192:195], v[56:59], 0
    v_mul_f32 v142, v158, v110
    v_mul_f32 v143, v159, v111
    v_mfma_f32_16x16x32_bf16 v[208:211], v[184:187], v[64:67], v[208:211]
    v_mul_f32 v144, v160, v104
    v_mul_f32 v145, v161, v105
    v_mfma_f32_16x16x32_bf16 v[212:215], v[192:195], v[64:67], v[212:215]
    v_mul_f32 v146, v162, v106
    v_mul_f32 v147, v163, v107
    v_mfma_f32_16x16x32_bf16 v[216:219], v[168:171], v[72:75], v[216:219]
    v_mul_f32 v148, v164, v108
    v_mul_f32 v149, v165, v109
    v_mfma_f32_16x16x32_bf16 v[220:223], v[176:179], v[72:75], v[220:223]
    v_mul_f32 v150, v166, v110
    v_mul_f32 v151, v167, v111
    v_mfma_f32_16x16x32_bf16 v[208:211], v[172:175], v[60:63], v[208:211]
    v_fma_f32 v136, v160, v112, v136
    v_fma_f32 v137, v161, v113, v137
    v_mfma_f32_16x16x32_bf16 v[212:215], v[180:183], v[60:63], v[212:215]
    v_fma_f32 v138, v162, v114, v138
    v_fma_f32 v139, v163, v115, v139
    v_mfma_f32_16x16x32_bf16 v[216:219], v[188:191], v[60:63], v[216:219]
    v_fma_f32 v140, v164, v116, v140
    v_fma_f32 v141, v165, v117, v141
    v_mfma_f32_16x16x32_bf16 v[220:223], v[196:199], v[60:63], v[220:223]
    v_fma_f32 v142, v166, v118, v142
    v_fma_f32 v143, v167, v119, v143
    v_mfma_f32_16x16x32_bf16 v[208:211], v[188:191], v[68:71], v[208:211]
    v_fma_f32 v144, -v152, v112, v144
    v_fma_f32 v145, -v153, v113, v145
    v_mfma_f32_16x16x32_bf16 v[212:215], v[196:199], v[68:71], v[212:215]
    v_fma_f32 v146, -v154, v114, v146
    v_fma_f32 v147, -v155, v115, v147
    v_mfma_f32_16x16x32_bf16 v[216:219], v[172:175], v[76:79], v[216:219]
    v_fma_f32 v148, -v156, v116, v148
    v_fma_f32 v149, -v157, v117, v149
    v_mfma_f32_16x16x32_bf16 v[220:223], v[180:183], v[76:79], v[220:223]
    v_fma_f32 v150, -v158, v118, v150
    v_fma_f32 v151, -v159, v119, v151
    v_cvt_pk_bf16_f32 v8, v136, v137
    v_cvt_pk_bf16_f32 v9, v138, v139
    v_cvt_pk_bf16_f32 v10, v140, v141
    v_cvt_pk_bf16_f32 v11, v142, v143
    v_cvt_pk_bf16_f32 v12, v144, v145
    v_cvt_pk_bf16_f32 v13, v146, v147
    v_cvt_pk_bf16_f32 v14, v148, v149
    v_cvt_pk_bf16_f32 v15, v150, v151
    s_nop 0
    v_mfma_f32_16x16x32_bf16 v[152:155], v[80:83], v[8:11], 0
    v_mul_f32 v136, v208, v104
    v_mul_f32 v137, v209, v105
    v_mfma_f32_16x16x32_bf16 v[156:159], v[84:87], v[8:11], 0
    v_mul_f32 v138, v210, v106
    v_mul_f32 v139, v211, v107
    v_mfma_f32_16x16x32_bf16 v[160:163], v[80:83], v[12:15], 0
    v_mul_f32 v140, v212, v108
    v_mul_f32 v141, v213, v109
    v_mfma_f32_16x16x32_bf16 v[164:167], v[84:87], v[12:15], 0
    v_mul_f32 v142, v214, v110
    v_mul_f32 v143, v215, v111
    v_mfma_f32_16x16x32_bf16 v[152:155], v[88:91], v[12:15], v[152:155]
    v_mul_f32 v144, v216, v104
    v_mul_f32 v145, v217, v105
    v_mfma_f32_16x16x32_bf16 v[156:159], v[92:95], v[12:15], v[156:159]
    v_mul_f32 v146, v218, v106
    v_mul_f32 v147, v219, v107
    v_mfma_f32_16x16x32_bf16 v[160:163], v[96:99], v[8:11], v[160:163]
    v_mul_f32 v148, v220, v108
    v_mul_f32 v149, v221, v109
    v_mfma_f32_16x16x32_bf16 v[164:167], v[100:103], v[8:11], v[164:167]
    v_mul_f32 v150, v222, v110
    v_mul_f32 v151, v223, v111
    v_fma_f32 v136, v216, v112, v136
    v_fma_f32 v137, v217, v113, v137
    v_fma_f32 v138, v218, v114, v138
    v_fma_f32 v139, v219, v115, v139
    v_fma_f32 v140, v220, v116, v140
    v_fma_f32 v141, v221, v117, v141
    v_fma_f32 v142, v222, v118, v142
    v_fma_f32 v143, v223, v119, v143
    v_fma_f32 v144, -v208, v112, v144
    v_fma_f32 v145, -v209, v113, v145
    v_fma_f32 v146, -v210, v114, v146
    v_fma_f32 v147, -v211, v115, v147
    v_fma_f32 v148, -v212, v116, v148
    v_fma_f32 v149, -v213, v117, v149
    v_fma_f32 v150, -v214, v118, v150
    v_fma_f32 v151, -v215, v119, v151
    v_cvt_pk_bf16_f32 v224, v136, v137
    v_cvt_pk_bf16_f32 v225, v138, v139
    v_cvt_pk_bf16_f32 v226, v140, v141
    v_cvt_pk_bf16_f32 v227, v142, v143
    v_cvt_pk_bf16_f32 v228, v144, v145
    v_cvt_pk_bf16_f32 v229, v146, v147
    v_cvt_pk_bf16_f32 v230, v148, v149
    v_cvt_pk_bf16_f32 v231, v150, v151
    s_waitcnt vmcnt(0)
    s_add_u32 m0, s52, 49152
    s_nop 0
    buffer_load_dwordx4 v232, s[12:15], s16 offen offset:0 nt lds
    s_add_u32 m0, s52, 53120
    s_nop 0
    buffer_load_dwordx4 v232, s[12:15], s16 offen offset:128 nt lds
    s_add_u32 m0, s52, 57088
    s_nop 0
    buffer_load_dwordx4 v232, s[12:15], s16 offen offset:256 nt lds
    s_bitcmp1_b32 s34, 0
    s_cbranch_scc1 L_noearly_18
    s_add_u32 m0, s52, 61440
    s_nop 0
    buffer_load_dwordx4 v232, s[12:15], s17 offen offset:0 nt lds
    s_add_u32 m0, s52, 65408
    s_nop 0
    buffer_load_dwordx4 v232, s[12:15], s17 offen offset:128 nt lds
    s_add_u32 m0, s52, 69376
    s_nop 0
    buffer_load_dwordx4 v232, s[12:15], s17 offen offset:256 nt lds
L_noearly_18:
    v_mfma_f32_16x16x32_bf16 v[208:211], v[80:83], v[224:227], 0
    v_lshlrev_b32 v104, 16, v48
    v_and_b32 v112, 0xffff0000, v48
    v_mfma_f32_16x16x32_bf16 v[212:215], v[84:87], v[224:227], 0
    v_lshlrev_b32 v105, 16, v49
    v_and_b32 v113, 0xffff0000, v49
    v_mfma_f32_16x16x32_bf16 v[216:219], v[80:83], v[228:231], 0
    v_lshlrev_b32 v106, 16, v50
    v_and_b32 v114, 0xffff0000, v50
    v_mfma_f32_16x16x32_bf16 v[220:223], v[84:87], v[228:231], 0
    v_lshlrev_b32 v107, 16, v51
    v_and_b32 v115, 0xffff0000, v51
    v_mfma_f32_16x16x32_bf16 v[208:211], v[88:91], v[228:231], v[208:211]
    v_lshlrev_b32 v108, 16, v52
    v_and_b32 v116, 0xffff0000, v52
    v_mfma_f32_16x16x32_bf16 v[212:215], v[92:95], v[228:231], v[212:215]
    v_lshlrev_b32 v109, 16, v53
    v_and_b32 v117, 0xffff0000, v53
    v_mfma_f32_16x16x32_bf16 v[216:219], v[96:99], v[224:227], v[216:219]
    v_lshlrev_b32 v110, 16, v54
    v_and_b32 v118, 0xffff0000, v54
    v_mfma_f32_16x16x32_bf16 v[220:223], v[100:103], v[224:227], v[220:223]
    v_lshlrev_b32 v111, 16, v55
    v_and_b32 v119, 0xffff0000, v55
    v_mul_f32 v136, v152, v104
    v_mul_f32 v137, v153, v105
    v_mul_f32 v138, v154, v106
    v_mul_f32 v139, v155, v107
    v_mul_f32 v140, v156, v108
    v_mul_f32 v141, v157, v109
    v_mul_f32 v142, v158, v110
    v_mul_f32 v143, v159, v111
    v_mul_f32 v144, v160, v104
    v_mul_f32 v145, v161, v105
    v_mul_f32 v146, v162, v106
    v_mul_f32 v147, v163, v107
    v_mul_f32 v148, v164, v108
    v_mul_f32 v149, v165, v109
    v_mul_f32 v150, v166, v110
    v_mul_f32 v151, v167, v111
    v_fma_f32 v136, -v160, v112, v136
    v_fma_f32 v137, -v161, v113, v137
    v_fma_f32 v138, -v162, v114, v138
    v_fma_f32 v139, -v163, v115, v139
    v_fma_f32 v140, -v164, v116, v140
    v_fma_f32 v141, -v165, v117, v141
    v_fma_f32 v142, -v166, v118, v142
    v_fma_f32 v143, -v167, v119, v143
    v_fma_f32 v144, v152, v112, v144
    v_fma_f32 v145, v153, v113, v145
    v_fma_f32 v146, v154, v114, v146
    v_fma_f32 v147, v155, v115, v147
    v_fma_f32 v148, v156, v116, v148
    v_fma_f32 v149, v157, v117, v149
    v_fma_f32 v150, v158, v118, v150
    v_fma_f32 v151, v159, v119, v151
    v_cvt_pk_bf16_f32 v8, v136, v137
    v_cvt_pk_bf16_f32 v9, v138, v139
    v_cvt_pk_bf16_f32 v10, v140, v141
    v_cvt_pk_bf16_f32 v11, v142, v143
    v_cvt_pk_bf16_f32 v12, v144, v145
    v_cvt_pk_bf16_f32 v13, v146, v147
    v_cvt_pk_bf16_f32 v14, v148, v149
    v_cvt_pk_bf16_f32 v15, v150, v151
    s_lshr_b32 s43, s3, 1
    s_lshl_b32 s43, s43, 10
    v_mfma_f32_16x16x32_bf16 v[152:155], v[8:11], v[80:83], 0
    v_lshlrev_b32 v104, 16, v200
    v_and_b32 v112, 0xffff0000, v200
    v_mfma_f32_16x16x32_bf16 v[156:159], v[8:11], v[84:87], 0
    v_lshlrev_b32 v105, 16, v201
    v_and_b32 v113, 0xffff0000, v201
    v_mfma_f32_16x16x32_bf16 v[160:163], v[12:15], v[80:83], 0
    v_lshlrev_b32 v106, 16, v202
    v_and_b32 v114, 0xffff0000, v202
    v_mfma_f32_16x16x32_bf16 v[164:167], v[12:15], v[84:87], 0
    v_lshlrev_b32 v107, 16, v203
    v_and_b32 v115, 0xffff0000, v203
    v_mfma_f32_16x16x32_bf16 v[152:155], v[12:15], v[96:99], v[152:155]
    v_lshlrev_b32 v108, 16, v204
    v_and_b32 v116, 0xffff0000, v204
    v_mfma_f32_16x16x32_bf16 v[156:159], v[12:15], v[100:103], v[156:159]
    v_lshlrev_b32 v109, 16, v205
    v_and_b32 v117, 0xffff0000, v205
    v_mfma_f32_16x16x32_bf16 v[160:163], v[8:11], v[88:91], v[160:163]
    v_lshlrev_b32 v110, 16, v206
    v_and_b32 v118, 0xffff0000, v206
    v_mfma_f32_16x16x32_bf16 v[164:167], v[8:11], v[92:95], v[164:167]
    v_lshlrev_b32 v111, 16, v207
    v_and_b32 v119, 0xffff0000, v207
    v_mul_f32 v136, v208, v104
    v_mul_f32 v137, v209, v105
    v_mul_f32 v138, v210, v106
    v_mul_f32 v139, v211, v107
    v_mul_f32 v140, v212, v108
    v_mul_f32 v141, v213, v109
    v_mul_f32 v142, v214, v110
    v_mul_f32 v143, v215, v111
    v_mul_f32 v144, v216, v104
    v_mul_f32 v145, v217, v105
    v_mul_f32 v146, v218, v106
    v_mul_f32 v147, v219, v107
    v_mul_f32 v148, v220, v108
    v_mul_f32 v149, v221, v109
    v_mul_f32 v150, v222, v110
    v_mul_f32 v151, v223, v111
    v_fma_f32 v136, -v216, v112, v136
    v_fma_f32 v137, -v217, v113, v137
    v_fma_f32 v138, -v218, v114, v138
    v_fma_f32 v139, -v219, v115, v139
    v_fma_f32 v140, -v220, v116, v140
    v_fma_f32 v141, -v221, v117, v141
    v_fma_f32 v142, -v222, v118, v142
    v_fma_f32 v143, -v223, v119, v143
    v_fma_f32 v144, v208, v112, v144
    v_fma_f32 v145, v209, v113, v145
    v_fma_f32 v146, v210, v114, v146
    v_fma_f32 v147, v211, v115, v147
    v_fma_f32 v148, v212, v116, v148
    v_fma_f32 v149, v213, v117, v149
    v_fma_f32 v150, v214, v118, v150
    v_fma_f32 v151, v215, v119, v151
    v_cvt_pk_bf16_f32 v224, v136, v137
    v_cvt_pk_bf16_f32 v225, v138, v139
    v_cvt_pk_bf16_f32 v226, v140, v141
    v_cvt_pk_bf16_f32 v227, v142, v143
    v_cvt_pk_bf16_f32 v228, v144, v145
    v_cvt_pk_bf16_f32 v229, v146, v147
    v_cvt_pk_bf16_f32 v230, v148, v149
    v_cvt_pk_bf16_f32 v231, v150, v151
    s_and_b32 s44, s3, 1
    s_lshl_b32 s44, s44, 3
    s_add_u32 s43, s43, s44
    v_add_u32 v5, s43, v4
    v_mfma_f32_16x16x32_bf16 v[208:211], v[224:227], v[80:83], 0
    v_mul_f32 v136, v152, v120
    v_mul_f32 v137, v153, v121
    v_mfma_f32_16x16x32_bf16 v[212:215], v[224:227], v[84:87], 0
    v_mul_f32 v138, v154, v122
    v_mul_f32 v139, v155, v123
    v_mfma_f32_16x16x32_bf16 v[216:219], v[228:231], v[80:83], 0
    v_mul_f32 v140, v156, v124
    v_mul_f32 v141, v157, v125
    v_mfma_f32_16x16x32_bf16 v[220:223], v[228:231], v[84:87], 0
    v_mul_f32 v142, v158, v126
    v_mul_f32 v143, v159, v127
    v_mfma_f32_16x16x32_bf16 v[208:211], v[228:231], v[96:99], v[208:211]
    v_mul_f32 v144, v160, v120
    v_mul_f32 v145, v161, v121
    v_mfma_f32_16x16x32_bf16 v[212:215], v[228:231], v[100:103], v[212:215]
    v_mul_f32 v146, v162, v122
    v_mul_f32 v147, v163, v123
    v_mfma_f32_16x16x32_bf16 v[216:219], v[224:227], v[88:91], v[216:219]
    v_mul_f32 v148, v164, v124
    v_mul_f32 v149, v165, v125
    v_mfma_f32_16x16x32_bf16 v[220:223], v[224:227], v[92:95], v[220:223]
    v_mul_f32 v150, v166, v126
    v_mul_f32 v151, v167, v127
    v_fma_f32 v136, -v160, v128, v136
    v_fma_f32 v137, -v161, v129, v137
    v_fma_f32 v138, -v162, v130, v138
    v_fma_f32 v139, -v163, v131, v139
    v_fma_f32 v140, -v164, v132, v140
    v_fma_f32 v141, -v165, v133, v141
    v_fma_f32 v142, -v166, v134, v142
    v_fma_f32 v143, -v167, v135, v143
    v_fma_f32 v144, v152, v128, v144
    v_fma_f32 v145, v153, v129, v145
    v_fma_f32 v146, v154, v130, v146
    v_fma_f32 v147, v155, v131, v147
    v_fma_f32 v148, v156, v132, v148
    v_fma_f32 v149, v157, v133, v149
    v_fma_f32 v150, v158, v134, v150
    v_fma_f32 v151, v159, v135, v151
    v_cvt_pk_bf16_f32 v8, v136, v137
    v_cvt_pk_bf16_f32 v9, v138, v139
    v_cvt_pk_bf16_f32 v10, v140, v141
    v_cvt_pk_bf16_f32 v11, v142, v143
    v_cvt_pk_bf16_f32 v12, v144, v145
    v_cvt_pk_bf16_f32 v13, v146, v147
    v_cvt_pk_bf16_f32 v14, v148, v149
    v_cvt_pk_bf16_f32 v15, v150, v151
    ds_write_b64 v5, v[8:9] offset:0
    ds_write_b64 v5, v[12:13] offset:2048
    ds_write_b64 v5, v[10:11] offset:4096
    ds_write_b64 v5, v[14:15] offset:6144
    v_mul_f32 v136, v208, v120
    v_mul_f32 v137, v209, v121
    v_mul_f32 v138, v210, v122
    v_mul_f32 v139, v211, v123
    v_mul_f32 v140, v212, v124
    v_mul_f32 v141, v213, v125
    v_mul_f32 v142, v214, v126
    v_mul_f32 v143, v215, v127
    v_mul_f32 v144, v216, v120
    v_mul_f32 v145, v217, v121
    v_mul_f32 v146, v218, v122
    v_mul_f32 v147, v219, v123
    v_mul_f32 v148, v220, v124
    v_mul_f32 v149, v221, v125
    v_mul_f32 v150, v222, v126
    v_mul_f32 v151, v223, v127
    v_fma_f32 v136, -v216, v128, v136
    v_fma_f32 v137, -v217, v129, v137
    v_fma_f32 v138, -v218, v130, v138
    v_fma_f32 v139, -v219, v131, v139
    v_fma_f32 v140, -v220, v132, v140
    v_fma_f32 v141, -v221, v133, v141
    v_fma_f32 v142, -v222, v134, v142
    v_fma_f32 v143, -v223, v135, v143
    v_fma_f32 v144, v208, v128, v144
    v_fma_f32 v145, v209, v129, v145
    v_fma_f32 v146, v210, v130, v146
    v_fma_f32 v147, v211, v131, v147
    v_fma_f32 v148, v212, v132, v148
    v_fma_f32 v149, v213, v133, v149
    v_fma_f32 v150, v214, v134, v150
    v_fma_f32 v151, v215, v135, v151
    v_cvt_pk_bf16_f32 v224, v136, v137
    v_cvt_pk_bf16_f32 v225, v138, v139
    v_cvt_pk_bf16_f32 v226, v140, v141
    v_cvt_pk_bf16_f32 v227, v142, v143
    v_cvt_pk_bf16_f32 v228, v144, v145
    v_cvt_pk_bf16_f32 v229, v146, v147
    v_cvt_pk_bf16_f32 v230, v148, v149
    v_cvt_pk_bf16_f32 v231, v150, v151
    ds_write_b64 v5, v[224:225] offset:8192
    ds_write_b64 v5, v[228:229] offset:10240
    ds_write_b64 v5, v[226:227] offset:12288
    ds_write_b64 v5, v[230:231] offset:14336
    s_lshl_b32 s40, s3, 11
    v_and_b32 v6, 7, v3
    v_lshlrev_b32 v6, 7, v6
    v_lshrrev_b32 v7, 3, v3
    v_lshl_add_u32 v6, v7, 6, v6
    v_lshl_add_u32 v6, v2, 4, v6
    v_add_u32 v6, s40, v6
    s_add_u32 s38, s38, 2359296
    s_add_u32 s45, s45, 2359296
    s_waitcnt lgkmcnt(0)
    s_barrier
    ds_read_b128 v[16:19], v4 offset:0
    ds_read_b128 v[32:35], v4 offset:2048
    ds_read_b128 v[24:27], v4 offset:4096
    ds_read_b128 v[40:43], v4 offset:6144
    ds_read_b128 v[20:23], v4 offset:1024
    ds_read_b128 v[36:39], v4 offset:3072
    ds_read_b128 v[28:31], v4 offset:5120
    ds_read_b128 v[44:47], v4 offset:7168
    ds_read_b128 v[168:171], v4 offset:8192
    ds_read_b128 v[184:187], v4 offset:10240
    ds_read_b128 v[176:179], v4 offset:12288
    ds_read_b128 v[192:195], v4 offset:14336
    ds_read_b128 v[172:175], v4 offset:9216
    ds_read_b128 v[188:191], v4 offset:11264
    ds_read_b128 v[180:183], v4 offset:13312
    ds_read_b128 v[196:199], v4 offset:15360
    s_waitcnt lgkmcnt(0)
    v_mfma_f32_16x16x32_bf16 v[152:155], v[16:19], v[56:59], 0
    v_mfma_f32_16x16x32_bf16 v[156:159], v[24:27], v[56:59], 0
    v_mfma_f32_16x16x32_bf16 v[216:219], v[184:187], v[56:59], 0
    v_mfma_f32_16x16x32_bf16 v[220:223], v[192:195], v[56:59], 0
    v_mfma_f32_16x16x32_bf16 v[152:155], v[32:35], v[72:75], v[152:155]
    v_mfma_f32_16x16x32_bf16 v[156:159], v[40:43], v[72:75], v[156:159]
    v_mfma_f32_16x16x32_bf16 v[216:219], v[168:171], v[64:67], v[216:219]
    v_mfma_f32_16x16x32_bf16 v[220:223], v[176:179], v[64:67], v[220:223]
    v_mfma_f32_16x16x32_bf16 v[152:155], v[20:23], v[60:63], v[152:155]
    v_mfma_f32_16x16x32_bf16 v[156:159], v[28:31], v[60:63], v[156:159]
    v_mfma_f32_16x16x32_bf16 v[216:219], v[188:191], v[60:63], v[216:219]
    v_mfma_f32_16x16x32_bf16 v[220:223], v[196:199], v[60:63], v[220:223]
    v_mfma_f32_16x16x32_bf16 v[152:155], v[36:39], v[76:79], v[152:155]
    v_mfma_f32_16x16x32_bf16 v[156:159], v[44:47], v[76:79], v[156:159]
    v_mfma_f32_16x16x32_bf16 v[216:219], v[172:175], v[68:71], v[216:219]
    v_mfma_f32_16x16x32_bf16 v[220:223], v[180:183], v[68:71], v[220:223]
    s_cmp_eq_u32 s34, 143
    s_cbranch_scc1 L_special_19
    v_mfma_f32_16x16x32_bf16 v[208:211], v[168:171], v[56:59], 0
    s_nop 0
    s_nop 0
    v_mfma_f32_16x16x32_bf16 v[212:215], v[176:179], v[56:59], 0
    s_nop 0
    v_cvt_pk_bf16_f32 v8, v152, v153
    v_mfma_f32_16x16x32_bf16 v[160:163], v[32:35], v[56:59], 0
    v_cvt_pk_bf16_f32 v9, v154, v155
    v_cvt_pk_bf16_f32 v10, v156, v157
    v_mfma_f32_16x16x32_bf16 v[164:167], v[40:43], v[56:59], 0
    v_cvt_pk_bf16_f32 v11, v158, v159
    v_cvt_pk_bf16_f32 v228, v216, v217
    v_mfma_f32_16x16x32_bf16 v[208:211], v[184:187], v[72:75], v[208:211]
    v_cvt_pk_bf16_f32 v229, v218, v219
    v_cvt_pk_bf16_f32 v230, v220, v221
    v_mfma_f32_16x16x32_bf16 v[212:215], v[192:195], v[72:75], v[212:215]
    v_cvt_pk_bf16_f32 v231, v222, v223
    v_mov_b32 v136, v8
    v_mfma_f32_16x16x32_bf16 v[160:163], v[16:19], v[64:67], v[160:163]
    v_mov_b32 v137, v9
    v_mov_b32 v138, v10
    v_mfma_f32_16x16x32_bf16 v[164:167], v[24:27], v[64:67], v[164:167]
    v_mov_b32 v139, v11
    s_nop 0
    v_mfma_f32_16x16x32_bf16 v[208:211], v[172:175], v[60:63], v[208:211]
    v_mov_b32_dpp v8, v228 row_ror:8 row_mask:0xf bank_mask:0xc
    v_mov_b32_dpp v9, v229 row_ror:8 row_mask:0xf bank_mask:0xc
    v_mfma_f32_16x16x32_bf16 v[212:215], v[180:183], v[60:63], v[212:215]
    v_mov_b32_dpp v10, v230 row_ror:8 row_mask:0xf bank_mask:0xc
    v_mov_b32_dpp v11, v231 row_ror:8 row_mask:0xf bank_mask:0xc
    v_mfma_f32_16x16x32_bf16 v[160:163], v[36:39], v[60:63], v[160:163]
    v_mov_b32_dpp v228, v136 row_ror:8 row_mask:0xf bank_mask:0x3
    v_mov_b32_dpp v229, v137 row_ror:8 row_mask:0xf bank_mask:0x3
    v_mfma_f32_16x16x32_bf16 v[164:167], v[44:47], v[60:63], v[164:167]
    v_mov_b32_dpp v230, v138 row_ror:8 row_mask:0xf bank_mask:0x3
    v_mov_b32_dpp v231, v139 row_ror:8 row_mask:0xf bank_mask:0x3
    v_mfma_f32_16x16x32_bf16 v[208:211], v[188:191], v[76:79], v[208:211]
    buffer_store_dwordx4 v[8:11], v6, s[8:11], s38 offen sc1
    buffer_store_dwordx4 v[228:231], v6, s[8:11], s38 offen offset:1024 sc1
    v_mfma_f32_16x16x32_bf16 v[212:215], v[196:199], v[76:79], v[212:215]
    v_mfma_f32_16x16x32_bf16 v[160:163], v[20:23], v[68:71], v[160:163]
    v_mfma_f32_16x16x32_bf16 v[164:167], v[28:31], v[68:71], v[164:167]
    s_nop 7
    v_cvt_pk_bf16_f32 v224, v208, v209
    v_cvt_pk_bf16_f32 v225, v210, v211
    v_cvt_pk_bf16_f32 v226, v212, v213
    v_cvt_pk_bf16_f32 v227, v214, v215
    v_cvt_pk_bf16_f32 v12, v160, v161
    v_cvt_pk_bf16_f32 v13, v162, v163
    v_cvt_pk_bf16_f32 v14, v164, v165
    v_cvt_pk_bf16_f32 v15, v166, v167
    v_mov_b32 v136, v224
    v_mov_b32 v137, v225
    v_mov_b32 v138, v226
    v_mov_b32 v139, v227
    s_nop 0
    v_mov_b32_dpp v224, v12 row_ror:8 row_mask:0xf bank_mask:0xc
    v_mov_b32_dpp v225, v13 row_ror:8 row_mask:0xf bank_mask:0xc
    v_mov_b32_dpp v226, v14 row_ror:8 row_mask:0xf bank_mask:0xc
    v_mov_b32_dpp v227, v15 row_ror:8 row_mask:0xf bank_mask:0xc
    v_mov_b32_dpp v12, v136 row_ror:8 row_mask:0xf bank_mask:0x3
    v_mov_b32_dpp v13, v137 row_ror:8 row_mask:0xf bank_mask:0x3
    v_mov_b32_dpp v14, v138 row_ror:8 row_mask:0xf bank_mask:0x3
    v_mov_b32_dpp v15, v139 row_ror:8 row_mask:0xf bank_mask:0x3
    buffer_store_dwordx4 v[224:227], v6, s[8:11], s45 offen sc1
    buffer_store_dwordx4 v[12:15], v6, s[8:11], s45 offen offset:1024 sc1
    s_branch L_p2fin_20
L_special_19:
    v_mfma_f32_16x16x32_bf16 v[208:211], v[168:171], v[56:59], 0
    v_mfma_f32_16x16x32_bf16 v[212:215], v[176:179], v[56:59], 0
    v_mfma_f32_16x16x32_bf16 v[160:163], v[32:35], v[56:59], 0
    v_mfma_f32_16x16x32_bf16 v[164:167], v[40:43], v[56:59], 0
    v_mfma_f32_16x16x32_bf16 v[208:211], v[184:187], v[72:75], v[208:211]
    v_mfma_f32_16x16x32_bf16 v[212:215], v[192:195], v[72:75], v[212:215]
    v_mfma_f32_16x16x32_bf16 v[160:163], v[16:19], v[64:67], v[160:163]
    v_mfma_f32_16x16x32_bf16 v[164:167], v[24:27], v[64:67], v[164:167]
    v_mfma_f32_16x16x32_bf16 v[208:211], v[172:175], v[60:63], v[208:211]
    v_mfma_f32_16x16x32_bf16 v[212:215], v[180:183], v[60:63], v[212:215]
    v_mfma_f32_16x16x32_bf16 v[160:163], v[36:39], v[60:63], v[160:163]
    v_mfma_f32_16x16x32_bf16 v[164:167], v[44:47], v[60:63], v[164:167]
    v_mfma_f32_16x16x32_bf16 v[208:211], v[188:191], v[76:79], v[208:211]
    v_mfma_f32_16x16x32_bf16 v[212:215], v[196:199], v[76:79], v[212:215]
    v_mfma_f32_16x16x32_bf16 v[160:163], v[20:23], v[68:71], v[160:163]
    v_mfma_f32_16x16x32_bf16 v[164:167], v[28:31], v[68:71], v[164:167]
    s_nop 7
    v_cvt_pk_bf16_f32 v8, v152, v153
    v_cvt_pk_bf16_f32 v9, v154, v155
    v_cvt_pk_bf16_f32 v10, v156, v157
    v_cvt_pk_bf16_f32 v11, v158, v159
    v_cvt_pk_bf16_f32 v12, v160, v161
    v_cvt_pk_bf16_f32 v13, v162, v163
    v_cvt_pk_bf16_f32 v14, v164, v165
    v_cvt_pk_bf16_f32 v15, v166, v167
    v_cvt_pk_bf16_f32 v228, v208, v209
    v_cvt_pk_bf16_f32 v229, v210, v211
    v_cvt_pk_bf16_f32 v230, v212, v213
    v_cvt_pk_bf16_f32 v231, v214, v215
    v_mov_b32 v224, 0
    v_mov_b32 v225, 0
    v_mov_b32 v226, 0
    v_mov_b32 v227, 0
    v_mov_b32 v136, v8
    v_mov_b32 v137, v9
    v_mov_b32 v138, v10
    v_mov_b32 v139, v11
    s_nop 0
    v_mov_b32_dpp v8, v12 row_ror:8 row_mask:0xf bank_mask:0xc
    v_mov_b32_dpp v9, v13 row_ror:8 row_mask:0xf bank_mask:0xc
    v_mov_b32_dpp v10, v14 row_ror:8 row_mask:0xf bank_mask:0xc
    v_mov_b32_dpp v11, v15 row_ror:8 row_mask:0xf bank_mask:0xc
    v_mov_b32_dpp v12, v136 row_ror:8 row_mask:0xf bank_mask:0x3
    v_mov_b32_dpp v13, v137 row_ror:8 row_mask:0xf bank_mask:0x3
    v_mov_b32_dpp v14, v138 row_ror:8 row_mask:0xf bank_mask:0x3
    v_mov_b32_dpp v15, v139 row_ror:8 row_mask:0xf bank_mask:0x3
    buffer_store_dwordx4 v[8:11], v6, s[8:11], s38 offen sc1
    buffer_store_dwordx4 v[12:15], v6, s[8:11], s38 offen offset:1024 sc1
    v_mov_b32 v136, v224
    v_mov_b32 v137, v225
    v_mov_b32 v138, v226
    v_mov_b32 v139, v227
    s_nop 0
    v_mov_b32_dpp v224, v228 row_ror:8 row_mask:0xf bank_mask:0xc
    v_mov_b32_dpp v225, v229 row_ror:8 row_mask:0xf bank_mask:0xc
    v_mov_b32_dpp v226, v230 row_ror:8 row_mask:0xf bank_mask:0xc
    v_mov_b32_dpp v227, v231 row_ror:8 row_mask:0xf bank_mask:0xc
    v_mov_b32_dpp v228, v136 row_ror:8 row_mask:0xf bank_mask:0x3
    v_mov_b32_dpp v229, v137 row_ror:8 row_mask:0xf bank_mask:0x3
    v_mov_b32_dpp v230, v138 row_ror:8 row_mask:0xf bank_mask:0x3
    v_mov_b32_dpp v231, v139 row_ror:8 row_mask:0xf bank_mask:0x3
    buffer_store_dwordx4 v[224:227], v6, s[8:11], s45 offen sc1
    buffer_store_dwordx4 v[228:231], v6, s[8:11], s45 offen offset:1024 sc1
L_p2fin_20:
    s_branch L_join_17
L_pack_16:
    s_sub_u32 s56, s30, 18
    s_lshl_b32 s56, s56, 3
    s_add_u32 s56, s56, s31
    s_cmp_lt_u32 s3, 3
    s_cselect_b32 s57, 1, 0
    s_cmp_ge_u32 s56, 108
    s_cselect_b32 s57, 0, s57
    v_lshrrev_b32 v236, 3, v1
    v_and_b32 v237, 7, v1
    v_lshrrev_b32 v238, 2, v3
    s_waitcnt lgkmcnt(0)
    s_mov_b32 s8, s4
    s_and_b32 s9, s5, 0xffff
    s_mov_b32 s10, 268435456
    s_mov_b32 s11, 0x00020000
    s_cmp_eq_u32 s57, 0
    s_cbranch_scc1 L_join_17
    s_mul_i32 s42, s3, 24576
    s_add_u32 s42, s42, 36864
    s_mov_b32 s14, 5308416
    s_mov_b32 s15, 0x00020000
    s_lshl_b32 s34, s3, 1
    s_add_u32 s34, s34, 0
    s_cmp_ge_u32 s34, 3
    s_cselect_b32 s35, 1, 0
    s_cselect_b32 s36, 3, 0
    s_sub_u32 s44, s34, s36
    s_lshl_b32 s34, s56, 1
    s_add_u32 s34, s34, s35
    s_mul_hi_u32 s59, s34, 159072863
    s_mul_i32 s40, s59, 27
    s_sub_u32 s43, s34, s40
    s_cmp_ge_u32 s43, 9
    s_cselect_b32 s12, s20, s18
    s_cselect_b32 s13, s21, s19
    s_mov_b32 s33, 9216
    s_cselect_b32 s33, 1152, s33
    s_cselect_b32 s37, 4, 8
    s_cselect_b32 s38, 16, 4
    s_cselect_b32 s39, 136, 8
    s_cselect_b32 s36, -9, 9
    s_mov_b32 s50, 35389440
    s_cselect_b32 s50, 40697856, s50
    s_cselect_b32 s47, 1, 0
    s_and_b32 s13, s13, 0xffff
    s_add_u32 s43, s43, s36
    s_mul_i32 s40, s59, 663552
    s_add_u32 s50, s50, s40
    s_lshl_b32 s40, s43, 10
    s_add_u32 s50, s50, s40
    s_mul_i32 s40, s44, 221184
    s_add_u32 s50, s50, s40
    s_and_b32 s40, s43, 1
    s_mul_i32 s40, s40, 288
    s_lshr_b32 s46, s43, 1
    s_lshl_b32 s46, s46, 4
    s_add_u32 s40, s40, s46
    s_mul_i32 s46, s59, 576
    s_add_u32 s40, s40, s46
    s_mul_i32 s40, s40, 1152
    s_mul_i32 s46, s43, 294912
    s_mul_i32 s48, s59, 1152
    s_add_u32 s46, s46, s48
    s_cmp_eq_u32 s47, 1
    s_cselect_b32 s40, s40, s46
    s_mul_i32 s46, s44, 384
    s_add_u32 s40, s40, s46
    v_mul_lo_u32 v235, v236, s33
    v_lshl_add_u32 v235, v237, 4, v235
    s_lshl_b32 s41, s33, 3
    s_mul_i32 s39, s39, s33
    v_mul_lo_u32 v240, v2, s37
    v_add_u32 v240, v240, v238
    v_lshlrev_b32 v240, 7, v240
    v_and_b32 v241, 3, v3
    v_lshl_add_u32 v240, v241, 3, v240
    v_add_u32 v240, s42, v240
    s_lshl_b32 s43, s38, 7
    v_add_u32 v241, s43, v240
    s_add_u32 m0, s42, 0
    s_nop 0
    buffer_load_dwordx4 v235, s[12:15], s40 offen offset:0 nt lds
    s_add_u32 m0, s42, 3968
    s_nop 0
    buffer_load_dwordx4 v235, s[12:15], s40 offen offset:128 nt lds
    s_add_u32 m0, s42, 7936
    s_nop 0
    buffer_load_dwordx4 v235, s[12:15], s40 offen offset:256 nt lds
    s_add_u32 m0, s42, 1024
    s_add_u32 s40, s40, s41
    buffer_load_dwordx4 v235, s[12:15], s40 offen offset:0 nt lds
    s_add_u32 m0, s42, 4992
    s_nop 0
    buffer_load_dwordx4 v235, s[12:15], s40 offen offset:128 nt lds
    s_add_u32 m0, s42, 8960
    s_nop 0
    buffer_load_dwordx4 v235, s[12:15], s40 offen offset:256 nt lds
    s_add_u32 m0, s42, 2048
    s_add_u32 s40, s40, s39
    buffer_load_dwordx4 v235, s[12:15], s40 offen offset:0 nt lds
    s_add_u32 m0, s42, 6016
    s_nop 0
    buffer_load_dwordx4 v235, s[12:15], s40 offen offset:128 nt lds
    s_add_u32 m0, s42, 9984
    s_nop 0
    buffer_load_dwordx4 v235, s[12:15], s40 offen offset:256 nt lds
    s_add_u32 m0, s42, 3072
    s_add_u32 s40, s40, s41
    buffer_load_dwordx4 v235, s[12:15], s40 offen offset:0 nt lds
    s_add_u32 m0, s42, 7040
    s_nop 0
    buffer_load_dwordx4 v235, s[12:15], s40 offen offset:128 nt lds
    s_add_u32 m0, s42, 11008
    s_nop 0
    buffer_load_dwordx4 v235, s[12:15], s40 offen offset:256 nt lds
    s_lshl_b32 s34, s3, 1
    s_add_u32 s34, s34, 1
    s_cmp_ge_u32 s34, 3
    s_cselect_b32 s35, 1, 0
    s_cselect_b32 s36, 3, 0
    s_sub_u32 s44, s34, s36
    s_lshl_b32 s34, s56, 1
    s_add_u32 s34, s34, s35
    s_mul_hi_u32 s59, s34, 159072863
    s_mul_i32 s40, s59, 27
    s_sub_u32 s43, s34, s40
    s_cmp_ge_u32 s43, 9
    s_cselect_b32 s12, s20, s18
    s_cselect_b32 s13, s21, s19
    s_mov_b32 s33, 9216
    s_cselect_b32 s33, 1152, s33
    s_cselect_b32 s37, 4, 8
    s_cselect_b32 s38, 16, 4
    s_cselect_b32 s39, 136, 8
    s_cselect_b32 s36, -9, 9
    s_mov_b32 s51, 35389440
    s_cselect_b32 s51, 40697856, s51
    s_cselect_b32 s47, 1, 0
    s_and_b32 s13, s13, 0xffff
    s_add_u32 s43, s43, s36
    s_mul_i32 s40, s59, 663552
    s_add_u32 s51, s51, s40
    s_lshl_b32 s40, s43, 10
    s_add_u32 s51, s51, s40
    s_mul_i32 s40, s44, 221184
    s_add_u32 s51, s51, s40
    s_and_b32 s40, s43, 1
    s_mul_i32 s40, s40, 288
    s_lshr_b32 s46, s43, 1
    s_lshl_b32 s46, s46, 4
    s_add_u32 s40, s40, s46
    s_mul_i32 s46, s59, 576
    s_add_u32 s40, s40, s46
    s_mul_i32 s40, s40, 1152
    s_mul_i32 s46, s43, 294912
    s_mul_i32 s48, s59, 1152
    s_add_u32 s46, s46, s48
    s_cmp_eq_u32 s47, 1
    s_cselect_b32 s40, s40, s46
    s_mul_i32 s46, s44, 384
    s_add_u32 s40, s40, s46
    v_mul_lo_u32 v235, v236, s33
    v_lshl_add_u32 v235, v237, 4, v235
    s_lshl_b32 s41, s33, 3
    s_mul_i32 s39, s39, s33
    v_mul_lo_u32 v242, v2, s37
    v_add_u32 v242, v242, v238
    v_lshlrev_b32 v242, 7, v242
    v_and_b32 v243, 3, v3
    v_lshl_add_u32 v242, v243, 3, v242
    v_add_u32 v242, s42, v242
    s_lshl_b32 s43, s38, 7
    v_add_u32 v243, s43, v242
    s_add_u32 m0, s42, 12288
    s_nop 0
    buffer_load_dwordx4 v235, s[12:15], s40 offen offset:0 nt lds
    s_add_u32 m0, s42, 16256
    s_nop 0
    buffer_load_dwordx4 v235, s[12:15], s40 offen offset:128 nt lds
    s_add_u32 m0, s42, 20224
    s_nop 0
    buffer_load_dwordx4 v235, s[12:15], s40 offen offset:256 nt lds
    s_add_u32 m0, s42, 13312
    s_add_u32 s40, s40, s41
    buffer_load_dwordx4 v235, s[12:15], s40 offen offset:0 nt lds
    s_add_u32 m0, s42, 17280
    s_nop 0
    buffer_load_dwordx4 v235, s[12:15], s40 offen offset:128 nt lds
    s_add_u32 m0, s42, 21248
    s_nop 0
    buffer_load_dwordx4 v235, s[12:15], s40 offen offset:256 nt lds
    s_add_u32 m0, s42, 14336
    s_add_u32 s40, s40, s39
    buffer_load_dwordx4 v235, s[12:15], s40 offen offset:0 nt lds
    s_add_u32 m0, s42, 18304
    s_nop 0
    buffer_load_dwordx4 v235, s[12:15], s40 offen offset:128 nt lds
    s_add_u32 m0, s42, 22272
    s_nop 0
    buffer_load_dwordx4 v235, s[12:15], s40 offen offset:256 nt lds
    s_add_u32 m0, s42, 15360
    s_add_u32 s40, s40, s41
    buffer_load_dwordx4 v235, s[12:15], s40 offen offset:0 nt lds
    s_add_u32 m0, s42, 19328
    s_nop 0
    buffer_load_dwordx4 v235, s[12:15], s40 offen offset:128 nt lds
    s_add_u32 m0, s42, 23296
    s_nop 0
    buffer_load_dwordx4 v235, s[12:15], s40 offen offset:256 nt lds
L_join_17:
    s_mov_b32 s12, s6
    s_and_b32 s13, s7, 0xffff
    s_mov_b32 s14, 2359296
    s_mov_b32 s15, 0x00020000
    v_lshrrev_b32 v6, 3, v1
    v_and_b32 v7, 2, v6
    v_lshlrev_b32 v6, 13, v6
    v_and_b32 v5, 7, v1
    v_xor_b32 v7, v7, v5
    v_lshl_add_u32 v6, v7, 4, v6
    s_and_b32 s34, s3, 1
    s_lshl_b32 s34, s34, 6
    v_xor_b32 v253, s34, v6
    s_lshl_b32 s32, s3, 10
    s_lshl_b32 s33, s3, 16
    s_lshl_b32 s34, s25, 7
    s_add_u32 s33, s33, s34
    s_add_u32 s33, s33, 2359296
    v_bfe_u32 v5, v3, 2, 1
    v_lshlrev_b32 v5, 4, v5
    v_lshrrev_b32 v7, 3, v3
    v_lshl_add_u32 v5, v7, 2, v5
    v_and_b32 v7, 3, v3
    v_add_u32 v5, v5, v7
    s_lshl_b32 s34, s25, 5
    v_add_u32 v12, s34, v5
    v_mul_u32_u24 v96, 1152, v12
    v_lshl_add_u32 v96, v2, 3, v96
    v_add_u32 v97, 9216, v96
    v_lshrrev_b32 v5, 2, v5
    v_lshlrev_b32 v98, 7, v5
    v_lshl_add_u32 v98, v7, 4, v98
    s_lshr_b32 s38, s25, 5
    s_lshl_b32 s38, s38, 12
    s_bfe_u32 s34, s25, 0x20002
    s_lshl_b32 s34, s34, 10
    s_add_u32 s38, s38, s34
    s_bfe_u32 s34, s25, 0x10004
    s_lshl_b32 s34, s34, 6
    s_add_u32 s38, s38, s34
    s_and_b32 s34, s25, 3
    s_lshl_b32 s34, s34, 2
    s_add_u32 s38, s38, s34
    s_add_u32 s38, s38, 47351808
    s_lshl_b32 s37, s27, 5
    s_mul_i32 s30, s28, 36
    s_mul_i32 s31, s3, 9
    s_add_u32 s30, s30, s31
    s_mul_i32 s30, s30, 18432
    s_add_u32 s31, s30, 40697856
    s_add_u32 s30, s30, 35389440
    v_add_u32 v10, 18432, v4
    v_add_u32 v11, 36864, v4
    s_lshr_b32 s46, s3, 1
    s_mul_i32 s46, s46, 18432
    s_and_b32 s47, s3, 1
    s_lshl_b32 s47, s47, 10
    s_add_u32 s59, s46, s47
    s_mul_i32 s53, s25, 36864
    s_add_u32 s53, s53, s59
    s_cmp_lg_u32 s56, 255
    s_cbranch_scc1 L_sigdone_23
    s_waitcnt vmcnt(0)
    s_barrier
    s_cmp_lg_u32 s3, 3
    s_cbranch_scc1 L_sigdone_23
    s_lshl_b32 s46, s58, 4
    s_add_u32 s46, s46, 47672320
    v_mov_b32 v250, 1
    v_mul_u32_u24 v251, 2304, v1
    s_mov_b32 exec_hi, 0
    s_mov_b32 exec_lo, 0xf
    buffer_store_dword v250, v251, s[8:11], s46 offen sc1
    s_mov_b64 exec, -1
L_sigdone_23:
    s_cmp_eq_u32 s3, 3
    s_cbranch_scc1 L_w3_21
    s_mul_i32 s36, s27, 18432
    s_lshl_b32 s17, s27, 4
    v_add_u32 v32, s17, v3
    v_cvt_f32_u32 v32, v32
    v_lshlrev_b32 v38, 3, v2
    v_cvt_f32_u32 v38, v38
    v_mov_b32 v36, 0x3e000000
    v_mul_f32 v33, 0x3ae38e39, v32
    v_mul_f32 v34, 0x3d638e39, v32
    v_mul_f32 v35, v32, v38
    v_floor_f32 v34, v34
    v_cos_f32 v33, v33
    v_fmamk_f32 v34, v34, 0xc1900000, v32
    v_mul_f32 v34, 0x3d638e39, v34
    v_fmamk_f32 v16, v32, 0x00000000, v35
    v_fmamk_f32 v17, v32, 0x3f800000, v35
    v_fmamk_f32 v24, v32, 0x42000000, v35
    v_fmamk_f32 v25, v32, 0x42040000, v35
    v_cos_f32 v34, v34
    v_mul_f32 v18, 0x3ae38e39, v16
    v_mul_f32 v19, 0x3ae38e39, v17
    v_mul_f32 v26, 0x3ae38e39, v24
    v_mul_f32 v27, 0x3ae38e39, v25
    v_add_f32 v33, v33, v33
    v_floor_f32 v18, v18
    v_floor_f32 v19, v19
    v_floor_f32 v26, v26
    v_floor_f32 v27, v27
    v_add_f32 v34, v34, v34
    v_fmamk_f32 v16, v18, 0xc4100000, v16
    v_fmamk_f32 v17, v19, 0xc4100000, v17
    v_fmamk_f32 v24, v26, 0xc4100000, v24
    v_fmamk_f32 v25, v27, 0xc4100000, v25
    v_fmamk_f32 v16, v16, 0x3ae38e39, v36
    v_fmamk_f32 v17, v17, 0x3ae38e39, v36
    v_fmamk_f32 v24, v24, 0x3ae38e39, v36
    v_fmamk_f32 v25, v25, 0x3ae38e39, v36
    v_sin_f32 v16, v16
    v_sin_f32 v17, v17
    v_sin_f32 v24, v24
    v_sin_f32 v25, v25
    s_nop 0
    v_fma_f32 v18, v33, v17, -v16
    v_fma_f32 v26, v33, v25, -v24
    v_fma_f32 v19, v33, v18, -v17
    v_fma_f32 v27, v33, v26, -v25
    v_fma_f32 v20, v33, v19, -v18
    v_fma_f32 v28, v33, v27, -v26
    v_fma_f32 v21, v33, v20, -v19
    v_fma_f32 v29, v33, v28, -v27
    v_fma_f32 v22, v33, v21, -v20
    v_fma_f32 v30, v33, v29, -v28
    v_fma_f32 v23, v33, v22, -v21
    v_fma_f32 v31, v33, v30, -v29
    v_cvt_pk_bf16_f32 v104, v16, v17
    v_cvt_pk_bf16_f32 v105, v18, v19
    v_cvt_pk_bf16_f32 v106, v20, v21
    v_cvt_pk_bf16_f32 v107, v22, v23
    v_cvt_pk_bf16_f32 v116, v24, v25
    v_cvt_pk_bf16_f32 v117, v26, v27
    v_cvt_pk_bf16_f32 v118, v28, v29
    v_cvt_pk_bf16_f32 v119, v30, v31
    v_fma_f32 v16, v34, v24, -v16
    v_fma_f32 v17, v34, v25, -v17
    v_fma_f32 v18, v34, v26, -v18
    v_fma_f32 v19, v34, v27, -v19
    v_fma_f32 v20, v34, v28, -v20
    v_fma_f32 v21, v34, v29, -v21
    v_fma_f32 v22, v34, v30, -v22
    v_fma_f32 v23, v34, v31, -v23
    v_cvt_pk_bf16_f32 v128, v16, v17
    v_cvt_pk_bf16_f32 v129, v18, v19
    v_cvt_pk_bf16_f32 v130, v20, v21
    v_cvt_pk_bf16_f32 v131, v22, v23
    v_fma_f32 v24, v34, v16, -v24
    v_fma_f32 v25, v34, v17, -v25
    v_fma_f32 v26, v34, v18, -v26
    v_fma_f32 v27, v34, v19, -v27
    v_fma_f32 v28, v34, v20, -v28
    v_fma_f32 v29, v34, v21, -v29
    v_fma_f32 v30, v34, v22, -v30
    v_fma_f32 v31, v34, v23, -v31
    v_cvt_pk_bf16_f32 v140, v24, v25
    v_cvt_pk_bf16_f32 v141, v26, v27
    v_cvt_pk_bf16_f32 v142, v28, v29
    v_cvt_pk_bf16_f32 v143, v30, v31
    v_fma_f32 v16, v34, v24, -v16
    v_fma_f32 v17, v34, v25, -v17
    v_fma_f32 v18, v34, v26, -v18
    v_fma_f32 v19, v34, v27, -v19
    v_fma_f32 v20, v34, v28, -v20
    v_fma_f32 v21, v34, v29, -v21
    v_fma_f32 v22, v34, v30, -v22
    v_fma_f32 v23, v34, v31, -v23
    v_cvt_pk_bf16_f32 v152, v16, v17
    v_cvt_pk_bf16_f32 v153, v18, v19
    v_cvt_pk_bf16_f32 v154, v20, v21
    v_cvt_pk_bf16_f32 v155, v22, v23
    v_fma_f32 v24, v34, v16, -v24
    v_fma_f32 v25, v34, v17, -v25
    v_fma_f32 v26, v34, v18, -v26
    v_fma_f32 v27, v34, v19, -v27
    v_fma_f32 v28, v34, v20, -v28
    v_fma_f32 v29, v34, v21, -v29
    v_fma_f32 v30, v34, v22, -v30
    v_fma_f32 v31, v34, v23, -v31
    v_cvt_pk_bf16_f32 v164, v24, v25
    v_cvt_pk_bf16_f32 v165, v26, v27
    v_cvt_pk_bf16_f32 v166, v28, v29
    v_cvt_pk_bf16_f32 v167, v30, v31
    v_fma_f32 v16, v34, v24, -v16
    v_fma_f32 v17, v34, v25, -v17
    v_fma_f32 v18, v34, v26, -v18
    v_fma_f32 v19, v34, v27, -v19
    v_fma_f32 v20, v34, v28, -v20
    v_fma_f32 v21, v34, v29, -v21
    v_fma_f32 v22, v34, v30, -v22
    v_fma_f32 v23, v34, v31, -v23
    v_cvt_pk_bf16_f32 v176, v16, v17
    v_cvt_pk_bf16_f32 v177, v18, v19
    v_cvt_pk_bf16_f32 v178, v20, v21
    v_cvt_pk_bf16_f32 v179, v22, v23
    v_fma_f32 v24, v34, v16, -v24
    v_fma_f32 v25, v34, v17, -v25
    v_fma_f32 v26, v34, v18, -v26
    v_fma_f32 v27, v34, v19, -v27
    v_fma_f32 v28, v34, v20, -v28
    v_fma_f32 v29, v34, v21, -v29
    v_fma_f32 v30, v34, v22, -v30
    v_fma_f32 v31, v34, v23, -v31
    v_cvt_pk_bf16_f32 v188, v24, v25
    v_cvt_pk_bf16_f32 v189, v26, v27
    v_cvt_pk_bf16_f32 v190, v28, v29
    v_cvt_pk_bf16_f32 v191, v30, v31
    v_fma_f32 v16, v34, v24, -v16
    v_fma_f32 v17, v34, v25, -v17
    v_fma_f32 v18, v34, v26, -v18
    v_fma_f32 v19, v34, v27, -v19
    v_fma_f32 v20, v34, v28, -v20
    v_fma_f32 v21, v34, v29, -v21
    v_fma_f32 v22, v34, v30, -v22
    v_fma_f32 v23, v34, v31, -v23
    v_cvt_pk_bf16_f32 v200, v16, v17
    v_cvt_pk_bf16_f32 v201, v18, v19
    v_cvt_pk_bf16_f32 v202, v20, v21
    v_cvt_pk_bf16_f32 v203, v22, v23
    v_add_f32 v32, 0x41800000, v32
    v_mul_f32 v33, 0x3ae38e39, v32
    v_mul_f32 v34, 0x3d638e39, v32
    v_mul_f32 v35, v32, v38
    v_floor_f32 v34, v34
    v_cos_f32 v33, v33
    v_fmamk_f32 v34, v34, 0xc1900000, v32
    v_mul_f32 v34, 0x3d638e39, v34
    v_fmamk_f32 v16, v32, 0x00000000, v35
    v_fmamk_f32 v17, v32, 0x3f800000, v35
    v_fmamk_f32 v24, v32, 0x42000000, v35
    v_fmamk_f32 v25, v32, 0x42040000, v35
    v_cos_f32 v34, v34
    v_mul_f32 v18, 0x3ae38e39, v16
    v_mul_f32 v19, 0x3ae38e39, v17
    v_mul_f32 v26, 0x3ae38e39, v24
    v_mul_f32 v27, 0x3ae38e39, v25
    v_add_f32 v33, v33, v33
    v_floor_f32 v18, v18
    v_floor_f32 v19, v19
    v_floor_f32 v26, v26
    v_floor_f32 v27, v27
    v_add_f32 v34, v34, v34
    v_fmamk_f32 v16, v18, 0xc4100000, v16
    v_fmamk_f32 v17, v19, 0xc4100000, v17
    v_fmamk_f32 v24, v26, 0xc4100000, v24
    v_fmamk_f32 v25, v27, 0xc4100000, v25
    v_fmamk_f32 v16, v16, 0x3ae38e39, v36
    v_fmamk_f32 v17, v17, 0x3ae38e39, v36
    v_fmamk_f32 v24, v24, 0x3ae38e39, v36
    v_fmamk_f32 v25, v25, 0x3ae38e39, v36
    v_sin_f32 v16, v16
    v_sin_f32 v17, v17
    v_sin_f32 v24, v24
    v_sin_f32 v25, v25
    s_nop 0
    v_fma_f32 v18, v33, v17, -v16
    v_fma_f32 v26, v33, v25, -v24
    v_fma_f32 v19, v33, v18, -v17
    v_fma_f32 v27, v33, v26, -v25
    v_fma_f32 v20, v33, v19, -v18
    v_fma_f32 v28, v33, v27, -v26
    v_fma_f32 v21, v33, v20, -v19
    v_fma_f32 v29, v33, v28, -v27
    v_fma_f32 v22, v33, v21, -v20
    v_fma_f32 v30, v33, v29, -v28
    v_fma_f32 v23, v33, v22, -v21
    v_fma_f32 v31, v33, v30, -v29
    v_cvt_pk_bf16_f32 v108, v16, v17
    v_cvt_pk_bf16_f32 v109, v18, v19
    v_cvt_pk_bf16_f32 v110, v20, v21
    v_cvt_pk_bf16_f32 v111, v22, v23
    v_cvt_pk_bf16_f32 v120, v24, v25
    v_cvt_pk_bf16_f32 v121, v26, v27
    v_cvt_pk_bf16_f32 v122, v28, v29
    v_cvt_pk_bf16_f32 v123, v30, v31
    v_fma_f32 v16, v34, v24, -v16
    v_fma_f32 v17, v34, v25, -v17
    v_fma_f32 v18, v34, v26, -v18
    v_fma_f32 v19, v34, v27, -v19
    v_fma_f32 v20, v34, v28, -v20
    v_fma_f32 v21, v34, v29, -v21
    v_fma_f32 v22, v34, v30, -v22
    v_fma_f32 v23, v34, v31, -v23
    v_cvt_pk_bf16_f32 v132, v16, v17
    v_cvt_pk_bf16_f32 v133, v18, v19
    v_cvt_pk_bf16_f32 v134, v20, v21
    v_cvt_pk_bf16_f32 v135, v22, v23
    v_fma_f32 v24, v34, v16, -v24
    v_fma_f32 v25, v34, v17, -v25
    v_fma_f32 v26, v34, v18, -v26
    v_fma_f32 v27, v34, v19, -v27
    v_fma_f32 v28, v34, v20, -v28
    v_fma_f32 v29, v34, v21, -v29
    v_fma_f32 v30, v34, v22, -v30
    v_fma_f32 v31, v34, v23, -v31
    v_cvt_pk_bf16_f32 v144, v24, v25
    v_cvt_pk_bf16_f32 v145, v26, v27
    v_cvt_pk_bf16_f32 v146, v28, v29
    v_cvt_pk_bf16_f32 v147, v30, v31
    v_fma_f32 v16, v34, v24, -v16
    v_fma_f32 v17, v34, v25, -v17
    v_fma_f32 v18, v34, v26, -v18
    v_fma_f32 v19, v34, v27, -v19
    v_fma_f32 v20, v34, v28, -v20
    v_fma_f32 v21, v34, v29, -v21
    v_fma_f32 v22, v34, v30, -v22
    v_fma_f32 v23, v34, v31, -v23
    v_cvt_pk_bf16_f32 v156, v16, v17
    v_cvt_pk_bf16_f32 v157, v18, v19
    v_cvt_pk_bf16_f32 v158, v20, v21
    v_cvt_pk_bf16_f32 v159, v22, v23
    buffer_load_dwordx2 v[212:213], v96, s[12:15], s37 offen offset:0
    buffer_load_dwordx2 v[214:215], v97, s[12:15], s37 offen offset:0
    buffer_load_dwordx2 v[216:217], v96, s[12:15], s37 offen offset:32
    buffer_load_dwordx2 v[218:219], v97, s[12:15], s37 offen offset:32
    buffer_load_dwordx2 v[220:221], v96, s[12:15], s37 offen offset:64
    buffer_load_dwordx2 v[222:223], v97, s[12:15], s37 offen offset:64
    buffer_load_dword v14, v98, s[8:11], s38 offen
    buffer_load_dword v15, v98, s[8:11], s38 offen offset:256
    v_fma_f32 v24, v34, v16, -v24
    v_fma_f32 v25, v34, v17, -v25
    v_fma_f32 v26, v34, v18, -v26
    v_fma_f32 v27, v34, v19, -v27
    v_fma_f32 v28, v34, v20, -v28
    v_fma_f32 v29, v34, v21, -v29
    v_fma_f32 v30, v34, v22, -v30
    v_fma_f32 v31, v34, v23, -v31
    v_cvt_pk_bf16_f32 v168, v24, v25
    v_cvt_pk_bf16_f32 v169, v26, v27
    v_cvt_pk_bf16_f32 v170, v28, v29
    v_cvt_pk_bf16_f32 v171, v30, v31
    v_fma_f32 v16, v34, v24, -v16
    v_fma_f32 v17, v34, v25, -v17
    v_fma_f32 v18, v34, v26, -v18
    v_fma_f32 v19, v34, v27, -v19
    v_fma_f32 v20, v34, v28, -v20
    v_fma_f32 v21, v34, v29, -v21
    v_fma_f32 v22, v34, v30, -v22
    v_fma_f32 v23, v34, v31, -v23
    v_cvt_pk_bf16_f32 v180, v16, v17
    v_cvt_pk_bf16_f32 v181, v18, v19
    v_cvt_pk_bf16_f32 v182, v20, v21
    v_cvt_pk_bf16_f32 v183, v22, v23
    v_fma_f32 v24, v34, v16, -v24
    v_fma_f32 v25, v34, v17, -v25
    v_fma_f32 v26, v34, v18, -v26
    v_fma_f32 v27, v34, v19, -v27
    v_fma_f32 v28, v34, v20, -v28
    v_fma_f32 v29, v34, v21, -v29
    v_fma_f32 v30, v34, v22, -v30
    v_fma_f32 v31, v34, v23, -v31
    v_cvt_pk_bf16_f32 v192, v24, v25
    v_cvt_pk_bf16_f32 v193, v26, v27
    v_cvt_pk_bf16_f32 v194, v28, v29
    v_cvt_pk_bf16_f32 v195, v30, v31
    v_fma_f32 v16, v34, v24, -v16
    v_fma_f32 v17, v34, v25, -v17
    v_fma_f32 v18, v34, v26, -v18
    v_fma_f32 v19, v34, v27, -v19
    v_fma_f32 v20, v34, v28, -v20
    v_fma_f32 v21, v34, v29, -v21
    v_fma_f32 v22, v34, v30, -v22
    v_fma_f32 v23, v34, v31, -v23
    v_cvt_pk_bf16_f32 v204, v16, v17
    v_cvt_pk_bf16_f32 v205, v18, v19
    v_cvt_pk_bf16_f32 v206, v20, v21
    v_cvt_pk_bf16_f32 v207, v22, v23
    v_add_f32 v32, 0x41800000, v32
    v_mul_f32 v33, 0x3ae38e39, v32
    v_mul_f32 v34, 0x3d638e39, v32
    v_mul_f32 v35, v32, v38
    v_floor_f32 v34, v34
    v_cos_f32 v33, v33
    v_fmamk_f32 v34, v34, 0xc1900000, v32
    v_mul_f32 v34, 0x3d638e39, v34
    v_fmamk_f32 v16, v32, 0x00000000, v35
    v_fmamk_f32 v17, v32, 0x3f800000, v35
    v_fmamk_f32 v24, v32, 0x42000000, v35
    v_fmamk_f32 v25, v32, 0x42040000, v35
    v_cos_f32 v34, v34
    v_mul_f32 v18, 0x3ae38e39, v16
    v_mul_f32 v19, 0x3ae38e39, v17
    v_mul_f32 v26, 0x3ae38e39, v24
    v_mul_f32 v27, 0x3ae38e39, v25
    v_add_f32 v33, v33, v33
    v_floor_f32 v18, v18
    v_floor_f32 v19, v19
    v_floor_f32 v26, v26
    v_floor_f32 v27, v27
    v_add_f32 v34, v34, v34
    v_fmamk_f32 v16, v18, 0xc4100000, v16
    v_fmamk_f32 v17, v19, 0xc4100000, v17
    v_fmamk_f32 v24, v26, 0xc4100000, v24
    v_fmamk_f32 v25, v27, 0xc4100000, v25
    v_fmamk_f32 v16, v16, 0x3ae38e39, v36
    v_fmamk_f32 v17, v17, 0x3ae38e39, v36
    v_fmamk_f32 v24, v24, 0x3ae38e39, v36
    v_fmamk_f32 v25, v25, 0x3ae38e39, v36
    v_sin_f32 v16, v16
    v_sin_f32 v17, v17
    v_sin_f32 v24, v24
    v_sin_f32 v25, v25
    s_nop 0
    v_fma_f32 v18, v33, v17, -v16
    v_fma_f32 v26, v33, v25, -v24
    v_fma_f32 v19, v33, v18, -v17
    v_fma_f32 v27, v33, v26, -v25
    v_fma_f32 v20, v33, v19, -v18
    v_fma_f32 v28, v33, v27, -v26
    v_fma_f32 v21, v33, v20, -v19
    v_fma_f32 v29, v33, v28, -v27
    v_fma_f32 v22, v33, v21, -v20
    v_fma_f32 v30, v33, v29, -v28
    v_fma_f32 v23, v33, v22, -v21
    v_fma_f32 v31, v33, v30, -v29
    v_cvt_pk_bf16_f32 v112, v16, v17
    v_cvt_pk_bf16_f32 v113, v18, v19
    v_cvt_pk_bf16_f32 v114, v20, v21
    v_cvt_pk_bf16_f32 v115, v22, v23
    v_cvt_pk_bf16_f32 v124, v24, v25
    v_cvt_pk_bf16_f32 v125, v26, v27
    v_cvt_pk_bf16_f32 v126, v28, v29
    v_cvt_pk_bf16_f32 v127, v30, v31
    v_fma_f32 v16, v34, v24, -v16
    v_fma_f32 v17, v34, v25, -v17
    v_fma_f32 v18, v34, v26, -v18
    v_fma_f32 v19, v34, v27, -v19
    v_fma_f32 v20, v34, v28, -v20
    v_fma_f32 v21, v34, v29, -v21
    v_fma_f32 v22, v34, v30, -v22
    v_fma_f32 v23, v34, v31, -v23
    v_cvt_pk_bf16_f32 v136, v16, v17
    v_cvt_pk_bf16_f32 v137, v18, v19
    v_cvt_pk_bf16_f32 v138, v20, v21
    v_cvt_pk_bf16_f32 v139, v22, v23
    s_barrier
    v_fma_f32 v24, v34, v16, -v24
    v_fma_f32 v25, v34, v17, -v25
    v_fma_f32 v26, v34, v18, -v26
    v_fma_f32 v27, v34, v19, -v27
    v_fma_f32 v28, v34, v20, -v28
    v_fma_f32 v29, v34, v21, -v29
    v_fma_f32 v30, v34, v22, -v30
    v_fma_f32 v31, v34, v23, -v31
    v_cvt_pk_bf16_f32 v148, v24, v25
    v_cvt_pk_bf16_f32 v149, v26, v27
    v_cvt_pk_bf16_f32 v150, v28, v29
    v_cvt_pk_bf16_f32 v151, v30, v31
    v_fma_f32 v16, v34, v24, -v16
    v_fma_f32 v17, v34, v25, -v17
    v_fma_f32 v18, v34, v26, -v18
    v_fma_f32 v19, v34, v27, -v19
    v_fma_f32 v20, v34, v28, -v20
    v_fma_f32 v21, v34, v29, -v21
    v_fma_f32 v22, v34, v30, -v22
    v_fma_f32 v23, v34, v31, -v23
    v_cvt_pk_bf16_f32 v160, v16, v17
    v_cvt_pk_bf16_f32 v161, v18, v19
    v_cvt_pk_bf16_f32 v162, v20, v21
    v_cvt_pk_bf16_f32 v163, v22, v23
    v_fma_f32 v24, v34, v16, -v24
    v_fma_f32 v25, v34, v17, -v25
    v_fma_f32 v26, v34, v18, -v26
    v_fma_f32 v27, v34, v19, -v27
    v_fma_f32 v28, v34, v20, -v28
    v_fma_f32 v29, v34, v21, -v29
    v_fma_f32 v30, v34, v22, -v30
    v_fma_f32 v31, v34, v23, -v31
    v_cvt_pk_bf16_f32 v172, v24, v25
    v_cvt_pk_bf16_f32 v173, v26, v27
    v_cvt_pk_bf16_f32 v174, v28, v29
    v_cvt_pk_bf16_f32 v175, v30, v31
    v_fma_f32 v16, v34, v24, -v16
    v_fma_f32 v17, v34, v25, -v17
    v_fma_f32 v18, v34, v26, -v18
    v_fma_f32 v19, v34, v27, -v19
    v_fma_f32 v20, v34, v28, -v20
    v_fma_f32 v21, v34, v29, -v21
    v_fma_f32 v22, v34, v30, -v22
    v_fma_f32 v23, v34, v31, -v23
    v_cvt_pk_bf16_f32 v184, v16, v17
    v_cvt_pk_bf16_f32 v185, v18, v19
    v_cvt_pk_bf16_f32 v186, v20, v21
    v_cvt_pk_bf16_f32 v187, v22, v23
    v_fma_f32 v24, v34, v16, -v24
    v_fma_f32 v25, v34, v17, -v25
    v_fma_f32 v26, v34, v18, -v26
    v_fma_f32 v27, v34, v19, -v27
    v_fma_f32 v28, v34, v20, -v28
    v_fma_f32 v29, v34, v21, -v29
    v_fma_f32 v30, v34, v22, -v30
    v_fma_f32 v31, v34, v23, -v31
    v_cvt_pk_bf16_f32 v196, v24, v25
    v_cvt_pk_bf16_f32 v197, v26, v27
    v_cvt_pk_bf16_f32 v198, v28, v29
    v_cvt_pk_bf16_f32 v199, v30, v31
    v_fma_f32 v16, v34, v24, -v16
    v_fma_f32 v17, v34, v25, -v17
    v_fma_f32 v18, v34, v26, -v18
    v_fma_f32 v19, v34, v27, -v19
    v_fma_f32 v20, v34, v28, -v20
    v_fma_f32 v21, v34, v29, -v21
    v_fma_f32 v22, v34, v30, -v22
    v_fma_f32 v23, v34, v31, -v23
    v_cvt_pk_bf16_f32 v208, v16, v17
    v_cvt_pk_bf16_f32 v209, v18, v19
    v_cvt_pk_bf16_f32 v210, v20, v21
    v_cvt_pk_bf16_f32 v211, v22, v23
    v_lshrrev_b32 v5, 1, v2
    v_lshlrev_b32 v8, 8, v5
    v_lshl_add_u32 v8, v3, 4, v8
    v_and_b32 v5, 1, v2
    v_mul_u32_u24 v9, 18432, v5
    v_add_u32 v8, v8, v9
    v_lshrrev_b32 v6, 2, v3
    v_lshl_add_u32 v6, v2, 3, v6
    v_lshlrev_b32 v6, 7, v6
    v_and_b32 v7, 3, v3
    v_lshl_add_u32 v6, v7, 3, v6
    v_lshl_add_u32 v6, v5, 6, v6
    v_lshrrev_b32 v7, 3, v3
    v_lshl_add_u32 v6, v7, 5, v6
    v_xor_b32 v7, 32, v6
    v_xor_b32 v5, 64, v6
    v_xor_b32 v9, 96, v6
    s_mul_i32 s39, s25, 36864
    s_lshl_b32 s40, s27, 9
    s_add_u32 s39, s39, s40
    s_lshl_b32 s42, s25, 11
    s_lshl_b32 s40, s3, 2
    s_add_u32 s40, s40, s24
    s_lshl_b32 s40, s40, 7
    s_add_u32 s41, s42, s40
    s_mov_b32 s43, 0x35e38e39
    v_lshlrev_b32 v13, 3, v3
    v_mul_u32_u24 v12, 384, v2
    v_add_u32 v12, v12, v13
    s_lshl_b32 s55, s24, 2
    s_add_u32 s55, s55, s3
    s_lshl_b32 s55, s55, 2
    s_lshl_b32 s40, s25, 7
    s_add_u32 s55, s55, s40
    v_mov_b32 v250, 1
    v_mov_b32 v251, 0
    s_cmp_eq_u32 s56, 255
    s_cbranch_scc1 L_pkdone_24
    v_add_u32 v239, 55296, v4
    s_waitcnt vmcnt(8)
    s_cmp_eq_u32 s57, 0
    s_cbranch_scc1 L_pkbar_25
    ds_read_b64_tr_b16 a[0:1], v240 offset:0
    ds_read_b64_tr_b16 a[2:3], v241 offset:0
    ds_read_b64_tr_b16 a[4:5], v240 offset:32
    ds_read_b64_tr_b16 a[6:7], v241 offset:32
    ds_read_b64_tr_b16 a[8:9], v240 offset:64
    ds_read_b64_tr_b16 a[10:11], v241 offset:64
    ds_read_b64_tr_b16 a[12:13], v240 offset:96
    ds_read_b64_tr_b16 a[14:15], v241 offset:96
    ds_read_b64_tr_b16 a[16:17], v240 offset:4096
    ds_read_b64_tr_b16 a[18:19], v241 offset:4096
    ds_read_b64_tr_b16 a[20:21], v240 offset:4128
    ds_read_b64_tr_b16 a[22:23], v241 offset:4128
    ds_read_b64_tr_b16 a[24:25], v240 offset:4160
    ds_read_b64_tr_b16 a[26:27], v241 offset:4160
    ds_read_b64_tr_b16 a[28:29], v240 offset:4192
    ds_read_b64_tr_b16 a[30:31], v241 offset:4192
    s_waitcnt lgkmcnt(14)
    buffer_store_dwordx4 a[0:3], v4, s[8:11], s50 offen sc1
    s_waitcnt lgkmcnt(12)
    buffer_store_dwordx4 a[4:7], v10, s[8:11], s50 offen sc1
    s_waitcnt lgkmcnt(10)
    buffer_store_dwordx4 a[8:11], v11, s[8:11], s50 offen sc1
    s_waitcnt lgkmcnt(8)
    buffer_store_dwordx4 a[12:15], v239, s[8:11], s50 offen sc1
    s_add_u32 s50, s50, 73728
    ds_read_b64_tr_b16 a[32:33], v240 offset:8192
    ds_read_b64_tr_b16 a[34:35], v241 offset:8192
    ds_read_b64_tr_b16 a[36:37], v240 offset:8224
    ds_read_b64_tr_b16 a[38:39], v241 offset:8224
    ds_read_b64_tr_b16 a[40:41], v240 offset:8256
    ds_read_b64_tr_b16 a[42:43], v241 offset:8256
    ds_read_b64_tr_b16 a[44:45], v240 offset:8288
    ds_read_b64_tr_b16 a[46:47], v241 offset:8288
    s_waitcnt lgkmcnt(14)
    buffer_store_dwordx4 a[16:19], v4, s[8:11], s50 offen sc1
    s_waitcnt lgkmcnt(12)
    buffer_store_dwordx4 a[20:23], v10, s[8:11], s50 offen sc1
    s_waitcnt lgkmcnt(10)
    buffer_store_dwordx4 a[24:27], v11, s[8:11], s50 offen sc1
    s_waitcnt lgkmcnt(8)
    buffer_store_dwordx4 a[28:31], v239, s[8:11], s50 offen sc1
    s_add_u32 s50, s50, 73728
    ds_read_b64_tr_b16 a[48:49], v242 offset:12288
    ds_read_b64_tr_b16 a[50:51], v243 offset:12288
    ds_read_b64_tr_b16 a[52:53], v242 offset:12320
    ds_read_b64_tr_b16 a[54:55], v243 offset:12320
    ds_read_b64_tr_b16 a[56:57], v242 offset:12352
    ds_read_b64_tr_b16 a[58:59], v243 offset:12352
    ds_read_b64_tr_b16 a[60:61], v242 offset:12384
    ds_read_b64_tr_b16 a[62:63], v243 offset:12384
    s_waitcnt lgkmcnt(14)
    buffer_store_dwordx4 a[32:35], v4, s[8:11], s50 offen sc1
    s_waitcnt lgkmcnt(12)
    buffer_store_dwordx4 a[36:39], v10, s[8:11], s50 offen sc1
    s_waitcnt lgkmcnt(10)
    buffer_store_dwordx4 a[40:43], v11, s[8:11], s50 offen sc1
    s_waitcnt lgkmcnt(8)
    buffer_store_dwordx4 a[44:47], v239, s[8:11], s50 offen sc1
    ds_read_b64_tr_b16 a[64:65], v242 offset:16384
    ds_read_b64_tr_b16 a[66:67], v243 offset:16384
    ds_read_b64_tr_b16 a[68:69], v242 offset:16416
    ds_read_b64_tr_b16 a[70:71], v243 offset:16416
    ds_read_b64_tr_b16 a[72:73], v242 offset:16448
    ds_read_b64_tr_b16 a[74:75], v243 offset:16448
    ds_read_b64_tr_b16 a[76:77], v242 offset:16480
    ds_read_b64_tr_b16 a[78:79], v243 offset:16480
    s_waitcnt lgkmcnt(14)
    buffer_store_dwordx4 a[48:51], v4, s[8:11], s51 offen sc1
    s_waitcnt lgkmcnt(12)
    buffer_store_dwordx4 a[52:55], v10, s[8:11], s51 offen sc1
    s_waitcnt lgkmcnt(10)
    buffer_store_dwordx4 a[56:59], v11, s[8:11], s51 offen sc1
    s_waitcnt lgkmcnt(8)
    buffer_store_dwordx4 a[60:63], v239, s[8:11], s51 offen sc1
    s_add_u32 s51, s51, 73728
    ds_read_b64_tr_b16 a[80:81], v242 offset:20480
    ds_read_b64_tr_b16 a[82:83], v243 offset:20480
    ds_read_b64_tr_b16 a[84:85], v242 offset:20512
    ds_read_b64_tr_b16 a[86:87], v243 offset:20512
    ds_read_b64_tr_b16 a[88:89], v242 offset:20544
    ds_read_b64_tr_b16 a[90:91], v243 offset:20544
    ds_read_b64_tr_b16 a[92:93], v242 offset:20576
    ds_read_b64_tr_b16 a[94:95], v243 offset:20576
    s_waitcnt lgkmcnt(14)
    buffer_store_dwordx4 a[64:67], v4, s[8:11], s51 offen sc1
    s_waitcnt lgkmcnt(12)
    buffer_store_dwordx4 a[68:71], v10, s[8:11], s51 offen sc1
    s_waitcnt lgkmcnt(10)
    buffer_store_dwordx4 a[72:75], v11, s[8:11], s51 offen sc1
    s_waitcnt lgkmcnt(8)
    buffer_store_dwordx4 a[76:79], v239, s[8:11], s51 offen sc1
    s_add_u32 s51, s51, 73728
    s_waitcnt lgkmcnt(6)
    buffer_store_dwordx4 a[80:83], v4, s[8:11], s51 offen sc1
    s_waitcnt lgkmcnt(4)
    buffer_store_dwordx4 a[84:87], v10, s[8:11], s51 offen sc1
    s_waitcnt lgkmcnt(2)
    buffer_store_dwordx4 a[88:91], v11, s[8:11], s51 offen sc1
    s_waitcnt lgkmcnt(0)
    buffer_store_dwordx4 a[92:95], v239, s[8:11], s51 offen sc1
L_pkbar_25:
    s_barrier
L_pkdone_24:
    s_add_u32 s52, s36, 46006272
    buffer_load_dwordx4 a[0:3], v4, s[8:11], s52 offen offset:0
    buffer_load_dwordx4 a[4:7], v10, s[8:11], s52 offen offset:0
    buffer_load_dwordx4 a[8:11], v11, s[8:11], s52 offen offset:0
    buffer_load_dwordx4 a[12:15], v4, s[8:11], s52 offen offset:1024
    buffer_load_dwordx4 a[16:19], v10, s[8:11], s52 offen offset:1024
    buffer_load_dwordx4 a[20:23], v11, s[8:11], s52 offen offset:1024
    buffer_load_dwordx4 a[24:27], v4, s[8:11], s52 offen offset:2048
    buffer_load_dwordx4 a[28:31], v10, s[8:11], s52 offen offset:2048
    buffer_load_dwordx4 a[32:35], v11, s[8:11], s52 offen offset:2048
    buffer_load_dwordx4 a[36:39], v4, s[8:11], s52 offen offset:3072
    buffer_load_dwordx4 a[40:43], v10, s[8:11], s52 offen offset:3072
    buffer_load_dwordx4 a[44:47], v11, s[8:11], s52 offen offset:3072
    s_barrier
    s_add_u32 m0, s32, 0
    s_nop 0
    buffer_load_dwordx4 v253, s[8:11], s33 offen sc1 lds
    s_add_u32 m0, s32, 4096
    s_add_u32 s33, s33, 262144
    buffer_load_dwordx4 v253, s[8:11], s33 offen sc1 lds
    s_add_u32 m0, s32, 8192
    s_add_u32 s33, s33, 262144
    buffer_load_dwordx4 v253, s[8:11], s33 offen sc1 lds
    s_add_u32 m0, s32, 12288
    s_add_u32 s33, s33, 262144
    buffer_load_dwordx4 v253, s[8:11], s33 offen sc1 lds
    s_add_u32 m0, s32, 16384
    s_add_u32 s33, s33, 262144
    buffer_load_dwordx4 v253, s[8:11], s33 offen sc1 lds
    s_add_u32 m0, s32, 20480
    s_add_u32 s33, s33, 262144
    buffer_load_dwordx4 v253, s[8:11], s33 offen sc1 lds
    s_add_u32 m0, s32, 24576
    s_add_u32 s33, s33, 262144
    buffer_load_dwordx4 v253, s[8:11], s33 offen sc1 lds
    s_add_u32 m0, s32, 28672
    s_add_u32 s33, s33, 262144
    buffer_load_dwordx4 v253, s[8:11], s33 offen sc1 lds
    s_add_u32 m0, s32, 32768
    s_add_u32 s33, s33, 262144
    buffer_load_dwordx4 v253, s[8:11], s33 offen sc1 lds
    s_waitcnt vmcnt(7)
    s_barrier
    ds_read_b64_tr_b16 v[64:65], v6 offset:0
    ds_read_b64_tr_b16 v[66:67], v6 offset:512
    ds_read_b64_tr_b16 v[68:69], v7 offset:0
    ds_read_b64_tr_b16 v[70:71], v7 offset:512
    ds_read_b64_tr_b16 v[72:73], v5 offset:0
    ds_read_b64_tr_b16 v[74:75], v5 offset:512
    ds_read_b64_tr_b16 v[76:77], v9 offset:0
    ds_read_b64_tr_b16 v[78:79], v9 offset:512
    ds_read_b64_tr_b16 v[80:81], v6 offset:4096
    ds_read_b64_tr_b16 v[82:83], v6 offset:4608
    ds_read_b64_tr_b16 v[84:85], v7 offset:4096
    ds_read_b64_tr_b16 v[86:87], v7 offset:4608
    s_waitcnt lgkmcnt(8)
    v_mfma_f32_16x16x32_bf16 v[16:19], v[104:107], v[64:67], 0
    v_mfma_f32_16x16x32_bf16 v[20:23], v[104:107], v[68:71], 0
    v_mfma_f32_16x16x32_bf16 v[24:27], v[108:111], v[64:67], 0
    v_mfma_f32_16x16x32_bf16 v[28:31], v[108:111], v[68:71], 0
    v_mfma_f32_16x16x32_bf16 v[32:35], v[112:115], v[64:67], 0
    v_mfma_f32_16x16x32_bf16 v[36:39], v[112:115], v[68:71], 0
    s_add_u32 s52, s52, 4096
    buffer_load_dwordx4 a[48:51], v4, s[8:11], s52 offen offset:0
    ds_read_b64_tr_b16 v[64:65], v5 offset:4096
    ds_read_b64_tr_b16 v[66:67], v5 offset:4608
    ds_read_b64_tr_b16 v[68:69], v9 offset:4096
    ds_read_b64_tr_b16 v[70:71], v9 offset:4608
    s_waitcnt lgkmcnt(8)
    v_mfma_f32_16x16x32_bf16 v[40:43], v[104:107], v[72:75], 0
    v_mfma_f32_16x16x32_bf16 v[44:47], v[104:107], v[76:79], 0
    v_mfma_f32_16x16x32_bf16 v[48:51], v[108:111], v[72:75], 0
    v_mfma_f32_16x16x32_bf16 v[52:55], v[108:111], v[76:79], 0
    v_mfma_f32_16x16x32_bf16 v[56:59], v[112:115], v[72:75], 0
    v_mfma_f32_16x16x32_bf16 v[60:63], v[112:115], v[76:79], 0
    buffer_load_dwordx4 a[52:55], v10, s[8:11], s52 offen offset:0
    s_waitcnt vmcnt(6)
    s_barrier
    ds_read_b64_tr_b16 v[72:73], v6 offset:8192
    ds_read_b64_tr_b16 v[74:75], v6 offset:8704
    ds_read_b64_tr_b16 v[76:77], v7 offset:8192
    ds_read_b64_tr_b16 v[78:79], v7 offset:8704
    s_waitcnt lgkmcnt(8)
    v_mfma_f32_16x16x32_bf16 v[16:19], v[116:119], v[80:83], v[16:19]
    v_mfma_f32_16x16x32_bf16 v[20:23], v[116:119], v[84:87], v[20:23]
    v_mfma_f32_16x16x32_bf16 v[24:27], v[120:123], v[80:83], v[24:27]
    v_mfma_f32_16x16x32_bf16 v[28:31], v[120:123], v[84:87], v[28:31]
    v_mfma_f32_16x16x32_bf16 v[32:35], v[124:127], v[80:83], v[32:35]
    v_mfma_f32_16x16x32_bf16 v[36:39], v[124:127], v[84:87], v[36:39]
    buffer_load_dwordx4 a[56:59], v11, s[8:11], s52 offen offset:0
    buffer_load_dwordx4 a[60:63], v4, s[8:11], s52 offen offset:1024
    ds_read_b64_tr_b16 v[80:81], v5 offset:8192
    ds_read_b64_tr_b16 v[82:83], v5 offset:8704
    ds_read_b64_tr_b16 v[84:85], v9 offset:8192
    ds_read_b64_tr_b16 v[86:87], v9 offset:8704
    s_waitcnt lgkmcnt(8)
    v_mfma_f32_16x16x32_bf16 v[40:43], v[116:119], v[64:67], v[40:43]
    v_mfma_f32_16x16x32_bf16 v[44:47], v[116:119], v[68:71], v[44:47]
    v_mfma_f32_16x16x32_bf16 v[48:51], v[120:123], v[64:67], v[48:51]
    v_mfma_f32_16x16x32_bf16 v[52:55], v[120:123], v[68:71], v[52:55]
    v_mfma_f32_16x16x32_bf16 v[56:59], v[124:127], v[64:67], v[56:59]
    v_mfma_f32_16x16x32_bf16 v[60:63], v[124:127], v[68:71], v[60:63]
    buffer_load_dwordx4 a[64:67], v10, s[8:11], s52 offen offset:1024
    ds_read_b64_tr_b16 v[64:65], v6 offset:12288
    ds_read_b64_tr_b16 v[66:67], v6 offset:12800
    ds_read_b64_tr_b16 v[68:69], v7 offset:12288
    ds_read_b64_tr_b16 v[70:71], v7 offset:12800
    s_waitcnt lgkmcnt(8)
    v_mfma_f32_16x16x32_bf16 v[16:19], v[128:131], v[72:75], v[16:19]
    v_mfma_f32_16x16x32_bf16 v[20:23], v[128:131], v[76:79], v[20:23]
    v_mfma_f32_16x16x32_bf16 v[24:27], v[132:135], v[72:75], v[24:27]
    v_mfma_f32_16x16x32_bf16 v[28:31], v[132:135], v[76:79], v[28:31]
    v_mfma_f32_16x16x32_bf16 v[32:35], v[136:139], v[72:75], v[32:35]
    v_mfma_f32_16x16x32_bf16 v[36:39], v[136:139], v[76:79], v[36:39]
    buffer_load_dwordx4 a[68:71], v11, s[8:11], s52 offen offset:1024
    ds_read_b64_tr_b16 v[72:73], v5 offset:12288
    ds_read_b64_tr_b16 v[74:75], v5 offset:12800
    ds_read_b64_tr_b16 v[76:77], v9 offset:12288
    ds_read_b64_tr_b16 v[78:79], v9 offset:12800
    s_waitcnt lgkmcnt(8)
    v_mfma_f32_16x16x32_bf16 v[40:43], v[128:131], v[80:83], v[40:43]
    v_mfma_f32_16x16x32_bf16 v[44:47], v[128:131], v[84:87], v[44:47]
    v_mfma_f32_16x16x32_bf16 v[48:51], v[132:135], v[80:83], v[48:51]
    v_mfma_f32_16x16x32_bf16 v[52:55], v[132:135], v[84:87], v[52:55]
    v_mfma_f32_16x16x32_bf16 v[56:59], v[136:139], v[80:83], v[56:59]
    v_mfma_f32_16x16x32_bf16 v[60:63], v[136:139], v[84:87], v[60:63]
    buffer_load_dwordx4 a[72:75], v4, s[8:11], s52 offen offset:2048
    buffer_load_dwordx4 a[76:79], v10, s[8:11], s52 offen offset:2048
    ds_read_b64_tr_b16 v[80:81], v6 offset:16384
    ds_read_b64_tr_b16 v[82:83], v6 offset:16896
    ds_read_b64_tr_b16 v[84:85], v7 offset:16384
    ds_read_b64_tr_b16 v[86:87], v7 offset:16896
    s_waitcnt lgkmcnt(8)
    v_mfma_f32_16x16x32_bf16 v[16:19], v[140:143], v[64:67], v[16:19]
    v_mfma_f32_16x16x32_bf16 v[20:23], v[140:143], v[68:71], v[20:23]
    v_mfma_f32_16x16x32_bf16 v[24:27], v[144:147], v[64:67], v[24:27]
    v_mfma_f32_16x16x32_bf16 v[28:31], v[144:147], v[68:71], v[28:31]
    v_mfma_f32_16x16x32_bf16 v[32:35], v[148:151], v[64:67], v[32:35]
    v_mfma_f32_16x16x32_bf16 v[36:39], v[148:151], v[68:71], v[36:39]
    buffer_load_dwordx4 a[80:83], v11, s[8:11], s52 offen offset:2048
    ds_read_b64_tr_b16 v[64:65], v5 offset:16384
    ds_read_b64_tr_b16 v[66:67], v5 offset:16896
    ds_read_b64_tr_b16 v[68:69], v9 offset:16384
    ds_read_b64_tr_b16 v[70:71], v9 offset:16896
    s_waitcnt lgkmcnt(8)
    v_mfma_f32_16x16x32_bf16 v[40:43], v[140:143], v[72:75], v[40:43]
    v_mfma_f32_16x16x32_bf16 v[44:47], v[140:143], v[76:79], v[44:47]
    v_mfma_f32_16x16x32_bf16 v[48:51], v[144:147], v[72:75], v[48:51]
    v_mfma_f32_16x16x32_bf16 v[52:55], v[144:147], v[76:79], v[52:55]
    v_mfma_f32_16x16x32_bf16 v[56:59], v[148:151], v[72:75], v[56:59]
    v_mfma_f32_16x16x32_bf16 v[60:63], v[148:151], v[76:79], v[60:63]
    buffer_load_dwordx4 a[84:87], v4, s[8:11], s52 offen offset:3072
    s_waitcnt vmcnt(10)
    s_barrier
    ds_read_b64_tr_b16 v[72:73], v6 offset:20480
    ds_read_b64_tr_b16 v[74:75], v6 offset:20992
    ds_read_b64_tr_b16 v[76:77], v7 offset:20480
    ds_read_b64_tr_b16 v[78:79], v7 offset:20992
    s_waitcnt lgkmcnt(8)
    v_mfma_f32_16x16x32_bf16 v[16:19], v[152:155], v[80:83], v[16:19]
    v_mfma_f32_16x16x32_bf16 v[20:23], v[152:155], v[84:87], v[20:23]
    v_mfma_f32_16x16x32_bf16 v[24:27], v[156:159], v[80:83], v[24:27]
    v_mfma_f32_16x16x32_bf16 v[28:31], v[156:159], v[84:87], v[28:31]
    v_mfma_f32_16x16x32_bf16 v[32:35], v[160:163], v[80:83], v[32:35]
    v_mfma_f32_16x16x32_bf16 v[36:39], v[160:163], v[84:87], v[36:39]
    buffer_load_dwordx4 a[88:91], v10, s[8:11], s52 offen offset:3072
    buffer_load_dwordx4 a[92:95], v11, s[8:11], s52 offen offset:3072
    ds_read_b64_tr_b16 v[80:81], v5 offset:20480
    ds_read_b64_tr_b16 v[82:83], v5 offset:20992
    ds_read_b64_tr_b16 v[84:85], v9 offset:20480
    ds_read_b64_tr_b16 v[86:87], v9 offset:20992
    s_waitcnt lgkmcnt(8)
    v_mfma_f32_16x16x32_bf16 v[40:43], v[152:155], v[64:67], v[40:43]
    v_mfma_f32_16x16x32_bf16 v[44:47], v[152:155], v[68:71], v[44:47]
    v_lshlrev_b32 v224, 16, v212
    v_mfma_f32_16x16x32_bf16 v[48:51], v[156:159], v[64:67], v[48:51]
    v_and_b32 v225, 0xffff0000, v212
    v_mfma_f32_16x16x32_bf16 v[52:55], v[156:159], v[68:71], v[52:55]
    v_lshlrev_b32 v226, 16, v213
    v_mfma_f32_16x16x32_bf16 v[56:59], v[160:163], v[64:67], v[56:59]
    v_and_b32 v227, 0xffff0000, v213
    v_mfma_f32_16x16x32_bf16 v[60:63], v[160:163], v[68:71], v[60:63]
    v_sub_f32 v224, v224, v14
    s_add_u32 s52, s52, 4096
    buffer_load_dwordx4 a[96:99], v4, s[8:11], s52 offen offset:0
    ds_read_b64_tr_b16 v[64:65], v6 offset:24576
    ds_read_b64_tr_b16 v[66:67], v6 offset:25088
    ds_read_b64_tr_b16 v[68:69], v7 offset:24576
    ds_read_b64_tr_b16 v[70:71], v7 offset:25088
    s_waitcnt lgkmcnt(8)
    v_mfma_f32_16x16x32_bf16 v[16:19], v[164:167], v[72:75], v[16:19]
    v_sub_f32 v225, v225, v14
    v_mfma_f32_16x16x32_bf16 v[20:23], v[164:167], v[76:79], v[20:23]
    v_sub_f32 v226, v226, v14
    v_mfma_f32_16x16x32_bf16 v[24:27], v[168:171], v[72:75], v[24:27]
    v_sub_f32 v227, v227, v14
    v_mfma_f32_16x16x32_bf16 v[28:31], v[168:171], v[76:79], v[28:31]
    v_lshlrev_b32 v228, 16, v214
    v_mfma_f32_16x16x32_bf16 v[32:35], v[172:175], v[72:75], v[32:35]
    v_and_b32 v229, 0xffff0000, v214
    v_mfma_f32_16x16x32_bf16 v[36:39], v[172:175], v[76:79], v[36:39]
    v_lshlrev_b32 v230, 16, v215
    buffer_load_dwordx4 a[100:103], v10, s[8:11], s52 offen offset:0
    ds_read_b64_tr_b16 v[72:73], v5 offset:24576
    ds_read_b64_tr_b16 v[74:75], v5 offset:25088
    ds_read_b64_tr_b16 v[76:77], v9 offset:24576
    ds_read_b64_tr_b16 v[78:79], v9 offset:25088
    s_waitcnt lgkmcnt(8)
    v_mfma_f32_16x16x32_bf16 v[40:43], v[164:167], v[80:83], v[40:43]
    v_and_b32 v231, 0xffff0000, v215
    v_mfma_f32_16x16x32_bf16 v[44:47], v[164:167], v[84:87], v[44:47]
    v_sub_f32 v228, v228, v15
    v_mfma_f32_16x16x32_bf16 v[48:51], v[168:171], v[80:83], v[48:51]
    v_sub_f32 v229, v229, v15
    v_mfma_f32_16x16x32_bf16 v[52:55], v[168:171], v[84:87], v[52:55]
    v_sub_f32 v230, v230, v15
    v_mfma_f32_16x16x32_bf16 v[56:59], v[172:175], v[80:83], v[56:59]
    v_sub_f32 v231, v231, v15
    v_mfma_f32_16x16x32_bf16 v[60:63], v[172:175], v[84:87], v[60:63]
    v_lshlrev_b32 v232, 16, v216
    buffer_load_dwordx4 a[104:107], v11, s[8:11], s52 offen offset:0
    buffer_load_dwordx4 a[108:111], v4, s[8:11], s52 offen offset:1024
    ds_read_b64_tr_b16 v[80:81], v6 offset:28672
    ds_read_b64_tr_b16 v[82:83], v6 offset:29184
    ds_read_b64_tr_b16 v[84:85], v7 offset:28672
    ds_read_b64_tr_b16 v[86:87], v7 offset:29184
    s_waitcnt lgkmcnt(8)
    v_mfma_f32_16x16x32_bf16 v[16:19], v[176:179], v[64:67], v[16:19]
    v_and_b32 v233, 0xffff0000, v216
    v_mfma_f32_16x16x32_bf16 v[20:23], v[176:179], v[68:71], v[20:23]
    v_lshlrev_b32 v234, 16, v217
    v_mfma_f32_16x16x32_bf16 v[24:27], v[180:183], v[64:67], v[24:27]
    v_and_b32 v235, 0xffff0000, v217
    v_mfma_f32_16x16x32_bf16 v[28:31], v[180:183], v[68:71], v[28:31]
    v_sub_f32 v232, v232, v14
    v_mfma_f32_16x16x32_bf16 v[32:35], v[184:187], v[64:67], v[32:35]
    v_sub_f32 v233, v233, v14
    v_mfma_f32_16x16x32_bf16 v[36:39], v[184:187], v[68:71], v[36:39]
    v_sub_f32 v234, v234, v14
    buffer_load_dwordx4 a[112:115], v10, s[8:11], s52 offen offset:1024
    ds_read_b64_tr_b16 v[64:65], v5 offset:28672
    ds_read_b64_tr_b16 v[66:67], v5 offset:29184
    ds_read_b64_tr_b16 v[68:69], v9 offset:28672
    ds_read_b64_tr_b16 v[70:71], v9 offset:29184
    s_waitcnt lgkmcnt(8)
    v_mfma_f32_16x16x32_bf16 v[40:43], v[176:179], v[72:75], v[40:43]
    v_sub_f32 v235, v235, v14
    v_mfma_f32_16x16x32_bf16 v[44:47], v[176:179], v[76:79], v[44:47]
    v_lshlrev_b32 v236, 16, v218
    v_mfma_f32_16x16x32_bf16 v[48:51], v[180:183], v[72:75], v[48:51]
    v_mfma_f32_16x16x32_bf16 v[52:55], v[180:183], v[76:79], v[52:55]
    v_and_b32 v237, 0xffff0000, v218
    v_mfma_f32_16x16x32_bf16 v[56:59], v[184:187], v[72:75], v[56:59]
    v_lshlrev_b32 v238, 16, v219
    v_mfma_f32_16x16x32_bf16 v[60:63], v[184:187], v[76:79], v[60:63]
    v_and_b32 v239, 0xffff0000, v219
    buffer_load_dwordx4 a[116:119], v11, s[8:11], s52 offen offset:1024
    ds_read_b64_tr_b16 v[72:73], v6 offset:32768
    ds_read_b64_tr_b16 v[74:75], v6 offset:33280
    ds_read_b64_tr_b16 v[76:77], v7 offset:32768
    ds_read_b64_tr_b16 v[78:79], v7 offset:33280
    s_waitcnt lgkmcnt(8)
    v_mfma_f32_16x16x32_bf16 v[16:19], v[188:191], v[80:83], v[16:19]
    v_sub_f32 v236, v236, v15
    v_mfma_f32_16x16x32_bf16 v[20:23], v[188:191], v[84:87], v[20:23]
    v_sub_f32 v237, v237, v15
    v_mfma_f32_16x16x32_bf16 v[24:27], v[192:195], v[80:83], v[24:27]
    v_sub_f32 v238, v238, v15
    v_mfma_f32_16x16x32_bf16 v[28:31], v[192:195], v[84:87], v[28:31]
    v_sub_f32 v239, v239, v15
    v_mfma_f32_16x16x32_bf16 v[32:35], v[196:199], v[80:83], v[32:35]
    v_lshlrev_b32 v240, 16, v220
    v_mfma_f32_16x16x32_bf16 v[36:39], v[196:199], v[84:87], v[36:39]
    v_and_b32 v241, 0xffff0000, v220
    buffer_load_dwordx4 a[120:123], v4, s[8:11], s52 offen offset:2048
    buffer_load_dwordx4 a[124:127], v10, s[8:11], s52 offen offset:2048
    ds_read_b64_tr_b16 v[80:81], v5 offset:32768
    ds_read_b64_tr_b16 v[82:83], v5 offset:33280
    ds_read_b64_tr_b16 v[84:85], v9 offset:32768
    ds_read_b64_tr_b16 v[86:87], v9 offset:33280
    s_waitcnt lgkmcnt(8)
    v_mfma_f32_16x16x32_bf16 v[40:43], v[188:191], v[64:67], v[40:43]
    v_lshlrev_b32 v242, 16, v221
    v_mfma_f32_16x16x32_bf16 v[44:47], v[188:191], v[68:71], v[44:47]
    v_and_b32 v243, 0xffff0000, v221
    v_mfma_f32_16x16x32_bf16 v[48:51], v[192:195], v[64:67], v[48:51]
    v_sub_f32 v240, v240, v14
    v_mfma_f32_16x16x32_bf16 v[52:55], v[192:195], v[68:71], v[52:55]
    v_sub_f32 v241, v241, v14
    v_mfma_f32_16x16x32_bf16 v[56:59], v[196:199], v[64:67], v[56:59]
    v_sub_f32 v242, v242, v14
    v_mfma_f32_16x16x32_bf16 v[60:63], v[196:199], v[68:71], v[60:63]
    v_sub_f32 v243, v243, v14
    buffer_load_dwordx4 a[128:131], v11, s[8:11], s52 offen offset:2048
    s_waitcnt lgkmcnt(4)
    v_mfma_f32_16x16x32_bf16 v[16:19], v[200:203], v[72:75], v[16:19]
    v_lshlrev_b32 v100, 16, v222
    v_mfma_f32_16x16x32_bf16 v[20:23], v[200:203], v[76:79], v[20:23]
    v_and_b32 v101, 0xffff0000, v222
    v_mfma_f32_16x16x32_bf16 v[24:27], v[204:207], v[72:75], v[24:27]
    v_lshlrev_b32 v102, 16, v223
    v_mfma_f32_16x16x32_bf16 v[28:31], v[204:207], v[76:79], v[28:31]
    v_and_b32 v103, 0xffff0000, v223
    v_mfma_f32_16x16x32_bf16 v[32:35], v[208:211], v[72:75], v[32:35]
    v_sub_f32 v100, v100, v15
    v_mfma_f32_16x16x32_bf16 v[36:39], v[208:211], v[76:79], v[36:39]
    v_sub_f32 v101, v101, v15
    buffer_load_dwordx4 a[132:135], v4, s[8:11], s52 offen offset:3072
    s_waitcnt lgkmcnt(0)
    v_mfma_f32_16x16x32_bf16 v[40:43], v[200:203], v[80:83], v[40:43]
    v_sub_f32 v102, v102, v15
    v_mfma_f32_16x16x32_bf16 v[44:47], v[200:203], v[84:87], v[44:47]
    v_sub_f32 v103, v103, v15
    v_mfma_f32_16x16x32_bf16 v[48:51], v[204:207], v[80:83], v[48:51]
    s_add_u32 s44, s39, 4718592
    v_mfma_f32_16x16x32_bf16 v[52:55], v[204:207], v[84:87], v[52:55]
    v_mov_b32 v90, 0
    v_mfma_f32_16x16x32_bf16 v[56:59], v[208:211], v[80:83], v[56:59]
    v_mov_b32 v91, 0
    v_mfma_f32_16x16x32_bf16 v[60:63], v[208:211], v[84:87], v[60:63]
    buffer_load_dwordx4 a[136:139], v10, s[8:11], s52 offen offset:3072
    buffer_load_dwordx4 a[140:143], v11, s[8:11], s52 offen offset:3072
    s_nop 0
    s_nop 4
    v_add_f32 v16, v16, v40
    v_sub_f32 v17, v17, v41
    v_add_f32 v18, v18, v42
    v_sub_f32 v19, v19, v43
    v_fma_f32 v40, v16, s43, v224
    v_fma_f32 v41, v17, s43, v225
    v_fma_f32 v42, v18, s43, v226
    v_fma_f32 v43, v19, s43, v227
    v_cvt_pk_bf16_f32 v64, v40, v41
    v_cvt_pk_bf16_f32 v65, v42, v43
    v_fmac_f32 v90, v40, v40
    v_fmac_f32 v90, v41, v41
    v_fmac_f32 v90, v42, v42
    v_fmac_f32 v90, v43, v43
    v_add_f32 v20, v20, v44
    v_sub_f32 v21, v21, v45
    v_add_f32 v22, v22, v46
    v_sub_f32 v23, v23, v47
    v_fma_f32 v44, v20, s43, v228
    v_fma_f32 v45, v21, s43, v229
    v_fma_f32 v46, v22, s43, v230
    v_fma_f32 v47, v23, s43, v231
    v_cvt_pk_bf16_f32 v66, v44, v45
    v_cvt_pk_bf16_f32 v67, v46, v47
    v_fmac_f32 v91, v44, v44
    v_fmac_f32 v91, v45, v45
    v_fmac_f32 v91, v46, v46
    v_fmac_f32 v91, v47, v47
    s_nop 0
    v_permlane16_swap_b32 v64, v66
    v_permlane16_swap_b32 v65, v67
    buffer_store_dwordx4 v[64:67], v8, s[8:11], s44 offen offset:0 sc1
    v_add_f32 v24, v24, v48
    v_sub_f32 v25, v25, v49
    v_add_f32 v26, v26, v50
    v_sub_f32 v27, v27, v51
    v_fma_f32 v48, v24, s43, v232
    v_fma_f32 v49, v25, s43, v233
    v_fma_f32 v50, v26, s43, v234
    v_fma_f32 v51, v27, s43, v235
    v_cvt_pk_bf16_f32 v68, v48, v49
    v_cvt_pk_bf16_f32 v69, v50, v51
    v_fmac_f32 v90, v48, v48
    v_fmac_f32 v90, v49, v49
    v_fmac_f32 v90, v50, v50
    v_fmac_f32 v90, v51, v51
    v_add_f32 v28, v28, v52
    v_sub_f32 v29, v29, v53
    v_add_f32 v30, v30, v54
    v_sub_f32 v31, v31, v55
    v_fma_f32 v52, v28, s43, v236
    v_fma_f32 v53, v29, s43, v237
    v_fma_f32 v54, v30, s43, v238
    v_fma_f32 v55, v31, s43, v239
    v_cvt_pk_bf16_f32 v70, v52, v53
    v_cvt_pk_bf16_f32 v71, v54, v55
    v_fmac_f32 v91, v52, v52
    v_fmac_f32 v91, v53, v53
    v_fmac_f32 v91, v54, v54
    v_fmac_f32 v91, v55, v55
    s_nop 0
    v_permlane16_swap_b32 v68, v70
    v_permlane16_swap_b32 v69, v71
    buffer_store_dwordx4 v[68:71], v8, s[8:11], s44 offen offset:512 sc1
    v_add_f32 v32, v32, v56
    v_sub_f32 v33, v33, v57
    v_add_f32 v34, v34, v58
    v_sub_f32 v35, v35, v59
    v_fma_f32 v56, v32, s43, v240
    v_fma_f32 v57, v33, s43, v241
    v_fma_f32 v58, v34, s43, v242
    v_fma_f32 v59, v35, s43, v243
    v_cvt_pk_bf16_f32 v72, v56, v57
    v_cvt_pk_bf16_f32 v73, v58, v59
    v_fmac_f32 v90, v56, v56
    v_fmac_f32 v90, v57, v57
    v_fmac_f32 v90, v58, v58
    v_fmac_f32 v90, v59, v59
    v_add_f32 v36, v36, v60
    v_sub_f32 v37, v37, v61
    v_add_f32 v38, v38, v62
    v_sub_f32 v39, v39, v63
    v_fma_f32 v60, v36, s43, v100
    v_fma_f32 v61, v37, s43, v101
    v_fma_f32 v62, v38, s43, v102
    v_fma_f32 v63, v39, s43, v103
    v_cvt_pk_bf16_f32 v74, v60, v61
    v_cvt_pk_bf16_f32 v75, v62, v63
    v_fmac_f32 v91, v60, v60
    v_fmac_f32 v91, v61, v61
    v_fmac_f32 v91, v62, v62
    v_fmac_f32 v91, v63, v63
    s_nop 0
    v_permlane16_swap_b32 v72, v74
    v_permlane16_swap_b32 v73, v75
    buffer_store_dwordx4 v[72:75], v8, s[8:11], s44 offen offset:1024 sc1
    v_mov_b32 v92, v90
    v_mov_b32 v93, v91
    s_nop 1
    v_permlane32_swap_b32 v90, v92
    v_permlane32_swap_b32 v91, v93
    v_add_f32 v90, v90, v92
    v_add_f32 v91, v91, v93
    v_mov_b32 v92, v90
    v_mov_b32 v93, v91
    s_nop 1
    v_permlane16_swap_b32 v90, v92
    v_permlane16_swap_b32 v91, v93
    v_add_f32 v90, v90, v92
    v_add_f32 v91, v91, v93
    s_add_u32 s46, s41, 47360000
    s_mov_b64 exec, 0xffff
    buffer_store_dwordx2 v[90:91], v13, s[8:11], s46 offen sc1
    s_mov_b64 exec, -1
    s_add_u32 s44, s39, 7077888
    s_add_u32 s47, s42, 47360000
    s_waitcnt vmcnt(0)
    s_add_u32 s46, s55, 47622144
    s_mov_b64 exec, 1
    buffer_store_dword v250, v251, s[8:11], s46 offen sc1
    s_mov_b64 exec, -1
    s_add_u32 s52, s52, 4096
    buffer_load_dwordx4 a[144:147], v4, s[8:11], s52 offen offset:0
    buffer_load_dwordx4 a[148:151], v10, s[8:11], s52 offen offset:0
    buffer_load_dwordx4 a[152:155], v11, s[8:11], s52 offen offset:0
    buffer_load_dwordx4 a[156:159], v4, s[8:11], s52 offen offset:1024
    s_barrier
    buffer_load_dwordx4 a[160:163], v10, s[8:11], s52 offen offset:1024
    buffer_load_dwordx4 a[164:167], v11, s[8:11], s52 offen offset:1024
    buffer_load_dwordx4 a[168:171], v4, s[8:11], s52 offen offset:2048
    buffer_load_dwordx4 a[172:175], v10, s[8:11], s52 offen offset:2048
    buffer_load_dwordx4 a[176:179], v11, s[8:11], s52 offen offset:2048
    buffer_load_dwordx4 a[180:183], v4, s[8:11], s52 offen offset:3072
    buffer_load_dwordx4 a[184:187], v10, s[8:11], s52 offen offset:3072
    buffer_load_dwordx4 a[188:191], v11, s[8:11], s52 offen offset:3072
    s_add_u32 s52, s52, 4096
    buffer_load_dwordx4 a[192:195], v4, s[8:11], s52 offen offset:0
    buffer_load_dwordx4 a[196:199], v10, s[8:11], s52 offen offset:0
    buffer_load_dwordx4 a[200:203], v11, s[8:11], s52 offen offset:0
    buffer_load_dwordx4 a[204:207], v4, s[8:11], s52 offen offset:1024
    buffer_load_dwordx4 a[208:211], v10, s[8:11], s52 offen offset:1024
    buffer_load_dwordx4 a[212:215], v11, s[8:11], s52 offen offset:1024
    v_bfe_u32 v90, v3, 2, 1
    v_lshlrev_b32 v90, 4, v90
    v_lshrrev_b32 v91, 3, v3
    v_lshl_add_u32 v90, v91, 2, v90
    v_and_b32 v91, 3, v3
    s_lshl_b32 s48, s25, 5
    s_lshr_b32 s49, s3, 1
    s_lshl_b32 s49, s49, 3
    s_add_u32 s48, s48, s49
    v_add3_u32 v245, v90, v91, s48
    v_mov_b32 v95, 2048
    v_lshlrev_b32 v91, 8, v2
    v_add_u32 v90, -1, v245
    v_cmp_lt_u32 vcc, v90, v95
    v_bfe_u32 v92, v90, 5, 6
    v_mul_u32_u24 v92, 36864, v92
    v_bfe_u32 v93, v90, 3, 1
    v_mul_u32_u24 v93, 18432, v93
    v_bfe_u32 v94, v90, 2, 1
    v_lshl_add_u32 v92, v94, 7, v92
    v_bfe_u32 v94, v90, 4, 1
    v_lshl_add_u32 v92, v94, 6, v92
    v_and_b32 v94, 3, v90
    v_lshl_add_u32 v92, v94, 4, v92
    v_add3_u32 v92, v92, v93, v91
    v_bfrev_b32 v93, 2
    v_cndmask_b32 v240, v93, v92, vcc
    v_add_u32 v90, 1, v245
    v_cmp_lt_u32 vcc, v90, v95
    v_bfe_u32 v92, v90, 5, 6
    v_mul_u32_u24 v92, 36864, v92
    v_bfe_u32 v93, v90, 3, 1
    v_mul_u32_u24 v93, 18432, v93
    v_bfe_u32 v94, v90, 2, 1
    v_lshl_add_u32 v92, v94, 7, v92
    v_bfe_u32 v94, v90, 4, 1
    v_lshl_add_u32 v92, v94, 6, v92
    v_and_b32 v94, 3, v90
    v_lshl_add_u32 v92, v94, 4, v92
    v_add3_u32 v92, v92, v93, v91
    v_bfrev_b32 v93, 2
    v_cndmask_b32 v241, v93, v92, vcc
    v_add_u32 v90, -2, v245
    v_cmp_lt_u32 vcc, v90, v95
    v_bfe_u32 v92, v90, 5, 6
    v_mul_u32_u24 v92, 36864, v92
    v_bfe_u32 v93, v90, 3, 1
    v_mul_u32_u24 v93, 18432, v93
    v_bfe_u32 v94, v90, 2, 1
    v_lshl_add_u32 v92, v94, 7, v92
    v_bfe_u32 v94, v90, 4, 1
    v_lshl_add_u32 v92, v94, 6, v92
    v_and_b32 v94, 3, v90
    v_lshl_add_u32 v92, v94, 4, v92
    v_add3_u32 v92, v92, v93, v91
    v_bfrev_b32 v93, 2
    v_cndmask_b32 v242, v93, v92, vcc
    v_add_u32 v90, 2, v245
    v_cmp_lt_u32 vcc, v90, v95
    v_bfe_u32 v92, v90, 5, 6
    v_mul_u32_u24 v92, 36864, v92
    v_bfe_u32 v93, v90, 3, 1
    v_mul_u32_u24 v93, 18432, v93
    v_bfe_u32 v94, v90, 2, 1
    v_lshl_add_u32 v92, v94, 7, v92
    v_bfe_u32 v94, v90, 4, 1
    v_lshl_add_u32 v92, v94, 6, v92
    v_and_b32 v94, 3, v90
    v_lshl_add_u32 v92, v94, 4, v92
    v_add3_u32 v92, v92, v93, v91
    v_bfrev_b32 v93, 2
    v_cndmask_b32 v243, v93, v92, vcc
    v_cmp_gt_u32 vcc, 2, v2
    s_bitcmp1_b32 s3, 0
    s_cselect_b64 s[48:49], -1, 0
    v_cndmask_b32 v92, v241, v240, vcc
    v_cndmask_b32 v93, v243, v242, vcc
    v_cndmask_b32 v244, v92, v241, s[48:49]
    v_cndmask_b32 v245, v241, v242, s[48:49]
    v_cndmask_b32 v246, v242, v93, s[48:49]
    s_and_b32 s54, s3, 1
    s_lshl_b32 s54, s54, 10
    s_add_u32 s54, s54, 7077888
    s_barrier
    s_add_u32 s46, s53, 4718592
    s_add_u32 m0, s59, 0
    s_nop 0
    buffer_load_dwordx4 v4, s[8:11], s46 offen offset:0 sc1 lds
    buffer_load_dwordx4 v4, s[8:11], s46 offen offset:2048 sc1 lds
    s_add_u32 m0, s59, 4096
    s_add_u32 s46, s46, 4096
    buffer_load_dwordx4 v4, s[8:11], s46 offen offset:0 sc1 lds
    buffer_load_dwordx4 v4, s[8:11], s46 offen offset:2048 sc1 lds
    s_add_u32 m0, s59, 8192
    s_add_u32 s46, s46, 4096
    buffer_load_dwordx4 v4, s[8:11], s46 offen offset:0 sc1 lds
    buffer_load_dwordx4 v4, s[8:11], s46 offen offset:2048 sc1 lds
    s_add_u32 m0, s59, 12288
    s_add_u32 s46, s46, 4096
    buffer_load_dwordx4 v4, s[8:11], s46 offen offset:0 sc1 lds
    buffer_load_dwordx4 v4, s[8:11], s46 offen offset:2048 sc1 lds
    s_add_u32 m0, s59, 16384
    s_add_u32 s46, s46, 4096
    buffer_load_dwordx4 v4, s[8:11], s46 offen offset:0 sc1 lds
    buffer_load_dwordx2 v[96:97], v12, s[8:11], s47 offen offset:0 sc1
    buffer_load_dwordx2 v[98:99], v12, s[8:11], s47 offen offset:128 sc1
    buffer_load_dwordx2 v[100:101], v12, s[8:11], s47 offen offset:256 sc1
    s_waitcnt vmcnt(10)
    s_barrier
    ds_read_b128 v[64:67], v4 offset:0
    ds_read_b128 v[68:71], v4 offset:18432
    ds_read_b128 v[72:75], v4 offset:1024
    ds_read_b128 v[76:79], v4 offset:19456
    ds_read_b128 v[80:83], v4 offset:2048
    ds_read_b128 v[84:87], v4 offset:20480
    s_waitcnt lgkmcnt(4)
    v_mfma_f32_16x16x32_bf16 v[16:19], a[0:3], v[64:67], 0
    v_mfma_f32_16x16x32_bf16 v[20:23], a[0:3], v[68:71], 0
    v_mfma_f32_16x16x32_bf16 v[24:27], a[4:7], v[64:67], 0
    v_mfma_f32_16x16x32_bf16 v[28:31], a[4:7], v[68:71], 0
    v_mfma_f32_16x16x32_bf16 v[32:35], a[8:11], v[64:67], 0
    v_mfma_f32_16x16x32_bf16 v[36:39], a[8:11], v[68:71], 0
    s_add_u32 s52, s36, 46669824
    buffer_load_dwordx4 v[104:107], v4, s[8:11], s52 offen offset:0
    buffer_load_dwordx4 v[108:111], v10, s[8:11], s52 offen offset:0
    ds_read_b128 v[64:67], v4 offset:3072
    ds_read_b128 v[68:71], v4 offset:21504
    s_waitcnt lgkmcnt(4)
    v_mfma_f32_16x16x32_bf16 v[16:19], a[12:15], v[72:75], v[16:19]
    v_mfma_f32_16x16x32_bf16 v[20:23], a[12:15], v[76:79], v[20:23]
    v_mfma_f32_16x16x32_bf16 v[24:27], a[16:19], v[72:75], v[24:27]
    v_mfma_f32_16x16x32_bf16 v[28:31], a[16:19], v[76:79], v[28:31]
    v_mfma_f32_16x16x32_bf16 v[32:35], a[20:23], v[72:75], v[32:35]
    v_mfma_f32_16x16x32_bf16 v[36:39], a[20:23], v[76:79], v[36:39]
    buffer_load_dwordx4 v[112:115], v11, s[8:11], s52 offen offset:0
    buffer_load_dwordx4 v[116:119], v4, s[8:11], s52 offen offset:1024
    s_waitcnt vmcnt(11)
    s_barrier
    ds_read_b128 v[72:75], v4 offset:4096
    ds_read_b128 v[76:79], v4 offset:22528
    s_waitcnt lgkmcnt(4)
    v_mfma_f32_16x16x32_bf16 v[16:19], a[24:27], v[80:83], v[16:19]
    s_waitcnt vmcnt(4)
    v_mfma_f32_16x16x32_bf16 v[20:23], a[24:27], v[84:87], v[20:23]
    v_add_f32 v97, v97, v99
    v_mfma_f32_16x16x32_bf16 v[24:27], a[28:31], v[80:83], v[24:27]
    v_mfma_f32_16x16x32_bf16 v[28:31], a[28:31], v[84:87], v[28:31]
    v_add_f32 v96, v96, v98
    v_mfma_f32_16x16x32_bf16 v[32:35], a[32:35], v[80:83], v[32:35]
    v_mfma_f32_16x16x32_bf16 v[36:39], a[32:35], v[84:87], v[36:39]
    v_add_f32 v96, v96, v100
    buffer_load_dwordx4 v[120:123], v10, s[8:11], s52 offen offset:1024
    buffer_load_dwordx4 v[124:127], v11, s[8:11], s52 offen offset:1024
    ds_read_b128 v[80:83], v4 offset:5120
    ds_read_b128 v[84:87], v4 offset:23552
    s_waitcnt lgkmcnt(4)
    v_mfma_f32_16x16x32_bf16 v[16:19], a[36:39], v[64:67], v[16:19]
    v_mfma_f32_16x16x32_bf16 v[20:23], a[36:39], v[68:71], v[20:23]
    v_add_f32 v100, v97, v101
    v_mfma_f32_16x16x32_bf16 v[24:27], a[40:43], v[64:67], v[24:27]
    v_mfma_f32_16x16x32_bf16 v[28:31], a[40:43], v[68:71], v[28:31]
    v_mov_b32 v92, v96
    v_mfma_f32_16x16x32_bf16 v[32:35], a[44:47], v[64:67], v[32:35]
    v_mfma_f32_16x16x32_bf16 v[36:39], a[44:47], v[68:71], v[36:39]
    v_mov_b32 v93, v100
    buffer_load_dwordx4 v[128:131], v4, s[8:11], s52 offen offset:2048
    buffer_load_dwordx4 v[132:135], v10, s[8:11], s52 offen offset:2048
    ds_read_b128 v[64:67], v4 offset:6144
    ds_read_b128 v[68:71], v4 offset:24576
    s_waitcnt lgkmcnt(4)
    v_mfma_f32_16x16x32_bf16 v[16:19], a[48:51], v[72:75], v[16:19]
    v_mfma_f32_16x16x32_bf16 v[20:23], a[48:51], v[76:79], v[20:23]
    s_nop 1
    v_mfma_f32_16x16x32_bf16 v[24:27], a[52:55], v[72:75], v[24:27]
    v_mfma_f32_16x16x32_bf16 v[28:31], a[52:55], v[76:79], v[28:31]
    v_permlane32_swap_b32 v96, v92
    v_mfma_f32_16x16x32_bf16 v[32:35], a[56:59], v[72:75], v[32:35]
    v_mfma_f32_16x16x32_bf16 v[36:39], a[56:59], v[76:79], v[36:39]
    v_permlane32_swap_b32 v100, v93
    buffer_load_dwordx4 v[136:139], v11, s[8:11], s52 offen offset:2048
    buffer_load_dwordx4 v[140:143], v4, s[8:11], s52 offen offset:3072
    ds_read_b128 v[72:75], v4 offset:7168
    ds_read_b128 v[76:79], v4 offset:25600
    s_waitcnt lgkmcnt(4)
    v_mfma_f32_16x16x32_bf16 v[16:19], a[60:63], v[80:83], v[16:19]
    v_mfma_f32_16x16x32_bf16 v[20:23], a[60:63], v[84:87], v[20:23]
    v_add_f32 v96, v96, v92
    v_mfma_f32_16x16x32_bf16 v[24:27], a[64:67], v[80:83], v[24:27]
    v_mfma_f32_16x16x32_bf16 v[28:31], a[64:67], v[84:87], v[28:31]
    v_add_f32 v100, v100, v93
    v_mfma_f32_16x16x32_bf16 v[32:35], a[68:71], v[80:83], v[32:35]
    v_mov_b32 v92, v96
    v_mfma_f32_16x16x32_bf16 v[36:39], a[68:71], v[84:87], v[36:39]
    buffer_load_dwordx4 v[144:147], v10, s[8:11], s52 offen offset:3072
    buffer_load_dwordx4 v[148:151], v11, s[8:11], s52 offen offset:3072
    ds_read_b128 v[80:83], v4 offset:8192
    ds_read_b128 v[84:87], v4 offset:26624
    s_waitcnt lgkmcnt(4)
    v_mfma_f32_16x16x32_bf16 v[16:19], a[72:75], v[64:67], v[16:19]
    v_mov_b32 v93, v100
    v_mfma_f32_16x16x32_bf16 v[20:23], a[72:75], v[68:71], v[20:23]
    v_mfma_f32_16x16x32_bf16 v[24:27], a[76:79], v[64:67], v[24:27]
    s_nop 1
    v_mfma_f32_16x16x32_bf16 v[28:31], a[76:79], v[68:71], v[28:31]
    v_mfma_f32_16x16x32_bf16 v[32:35], a[80:83], v[64:67], v[32:35]
    v_permlane16_swap_b32 v96, v92
    v_mfma_f32_16x16x32_bf16 v[36:39], a[80:83], v[68:71], v[36:39]
    s_add_u32 s52, s52, 4096
    buffer_load_dwordx4 v[152:155], v4, s[8:11], s52 offen offset:0
    buffer_load_dwordx4 v[156:159], v10, s[8:11], s52 offen offset:0
    ds_read_b128 v[64:67], v4 offset:9216
    ds_read_b128 v[68:71], v4 offset:27648
    s_waitcnt lgkmcnt(4)
    v_mfma_f32_16x16x32_bf16 v[16:19], a[84:87], v[72:75], v[16:19]
    v_permlane16_swap_b32 v100, v93
    v_mfma_f32_16x16x32_bf16 v[20:23], a[84:87], v[76:79], v[20:23]
    v_mfma_f32_16x16x32_bf16 v[24:27], a[88:91], v[72:75], v[24:27]
    v_add_f32 v96, v96, v92
    v_mfma_f32_16x16x32_bf16 v[28:31], a[88:91], v[76:79], v[28:31]
    v_mfma_f32_16x16x32_bf16 v[32:35], a[92:95], v[72:75], v[32:35]
    v_add_f32 v100, v100, v93
    v_mfma_f32_16x16x32_bf16 v[36:39], a[92:95], v[76:79], v[36:39]
    buffer_load_dwordx4 v[160:163], v11, s[8:11], s52 offen offset:0
    buffer_load_dwordx4 v[164:167], v4, s[8:11], s52 offen offset:1024
    s_barrier
    ds_read_b128 v[72:75], v4 offset:10240
    ds_read_b128 v[76:79], v4 offset:28672
    s_waitcnt lgkmcnt(4)
    v_mfma_f32_16x16x32_bf16 v[16:19], a[96:99], v[80:83], v[16:19]
    v_mul_f32 v96, 0x3ae38e39, v96
    v_mfma_f32_16x16x32_bf16 v[20:23], a[96:99], v[84:87], v[20:23]
    v_mfma_f32_16x16x32_bf16 v[24:27], a[100:103], v[80:83], v[24:27]
    v_mul_f32 v100, 0x3ae38e39, v100
    v_mfma_f32_16x16x32_bf16 v[28:31], a[100:103], v[84:87], v[28:31]
    v_mfma_f32_16x16x32_bf16 v[32:35], a[104:107], v[80:83], v[32:35]
    v_add_f32 v88, 0x3727c5ac, v96
    v_mfma_f32_16x16x32_bf16 v[36:39], a[104:107], v[84:87], v[36:39]
    buffer_load_dwordx4 v[168:171], v10, s[8:11], s52 offen offset:1024
    buffer_load_dwordx4 v[172:175], v11, s[8:11], s52 offen offset:1024
    ds_read_b128 v[80:83], v4 offset:11264
    ds_read_b128 v[84:87], v4 offset:29696
    s_waitcnt lgkmcnt(4)
    v_mfma_f32_16x16x32_bf16 v[16:19], a[108:111], v[64:67], v[16:19]
    v_add_f32 v89, 0x3727c5ac, v100
    v_mfma_f32_16x16x32_bf16 v[20:23], a[108:111], v[68:71], v[20:23]
    v_mfma_f32_16x16x32_bf16 v[24:27], a[112:115], v[64:67], v[24:27]
    v_rsq_f32 v88, v88
    v_mfma_f32_16x16x32_bf16 v[28:31], a[112:115], v[68:71], v[28:31]
    v_rsq_f32 v89, v89
    v_mfma_f32_16x16x32_bf16 v[32:35], a[116:119], v[64:67], v[32:35]
    v_mfma_f32_16x16x32_bf16 v[36:39], a[116:119], v[68:71], v[36:39]
    s_nop 0
    buffer_load_dwordx4 v[176:179], v4, s[8:11], s52 offen offset:2048
    buffer_load_dwordx4 v[180:183], v10, s[8:11], s52 offen offset:2048
    ds_read_b128 v[64:67], v4 offset:12288
    ds_read_b128 v[68:71], v4 offset:30720
    s_waitcnt lgkmcnt(4)
    v_mfma_f32_16x16x32_bf16 v[16:19], a[120:123], v[72:75], v[16:19]
    v_mfma_f32_16x16x32_bf16 v[20:23], a[120:123], v[76:79], v[20:23]
    v_mul_f32 v98, v88, v88
    v_mfma_f32_16x16x32_bf16 v[24:27], a[124:127], v[72:75], v[24:27]
    v_mfma_f32_16x16x32_bf16 v[28:31], a[124:127], v[76:79], v[28:31]
    v_mul_f32 v102, v89, v89
    v_mfma_f32_16x16x32_bf16 v[32:35], a[128:131], v[72:75], v[32:35]
    v_mfma_f32_16x16x32_bf16 v[36:39], a[128:131], v[76:79], v[36:39]
    v_mul_f32 v98, v98, v96
    buffer_load_dwordx4 v[184:187], v11, s[8:11], s52 offen offset:2048
    buffer_load_dwordx4 v[188:191], v4, s[8:11], s52 offen offset:3072
    ds_read_b128 v[72:75], v4 offset:13312
    ds_read_b128 v[76:79], v4 offset:31744
    s_waitcnt lgkmcnt(4)
    v_mfma_f32_16x16x32_bf16 v[16:19], a[132:135], v[80:83], v[16:19]
    v_mfma_f32_16x16x32_bf16 v[20:23], a[132:135], v[84:87], v[20:23]
    v_mul_f32 v102, v102, v100
    v_mfma_f32_16x16x32_bf16 v[24:27], a[136:139], v[80:83], v[24:27]
    v_mfma_f32_16x16x32_bf16 v[28:31], a[136:139], v[84:87], v[28:31]
    v_add_f32 v98, 0x3727c5ac, v98
    v_mfma_f32_16x16x32_bf16 v[32:35], a[140:143], v[80:83], v[32:35]
    v_mfma_f32_16x16x32_bf16 v[36:39], a[140:143], v[84:87], v[36:39]
    v_add_f32 v102, 0x3727c5ac, v102
    buffer_load_dwordx4 v[192:195], v10, s[8:11], s52 offen offset:3072
    buffer_load_dwordx4 v[196:199], v11, s[8:11], s52 offen offset:3072
    ds_read_b128 v[80:83], v4 offset:14336
    ds_read_b128 v[84:87], v4 offset:32768
    s_waitcnt lgkmcnt(4)
    v_mfma_f32_16x16x32_bf16 v[16:19], a[144:147], v[64:67], v[16:19]
    v_mfma_f32_16x16x32_bf16 v[20:23], a[144:147], v[68:71], v[20:23]
    v_rsq_f32 v98, v98
    v_mfma_f32_16x16x32_bf16 v[24:27], a[148:151], v[64:67], v[24:27]
    v_mfma_f32_16x16x32_bf16 v[28:31], a[148:151], v[68:71], v[28:31]
    v_rsq_f32 v102, v102
    v_mfma_f32_16x16x32_bf16 v[32:35], a[152:155], v[64:67], v[32:35]
    v_mfma_f32_16x16x32_bf16 v[36:39], a[152:155], v[68:71], v[36:39]
    s_nop 0
    s_add_u32 s52, s52, 4096
    buffer_load_dwordx4 v[200:203], v4, s[8:11], s52 offen offset:0
    buffer_load_dwordx4 v[204:207], v10, s[8:11], s52 offen offset:0
    ds_read_b128 v[64:67], v4 offset:15360
    ds_read_b128 v[68:71], v4 offset:33792
    s_waitcnt lgkmcnt(4)
    v_mfma_f32_16x16x32_bf16 v[16:19], a[156:159], v[72:75], v[16:19]
    v_mfma_f32_16x16x32_bf16 v[20:23], a[156:159], v[76:79], v[20:23]
    v_mul_f32 v96, v88, v98
    v_mfma_f32_16x16x32_bf16 v[24:27], a[160:163], v[72:75], v[24:27]
    v_mul_f32 v100, v89, v102
    v_mfma_f32_16x16x32_bf16 v[28:31], a[160:163], v[76:79], v[28:31]
    v_mfma_f32_16x16x32_bf16 v[32:35], a[164:167], v[72:75], v[32:35]
    v_rcp_f32 v99, v96
    v_mfma_f32_16x16x32_bf16 v[36:39], a[164:167], v[76:79], v[36:39]
    buffer_load_dwordx4 v[208:211], v11, s[8:11], s52 offen offset:0
    buffer_load_dwordx4 v[212:215], v4, s[8:11], s52 offen offset:1024
    ds_read_b128 v[72:75], v4 offset:16384
    ds_read_b128 v[76:79], v4 offset:34816
    s_waitcnt lgkmcnt(4)
    v_mfma_f32_16x16x32_bf16 v[16:19], a[168:171], v[80:83], v[16:19]
    v_mul_f32 v97, 0xc0135761, v96
    v_mfma_f32_16x16x32_bf16 v[20:23], a[168:171], v[84:87], v[20:23]
    v_mfma_f32_16x16x32_bf16 v[24:27], a[172:175], v[80:83], v[24:27]
    v_mul_f32 v98, v96, v96
    v_mfma_f32_16x16x32_bf16 v[28:31], a[172:175], v[84:87], v[28:31]
    v_mfma_f32_16x16x32_bf16 v[32:35], a[176:179], v[80:83], v[32:35]
    v_mul_f32 v98, v98, v96
    v_mfma_f32_16x16x32_bf16 v[36:39], a[176:179], v[84:87], v[36:39]
    buffer_load_dwordx4 v[216:219], v10, s[8:11], s52 offen offset:1024
    buffer_load_dwordx4 v[220:223], v11, s[8:11], s52 offen offset:1024
    ds_read_b128 v[80:83], v4 offset:17408
    ds_read_b128 v[84:87], v4 offset:35840
    s_waitcnt lgkmcnt(4)
    v_mfma_f32_16x16x32_bf16 v[16:19], a[180:183], v[64:67], v[16:19]
    v_mul_f32 v98, 0xbdd2d3e8, v98
    v_mfma_f32_16x16x32_bf16 v[20:23], a[180:183], v[68:71], v[20:23]
    v_mfma_f32_16x16x32_bf16 v[24:27], a[184:187], v[64:67], v[24:27]
    v_rcp_f32 v103, v100
    v_mfma_f32_16x16x32_bf16 v[28:31], a[184:187], v[68:71], v[28:31]
    v_mfma_f32_16x16x32_bf16 v[32:35], a[188:191], v[64:67], v[32:35]
    v_mul_f32 v101, 0xc0135761, v100
    v_mfma_f32_16x16x32_bf16 v[36:39], a[188:191], v[68:71], v[36:39]
    buffer_load_dwordx4 v[224:227], v4, s[8:11], s52 offen offset:2048
    buffer_load_dwordx4 v[228:231], v10, s[8:11], s52 offen offset:2048
    s_waitcnt lgkmcnt(2)
    v_mfma_f32_16x16x32_bf16 v[16:19], a[192:195], v[72:75], v[16:19]
    v_mul_f32 v102, v100, v100
    v_mfma_f32_16x16x32_bf16 v[20:23], a[192:195], v[76:79], v[20:23]
    v_mfma_f32_16x16x32_bf16 v[24:27], a[196:199], v[72:75], v[24:27]
    v_mul_f32 v102, v102, v100
    v_mfma_f32_16x16x32_bf16 v[28:31], a[196:199], v[76:79], v[28:31]
    v_mfma_f32_16x16x32_bf16 v[32:35], a[200:203], v[72:75], v[32:35]
    v_mul_f32 v102, 0xbdd2d3e8, v102
    v_mfma_f32_16x16x32_bf16 v[36:39], a[200:203], v[76:79], v[36:39]
    buffer_load_dwordx4 a[216:219], v11, s[8:11], s52 offen offset:2048
    buffer_load_dwordx4 a[220:223], v4, s[8:11], s52 offen offset:3072
    s_waitcnt lgkmcnt(0)
    v_mfma_f32_16x16x32_bf16 v[16:19], a[204:207], v[80:83], v[16:19]
    v_mfma_f32_16x16x32_bf16 v[20:23], a[204:207], v[84:87], v[20:23]
    v_mfma_f32_16x16x32_bf16 v[24:27], a[208:211], v[80:83], v[24:27]
    v_mfma_f32_16x16x32_bf16 v[28:31], a[208:211], v[84:87], v[28:31]
    v_mfma_f32_16x16x32_bf16 v[32:35], a[212:215], v[80:83], v[32:35]
    v_mfma_f32_16x16x32_bf16 v[36:39], a[212:215], v[84:87], v[36:39]
    buffer_load_dwordx4 a[224:227], v10, s[8:11], s52 offen offset:3072
    buffer_load_dwordx4 a[228:231], v11, s[8:11], s52 offen offset:3072
    s_nop 0
    s_nop 4
    v_mul_f32 v92, v16, v16
    v_mul_f32 v93, v17, v17
    v_mul_f32 v94, v18, v18
    v_mul_f32 v95, v19, v19
    v_fma_f32 v92, v92, v98, v97
    v_fma_f32 v93, v93, v98, v97
    v_fma_f32 v94, v94, v98, v97
    v_fma_f32 v95, v95, v98, v97
    v_mul_f32 v92, v92, v16
    v_mul_f32 v93, v93, v17
    v_mul_f32 v94, v94, v18
    v_mul_f32 v95, v95, v19
    v_exp_f32 v92, v92
    v_exp_f32 v93, v93
    v_exp_f32 v94, v94
    v_exp_f32 v95, v95
    v_fma_f32 v92, v92, v99, v99
    v_fma_f32 v93, v93, v99, v99
    v_fma_f32 v94, v94, v99, v99
    v_fma_f32 v95, v95, v99, v99
    v_rcp_f32 v92, v92
    v_rcp_f32 v93, v93
    v_rcp_f32 v94, v94
    v_rcp_f32 v95, v95
    v_mul_f32 v92, v92, v16
    v_mul_f32 v93, v93, v17
    v_mul_f32 v94, v94, v18
    v_mul_f32 v95, v95, v19
    v_cvt_pk_bf16_f32 v64, v92, v93
    v_cvt_pk_bf16_f32 v65, v94, v95
    v_mul_f32 v92, v20, v20
    v_mul_f32 v93, v21, v21
    v_mul_f32 v94, v22, v22
    v_mul_f32 v95, v23, v23
    v_fma_f32 v92, v92, v102, v101
    v_fma_f32 v93, v93, v102, v101
    v_fma_f32 v94, v94, v102, v101
    v_fma_f32 v95, v95, v102, v101
    v_mul_f32 v92, v92, v20
    v_mul_f32 v93, v93, v21
    v_mul_f32 v94, v94, v22
    v_mul_f32 v95, v95, v23
    v_exp_f32 v92, v92
    v_exp_f32 v93, v93
    v_exp_f32 v94, v94
    v_exp_f32 v95, v95
    v_fma_f32 v92, v92, v103, v103
    v_fma_f32 v93, v93, v103, v103
    v_fma_f32 v94, v94, v103, v103
    v_fma_f32 v95, v95, v103, v103
    v_rcp_f32 v92, v92
    v_rcp_f32 v93, v93
    v_rcp_f32 v94, v94
    v_rcp_f32 v95, v95
    v_mul_f32 v92, v92, v20
    v_mul_f32 v93, v93, v21
    v_mul_f32 v94, v94, v22
    v_mul_f32 v95, v95, v23
    v_cvt_pk_bf16_f32 v66, v92, v93
    v_cvt_pk_bf16_f32 v67, v94, v95
    s_nop 0
    s_nop 0
    v_permlane16_swap_b32 v64, v66
    v_permlane16_swap_b32 v65, v67
    buffer_store_dwordx4 v[64:67], v8, s[8:11], s44 offen offset:0 sc1
    v_mul_f32 v92, v24, v24
    v_mul_f32 v93, v25, v25
    v_mul_f32 v94, v26, v26
    v_mul_f32 v95, v27, v27
    v_fma_f32 v92, v92, v98, v97
    v_fma_f32 v93, v93, v98, v97
    v_fma_f32 v94, v94, v98, v97
    v_fma_f32 v95, v95, v98, v97
    v_mul_f32 v92, v92, v24
    v_mul_f32 v93, v93, v25
    v_mul_f32 v94, v94, v26
    v_mul_f32 v95, v95, v27
    v_exp_f32 v92, v92
    v_exp_f32 v93, v93
    v_exp_f32 v94, v94
    v_exp_f32 v95, v95
    v_fma_f32 v92, v92, v99, v99
    v_fma_f32 v93, v93, v99, v99
    v_fma_f32 v94, v94, v99, v99
    v_fma_f32 v95, v95, v99, v99
    v_rcp_f32 v92, v92
    v_rcp_f32 v93, v93
    v_rcp_f32 v94, v94
    v_rcp_f32 v95, v95
    v_mul_f32 v92, v92, v24
    v_mul_f32 v93, v93, v25
    v_mul_f32 v94, v94, v26
    v_mul_f32 v95, v95, v27
    v_cvt_pk_bf16_f32 v68, v92, v93
    v_cvt_pk_bf16_f32 v69, v94, v95
    v_mul_f32 v92, v28, v28
    v_mul_f32 v93, v29, v29
    v_mul_f32 v94, v30, v30
    v_mul_f32 v95, v31, v31
    v_fma_f32 v92, v92, v102, v101
    v_fma_f32 v93, v93, v102, v101
    v_fma_f32 v94, v94, v102, v101
    v_fma_f32 v95, v95, v102, v101
    v_mul_f32 v92, v92, v28
    v_mul_f32 v93, v93, v29
    v_mul_f32 v94, v94, v30
    v_mul_f32 v95, v95, v31
    v_exp_f32 v92, v92
    v_exp_f32 v93, v93
    v_exp_f32 v94, v94
    v_exp_f32 v95, v95
    v_fma_f32 v92, v92, v103, v103
    v_fma_f32 v93, v93, v103, v103
    v_fma_f32 v94, v94, v103, v103
    v_fma_f32 v95, v95, v103, v103
    v_rcp_f32 v92, v92
    v_rcp_f32 v93, v93
    v_rcp_f32 v94, v94
    v_rcp_f32 v95, v95
    v_mul_f32 v92, v92, v28
    v_mul_f32 v93, v93, v29
    v_mul_f32 v94, v94, v30
    v_mul_f32 v95, v95, v31
    v_cvt_pk_bf16_f32 v70, v92, v93
    v_cvt_pk_bf16_f32 v71, v94, v95
    s_nop 0
    s_nop 0
    v_permlane16_swap_b32 v68, v70
    v_permlane16_swap_b32 v69, v71
    buffer_store_dwordx4 v[68:71], v8, s[8:11], s44 offen offset:512 sc1
    v_mul_f32 v92, v32, v32
    v_mul_f32 v93, v33, v33
    v_mul_f32 v94, v34, v34
    v_mul_f32 v95, v35, v35
    v_fma_f32 v92, v92, v98, v97
    v_fma_f32 v93, v93, v98, v97
    v_fma_f32 v94, v94, v98, v97
    v_fma_f32 v95, v95, v98, v97
    v_mul_f32 v92, v92, v32
    v_mul_f32 v93, v93, v33
    v_mul_f32 v94, v94, v34
    v_mul_f32 v95, v95, v35
    v_exp_f32 v92, v92
    v_exp_f32 v93, v93
    v_exp_f32 v94, v94
    v_exp_f32 v95, v95
    v_fma_f32 v92, v92, v99, v99
    v_fma_f32 v93, v93, v99, v99
    v_fma_f32 v94, v94, v99, v99
    v_fma_f32 v95, v95, v99, v99
    v_rcp_f32 v92, v92
    v_rcp_f32 v93, v93
    v_rcp_f32 v94, v94
    v_rcp_f32 v95, v95
    v_mul_f32 v92, v92, v32
    v_mul_f32 v93, v93, v33
    v_mul_f32 v94, v94, v34
    v_mul_f32 v95, v95, v35
    v_cvt_pk_bf16_f32 v72, v92, v93
    v_cvt_pk_bf16_f32 v73, v94, v95
    v_mul_f32 v92, v36, v36
    v_mul_f32 v93, v37, v37
    v_mul_f32 v94, v38, v38
    v_mul_f32 v95, v39, v39
    v_fma_f32 v92, v92, v102, v101
    v_fma_f32 v93, v93, v102, v101
    v_fma_f32 v94, v94, v102, v101
    v_fma_f32 v95, v95, v102, v101
    v_mul_f32 v92, v92, v36
    v_mul_f32 v93, v93, v37
    v_mul_f32 v94, v94, v38
    v_mul_f32 v95, v95, v39
    v_exp_f32 v92, v92
    v_exp_f32 v93, v93
    v_exp_f32 v94, v94
    v_exp_f32 v95, v95
    v_fma_f32 v92, v92, v103, v103
    v_fma_f32 v93, v93, v103, v103
    v_fma_f32 v94, v94, v103, v103
    v_fma_f32 v95, v95, v103, v103
    v_rcp_f32 v92, v92
    v_rcp_f32 v93, v93
    v_rcp_f32 v94, v94
    v_rcp_f32 v95, v95
    v_mul_f32 v92, v92, v36
    v_mul_f32 v93, v93, v37
    v_mul_f32 v94, v94, v38
    v_mul_f32 v95, v95, v39
    v_cvt_pk_bf16_f32 v74, v92, v93
    v_cvt_pk_bf16_f32 v75, v94, v95
    s_nop 0
    s_nop 0
    v_permlane16_swap_b32 v72, v74
    v_permlane16_swap_b32 v73, v75
    buffer_store_dwordx4 v[72:75], v8, s[8:11], s44 offen offset:1024 sc1
    s_add_u32 s44, s39, 9437184
    v_lshlrev_b32 v98, 2, v3
    v_mov_b32 v90, 0
    v_mov_b32 v91, 0
    s_waitcnt vmcnt(0)
    s_add_u32 s46, s55, 47630336
    s_mov_b64 exec, 1
    buffer_store_dword v250, v251, s[8:11], s46 offen sc1
    s_mov_b64 exec, -1
    s_add_u32 s52, s52, 4096
    buffer_load_dwordx4 a[232:235], v4, s[8:11], s52 offen offset:0
    buffer_load_dwordx4 a[236:239], v10, s[8:11], s52 offen offset:0
    buffer_load_dwordx4 a[240:243], v11, s[8:11], s52 offen offset:0
    buffer_load_dwordx4 a[244:247], v4, s[8:11], s52 offen offset:1024
    s_barrier
    buffer_load_dwordx4 a[248:251], v10, s[8:11], s52 offen offset:1024
    buffer_load_dwordx4 a[252:255], v11, s[8:11], s52 offen offset:1024
    buffer_load_dwordx4 a[0:3], v4, s[8:11], s52 offen offset:2048
    buffer_load_dwordx4 a[4:7], v10, s[8:11], s52 offen offset:2048
    buffer_load_dwordx4 a[8:11], v11, s[8:11], s52 offen offset:2048
    buffer_load_dwordx4 a[12:15], v4, s[8:11], s52 offen offset:3072
    buffer_load_dwordx4 a[16:19], v10, s[8:11], s52 offen offset:3072
    buffer_load_dwordx4 a[20:23], v11, s[8:11], s52 offen offset:3072
    s_add_u32 s52, s52, 4096
    buffer_load_dwordx4 a[24:27], v4, s[8:11], s52 offen offset:0
    buffer_load_dwordx4 a[28:31], v10, s[8:11], s52 offen offset:0
    buffer_load_dwordx4 a[32:35], v11, s[8:11], s52 offen offset:0
    buffer_load_dwordx4 a[36:39], v4, s[8:11], s52 offen offset:1024
    buffer_load_dwordx4 a[40:43], v10, s[8:11], s52 offen offset:1024
    buffer_load_dwordx4 a[44:47], v11, s[8:11], s52 offen offset:1024
    v_mul_f32 v16, v40, v88
    v_mul_f32 v17, v41, v88
    v_mul_f32 v18, v42, v88
    v_mul_f32 v19, v43, v88
    v_add_f32 v40, v40, v14
    v_add_f32 v41, v41, v14
    v_add_f32 v42, v42, v14
    v_add_f32 v43, v43, v14
    v_mul_f32 v20, v44, v89
    v_mul_f32 v21, v45, v89
    v_mul_f32 v22, v46, v89
    v_mul_f32 v23, v47, v89
    v_add_f32 v44, v44, v15
    v_add_f32 v45, v45, v15
    v_add_f32 v46, v46, v15
    v_add_f32 v47, v47, v15
    v_mul_f32 v24, v48, v88
    v_mul_f32 v25, v49, v88
    v_mul_f32 v26, v50, v88
    v_mul_f32 v27, v51, v88
    v_add_f32 v48, v48, v14
    v_add_f32 v49, v49, v14
    v_add_f32 v50, v50, v14
    v_add_f32 v51, v51, v14
    v_mul_f32 v28, v52, v89
    v_mul_f32 v29, v53, v89
    v_mul_f32 v30, v54, v89
    v_mul_f32 v31, v55, v89
    v_add_f32 v52, v52, v15
    v_add_f32 v53, v53, v15
    v_add_f32 v54, v54, v15
    v_add_f32 v55, v55, v15
    v_mul_f32 v32, v56, v88
    v_mul_f32 v33, v57, v88
    v_mul_f32 v34, v58, v88
    v_mul_f32 v35, v59, v88
    v_add_f32 v56, v56, v14
    v_add_f32 v57, v57, v14
    v_add_f32 v58, v58, v14
    v_add_f32 v59, v59, v14
    v_mul_f32 v36, v60, v89
    v_mul_f32 v37, v61, v89
    v_mul_f32 v38, v62, v89
    v_mul_f32 v39, v63, v89
    v_add_f32 v60, v60, v15
    v_add_f32 v61, v61, v15
    v_add_f32 v62, v62, v15
    v_add_f32 v63, v63, v15
    s_barrier
    s_add_u32 m0, s59, 0
    s_nop 0
    buffer_load_dwordx4 v240, s[8:11], s54 offen offset:0 sc1 lds
    buffer_load_dwordx4 v240, s[8:11], s54 offen offset:2048 sc1 lds
    s_add_u32 m0, s59, 4096
    s_add_u32 s54, s54, 4096
    buffer_load_dwordx4 v244, s[8:11], s54 offen offset:0 sc1 lds
    buffer_load_dwordx4 v241, s[8:11], s54 offen offset:2048 sc1 lds
    s_add_u32 m0, s59, 8192
    s_add_u32 s54, s54, 4096
    buffer_load_dwordx4 v245, s[8:11], s54 offen offset:0 sc1 lds
    buffer_load_dwordx4 v242, s[8:11], s54 offen offset:2048 sc1 lds
    s_add_u32 m0, s59, 12288
    s_add_u32 s54, s54, 4096
    buffer_load_dwordx4 v246, s[8:11], s54 offen offset:0 sc1 lds
    buffer_load_dwordx4 v243, s[8:11], s54 offen offset:2048 sc1 lds
    s_add_u32 m0, s59, 16384
    s_add_u32 s54, s54, 4096
    buffer_load_dwordx4 v243, s[8:11], s54 offen offset:0 sc1 lds
    s_waitcnt vmcnt(7)
    s_barrier
    ds_read_b128 v[64:67], v4 offset:0
    ds_read_b128 v[68:71], v4 offset:18432
    ds_read_b128 v[72:75], v4 offset:1024
    ds_read_b128 v[76:79], v4 offset:19456
    ds_read_b128 v[80:83], v4 offset:2048
    ds_read_b128 v[84:87], v4 offset:20480
    s_waitcnt lgkmcnt(4)
    v_mfma_f32_16x16x32_bf16 v[16:19], v[104:107], v[64:67], v[16:19]
    v_mfma_f32_16x16x32_bf16 v[20:23], v[104:107], v[68:71], v[20:23]
    v_mfma_f32_16x16x32_bf16 v[24:27], v[108:111], v[64:67], v[24:27]
    v_mfma_f32_16x16x32_bf16 v[28:31], v[108:111], v[68:71], v[28:31]
    v_mfma_f32_16x16x32_bf16 v[32:35], v[112:115], v[64:67], v[32:35]
    v_mfma_f32_16x16x32_bf16 v[36:39], v[112:115], v[68:71], v[36:39]
    buffer_load_dwordx4 v[104:107], v4, s[8:11], s30 offen offset:0 sc1
    ds_read_b128 v[64:67], v4 offset:3072
    ds_read_b128 v[68:71], v4 offset:21504
    s_waitcnt lgkmcnt(4)
    v_mfma_f32_16x16x32_bf16 v[16:19], v[116:119], v[72:75], v[16:19]
    v_mfma_f32_16x16x32_bf16 v[20:23], v[116:119], v[76:79], v[20:23]
    v_mfma_f32_16x16x32_bf16 v[24:27], v[120:123], v[72:75], v[24:27]
    v_mfma_f32_16x16x32_bf16 v[28:31], v[120:123], v[76:79], v[28:31]
    v_mfma_f32_16x16x32_bf16 v[32:35], v[124:127], v[72:75], v[32:35]
    v_mfma_f32_16x16x32_bf16 v[36:39], v[124:127], v[76:79], v[36:39]
    buffer_load_dwordx4 v[108:111], v4, s[8:11], s30 offen offset:1024 sc1
    buffer_load_dwordx4 v[112:115], v4, s[8:11], s30 offen offset:2048 sc1
    s_waitcnt vmcnt(7)
    s_barrier
    ds_read_b128 v[72:75], v4 offset:4096
    ds_read_b128 v[76:79], v4 offset:22528
    s_waitcnt lgkmcnt(4)
    v_mfma_f32_16x16x32_bf16 v[16:19], v[128:131], v[80:83], v[16:19]
    v_mfma_f32_16x16x32_bf16 v[20:23], v[128:131], v[84:87], v[20:23]
    v_mfma_f32_16x16x32_bf16 v[24:27], v[132:135], v[80:83], v[24:27]
    v_mfma_f32_16x16x32_bf16 v[28:31], v[132:135], v[84:87], v[28:31]
    v_mfma_f32_16x16x32_bf16 v[32:35], v[136:139], v[80:83], v[32:35]
    v_mfma_f32_16x16x32_bf16 v[36:39], v[136:139], v[84:87], v[36:39]
    buffer_load_dwordx4 v[116:119], v4, s[8:11], s30 offen offset:3072 sc1
    ds_read_b128 v[80:83], v4 offset:5120
    ds_read_b128 v[84:87], v4 offset:23552
    s_waitcnt lgkmcnt(4)
    v_mfma_f32_16x16x32_bf16 v[16:19], v[140:143], v[64:67], v[16:19]
    v_mfma_f32_16x16x32_bf16 v[20:23], v[140:143], v[68:71], v[20:23]
    v_mfma_f32_16x16x32_bf16 v[24:27], v[144:147], v[64:67], v[24:27]
    v_mfma_f32_16x16x32_bf16 v[28:31], v[144:147], v[68:71], v[28:31]
    v_mfma_f32_16x16x32_bf16 v[32:35], v[148:151], v[64:67], v[32:35]
    v_mfma_f32_16x16x32_bf16 v[36:39], v[148:151], v[68:71], v[36:39]
    s_add_u32 s30, s30, 4096
    buffer_load_dwordx4 v[120:123], v4, s[8:11], s30 offen offset:0 sc1
    buffer_load_dwordx4 v[124:127], v4, s[8:11], s30 offen offset:1024 sc1
    ds_read_b128 v[64:67], v4 offset:6144
    ds_read_b128 v[68:71], v4 offset:24576
    s_waitcnt lgkmcnt(4)
    v_mfma_f32_16x16x32_bf16 v[16:19], v[152:155], v[72:75], v[16:19]
    v_mfma_f32_16x16x32_bf16 v[20:23], v[152:155], v[76:79], v[20:23]
    v_mfma_f32_16x16x32_bf16 v[24:27], v[156:159], v[72:75], v[24:27]
    v_mfma_f32_16x16x32_bf16 v[28:31], v[156:159], v[76:79], v[28:31]
    v_mfma_f32_16x16x32_bf16 v[32:35], v[160:163], v[72:75], v[32:35]
    v_mfma_f32_16x16x32_bf16 v[36:39], v[160:163], v[76:79], v[36:39]
    buffer_load_dwordx4 v[128:131], v4, s[8:11], s30 offen offset:2048 sc1
    ds_read_b128 v[72:75], v4 offset:7168
    ds_read_b128 v[76:79], v4 offset:25600
    s_waitcnt lgkmcnt(4)
    v_mfma_f32_16x16x32_bf16 v[16:19], v[164:167], v[80:83], v[16:19]
    v_mfma_f32_16x16x32_bf16 v[20:23], v[164:167], v[84:87], v[20:23]
    v_mfma_f32_16x16x32_bf16 v[24:27], v[168:171], v[80:83], v[24:27]
    v_mfma_f32_16x16x32_bf16 v[28:31], v[168:171], v[84:87], v[28:31]
    v_mfma_f32_16x16x32_bf16 v[32:35], v[172:175], v[80:83], v[32:35]
    v_mfma_f32_16x16x32_bf16 v[36:39], v[172:175], v[84:87], v[36:39]
    buffer_load_dwordx4 v[132:135], v4, s[8:11], s30 offen offset:3072 sc1
    s_add_u32 s30, s30, 4096
    buffer_load_dwordx4 v[136:139], v4, s[8:11], s30 offen offset:0 sc1
    ds_read_b128 v[80:83], v4 offset:8192
    ds_read_b128 v[84:87], v4 offset:26624
    s_waitcnt lgkmcnt(4)
    v_mfma_f32_16x16x32_bf16 v[16:19], v[176:179], v[64:67], v[16:19]
    v_mfma_f32_16x16x32_bf16 v[20:23], v[176:179], v[68:71], v[20:23]
    v_mfma_f32_16x16x32_bf16 v[24:27], v[180:183], v[64:67], v[24:27]
    v_mfma_f32_16x16x32_bf16 v[28:31], v[180:183], v[68:71], v[28:31]
    v_mfma_f32_16x16x32_bf16 v[32:35], v[184:187], v[64:67], v[32:35]
    v_mfma_f32_16x16x32_bf16 v[36:39], v[184:187], v[68:71], v[36:39]
    buffer_load_dwordx4 v[140:143], v4, s[8:11], s30 offen offset:1024 sc1
    ds_read_b128 v[64:67], v4 offset:9216
    ds_read_b128 v[68:71], v4 offset:27648
    s_waitcnt lgkmcnt(4)
    v_mfma_f32_16x16x32_bf16 v[16:19], v[188:191], v[72:75], v[16:19]
    v_mfma_f32_16x16x32_bf16 v[20:23], v[188:191], v[76:79], v[20:23]
    v_mfma_f32_16x16x32_bf16 v[24:27], v[192:195], v[72:75], v[24:27]
    v_mfma_f32_16x16x32_bf16 v[28:31], v[192:195], v[76:79], v[28:31]
    v_mfma_f32_16x16x32_bf16 v[32:35], v[196:199], v[72:75], v[32:35]
    v_mfma_f32_16x16x32_bf16 v[36:39], v[196:199], v[76:79], v[36:39]
    buffer_load_dwordx4 v[144:147], v4, s[8:11], s30 offen offset:2048 sc1
    buffer_load_dwordx4 v[148:151], v4, s[8:11], s30 offen offset:3072 sc1
    s_waitcnt vmcnt(12)
    s_barrier
    ds_read_b128 v[72:75], v4 offset:10240
    ds_read_b128 v[76:79], v4 offset:28672
    s_waitcnt lgkmcnt(4)
    v_mfma_f32_16x16x32_bf16 v[16:19], v[200:203], v[80:83], v[16:19]
    v_mfma_f32_16x16x32_bf16 v[20:23], v[200:203], v[84:87], v[20:23]
    v_mfma_f32_16x16x32_bf16 v[24:27], v[204:207], v[80:83], v[24:27]
    v_mfma_f32_16x16x32_bf16 v[28:31], v[204:207], v[84:87], v[28:31]
    v_mfma_f32_16x16x32_bf16 v[32:35], v[208:211], v[80:83], v[32:35]
    v_mfma_f32_16x16x32_bf16 v[36:39], v[208:211], v[84:87], v[36:39]
    s_add_u32 s30, s30, 4096
    buffer_load_dwordx4 v[152:155], v4, s[8:11], s30 offen offset:0 sc1
    ds_read_b128 v[80:83], v4 offset:11264
    ds_read_b128 v[84:87], v4 offset:29696
    s_waitcnt lgkmcnt(4)
    v_mfma_f32_16x16x32_bf16 v[16:19], v[212:215], v[64:67], v[16:19]
    v_mfma_f32_16x16x32_bf16 v[20:23], v[212:215], v[68:71], v[20:23]
    v_mfma_f32_16x16x32_bf16 v[24:27], v[216:219], v[64:67], v[24:27]
    v_mfma_f32_16x16x32_bf16 v[28:31], v[216:219], v[68:71], v[28:31]
    v_mfma_f32_16x16x32_bf16 v[32:35], v[220:223], v[64:67], v[32:35]
    v_mfma_f32_16x16x32_bf16 v[36:39], v[220:223], v[68:71], v[36:39]
    buffer_load_dwordx4 v[156:159], v4, s[8:11], s30 offen offset:1024 sc1
    buffer_load_dwordx4 v[160:163], v4, s[8:11], s30 offen offset:2048 sc1
    ds_read_b128 v[64:67], v4 offset:12288
    ds_read_b128 v[68:71], v4 offset:30720
    s_waitcnt lgkmcnt(4)
    v_mfma_f32_16x16x32_bf16 v[16:19], v[224:227], v[72:75], v[16:19]
    v_mfma_f32_16x16x32_bf16 v[20:23], v[224:227], v[76:79], v[20:23]
    v_mfma_f32_16x16x32_bf16 v[24:27], v[228:231], v[72:75], v[24:27]
    v_mfma_f32_16x16x32_bf16 v[28:31], v[228:231], v[76:79], v[28:31]
    v_mfma_f32_16x16x32_bf16 v[32:35], a[216:219], v[72:75], v[32:35]
    v_mfma_f32_16x16x32_bf16 v[36:39], a[216:219], v[76:79], v[36:39]
    buffer_load_dwordx4 v[164:167], v4, s[8:11], s30 offen offset:3072 sc1
    ds_read_b128 v[72:75], v4 offset:13312
    ds_read_b128 v[76:79], v4 offset:31744
    s_waitcnt lgkmcnt(4)
    v_mfma_f32_16x16x32_bf16 v[16:19], a[220:223], v[80:83], v[16:19]
    v_mfma_f32_16x16x32_bf16 v[20:23], a[220:223], v[84:87], v[20:23]
    v_mfma_f32_16x16x32_bf16 v[24:27], a[224:227], v[80:83], v[24:27]
    v_mfma_f32_16x16x32_bf16 v[28:31], a[224:227], v[84:87], v[28:31]
    v_mfma_f32_16x16x32_bf16 v[32:35], a[228:231], v[80:83], v[32:35]
    v_mfma_f32_16x16x32_bf16 v[36:39], a[228:231], v[84:87], v[36:39]
    s_add_u32 s30, s30, 4096
    buffer_load_dwordx4 v[168:171], v4, s[8:11], s30 offen offset:0 sc1
    buffer_load_dwordx4 v[172:175], v4, s[8:11], s30 offen offset:1024 sc1
    ds_read_b128 v[80:83], v4 offset:14336
    ds_read_b128 v[84:87], v4 offset:32768
    s_waitcnt lgkmcnt(4)
    v_mfma_f32_16x16x32_bf16 v[16:19], a[232:235], v[64:67], v[16:19]
    v_mfma_f32_16x16x32_bf16 v[20:23], a[232:235], v[68:71], v[20:23]
    v_mfma_f32_16x16x32_bf16 v[24:27], a[236:239], v[64:67], v[24:27]
    v_mfma_f32_16x16x32_bf16 v[28:31], a[236:239], v[68:71], v[28:31]
    v_mfma_f32_16x16x32_bf16 v[32:35], a[240:243], v[64:67], v[32:35]
    v_mfma_f32_16x16x32_bf16 v[36:39], a[240:243], v[68:71], v[36:39]
    buffer_load_dwordx4 v[176:179], v4, s[8:11], s30 offen offset:2048 sc1
    ds_read_b128 v[64:67], v4 offset:15360
    ds_read_b128 v[68:71], v4 offset:33792
    s_waitcnt lgkmcnt(4)
    v_mfma_f32_16x16x32_bf16 v[16:19], a[244:247], v[72:75], v[16:19]
    v_mfma_f32_16x16x32_bf16 v[20:23], a[244:247], v[76:79], v[20:23]
    v_mfma_f32_16x16x32_bf16 v[24:27], a[248:251], v[72:75], v[24:27]
    v_mfma_f32_16x16x32_bf16 v[28:31], a[248:251], v[76:79], v[28:31]
    v_mfma_f32_16x16x32_bf16 v[32:35], a[252:255], v[72:75], v[32:35]
    v_mfma_f32_16x16x32_bf16 v[36:39], a[252:255], v[76:79], v[36:39]
    buffer_load_dwordx4 v[180:183], v4, s[8:11], s30 offen offset:3072 sc1
    s_add_u32 s30, s30, 4096
    buffer_load_dwordx4 v[184:187], v4, s[8:11], s30 offen offset:0 sc1
    ds_read_b128 v[72:75], v4 offset:16384
    ds_read_b128 v[76:79], v4 offset:34816
    s_waitcnt lgkmcnt(4)
    v_mfma_f32_16x16x32_bf16 v[16:19], a[0:3], v[80:83], v[16:19]
    v_mfma_f32_16x16x32_bf16 v[20:23], a[0:3], v[84:87], v[20:23]
    v_mfma_f32_16x16x32_bf16 v[24:27], a[4:7], v[80:83], v[24:27]
    v_mfma_f32_16x16x32_bf16 v[28:31], a[4:7], v[84:87], v[28:31]
    v_mfma_f32_16x16x32_bf16 v[32:35], a[8:11], v[80:83], v[32:35]
    v_mfma_f32_16x16x32_bf16 v[36:39], a[8:11], v[84:87], v[36:39]
    buffer_load_dwordx4 v[188:191], v4, s[8:11], s30 offen offset:1024 sc1
    ds_read_b128 v[80:83], v4 offset:17408
    ds_read_b128 v[84:87], v4 offset:35840
    s_waitcnt lgkmcnt(4)
    v_mfma_f32_16x16x32_bf16 v[16:19], a[12:15], v[64:67], v[16:19]
    v_mfma_f32_16x16x32_bf16 v[20:23], a[12:15], v[68:71], v[20:23]
    v_mfma_f32_16x16x32_bf16 v[24:27], a[16:19], v[64:67], v[24:27]
    v_mfma_f32_16x16x32_bf16 v[28:31], a[16:19], v[68:71], v[28:31]
    v_mfma_f32_16x16x32_bf16 v[32:35], a[20:23], v[64:67], v[32:35]
    v_mfma_f32_16x16x32_bf16 v[36:39], a[20:23], v[68:71], v[36:39]
    buffer_load_dwordx4 v[192:195], v4, s[8:11], s30 offen offset:2048 sc1
    buffer_load_dwordx4 v[196:199], v4, s[8:11], s30 offen offset:3072 sc1
    s_waitcnt lgkmcnt(2)
    v_mfma_f32_16x16x32_bf16 v[16:19], a[24:27], v[72:75], v[16:19]
    v_mfma_f32_16x16x32_bf16 v[20:23], a[24:27], v[76:79], v[20:23]
    v_mfma_f32_16x16x32_bf16 v[24:27], a[28:31], v[72:75], v[24:27]
    v_mfma_f32_16x16x32_bf16 v[28:31], a[28:31], v[76:79], v[28:31]
    v_mfma_f32_16x16x32_bf16 v[32:35], a[32:35], v[72:75], v[32:35]
    v_mfma_f32_16x16x32_bf16 v[36:39], a[32:35], v[76:79], v[36:39]
    s_add_u32 s30, s30, 4096
    buffer_load_dwordx4 v[200:203], v4, s[8:11], s30 offen offset:0 sc1
    s_waitcnt lgkmcnt(0)
    v_mfma_f32_16x16x32_bf16 v[16:19], a[36:39], v[80:83], v[16:19]
    v_mfma_f32_16x16x32_bf16 v[20:23], a[36:39], v[84:87], v[20:23]
    v_mfma_f32_16x16x32_bf16 v[24:27], a[40:43], v[80:83], v[24:27]
    v_mfma_f32_16x16x32_bf16 v[28:31], a[40:43], v[84:87], v[28:31]
    v_mfma_f32_16x16x32_bf16 v[32:35], a[44:47], v[80:83], v[32:35]
    v_mfma_f32_16x16x32_bf16 v[36:39], a[44:47], v[84:87], v[36:39]
    buffer_load_dwordx4 v[204:207], v4, s[8:11], s30 offen offset:1024 sc1
    buffer_load_dwordx4 v[208:211], v4, s[8:11], s30 offen offset:2048 sc1
    s_barrier
    ds_read_b32 v96, v98 offset:36864
    ds_read_b32 v97, v98 offset:36928
    s_nop 3
    v_add_f32 v40, v40, v16
    v_add_f32 v41, v41, v17
    v_add_f32 v42, v42, v18
    v_add_f32 v43, v43, v19
    v_add_f32 v44, v44, v20
    v_add_f32 v45, v45, v21
    v_add_f32 v46, v46, v22
    v_add_f32 v47, v47, v23
    v_add_f32 v48, v48, v24
    v_add_f32 v49, v49, v25
    v_add_f32 v50, v50, v26
    v_add_f32 v51, v51, v27
    v_add_f32 v52, v52, v28
    v_add_f32 v53, v53, v29
    v_add_f32 v54, v54, v30
    v_add_f32 v55, v55, v31
    v_add_f32 v56, v56, v32
    v_add_f32 v57, v57, v33
    v_add_f32 v58, v58, v34
    v_add_f32 v59, v59, v35
    v_add_f32 v60, v60, v36
    v_add_f32 v61, v61, v37
    v_add_f32 v62, v62, v38
    v_add_f32 v63, v63, v39
    s_waitcnt lgkmcnt(0)
    v_sub_f32 v16, v16, v96
    v_sub_f32 v17, v17, v96
    v_sub_f32 v18, v18, v96
    v_sub_f32 v19, v19, v96
    v_cvt_pk_bf16_f32 v64, v16, v17
    v_cvt_pk_bf16_f32 v65, v18, v19
    v_fmac_f32 v90, v16, v16
    v_fmac_f32 v90, v17, v17
    v_fmac_f32 v90, v18, v18
    v_fmac_f32 v90, v19, v19
    v_sub_f32 v20, v20, v97
    v_sub_f32 v21, v21, v97
    v_sub_f32 v22, v22, v97
    v_sub_f32 v23, v23, v97
    v_cvt_pk_bf16_f32 v66, v20, v21
    v_cvt_pk_bf16_f32 v67, v22, v23
    v_fmac_f32 v91, v20, v20
    v_fmac_f32 v91, v21, v21
    v_fmac_f32 v91, v22, v22
    v_fmac_f32 v91, v23, v23
    s_nop 0
    v_permlane16_swap_b32 v64, v66
    v_permlane16_swap_b32 v65, v67
    buffer_store_dwordx4 v[64:67], v8, s[8:11], s44 offen offset:0 sc1
    v_sub_f32 v24, v24, v96
    v_sub_f32 v25, v25, v96
    v_sub_f32 v26, v26, v96
    v_sub_f32 v27, v27, v96
    v_cvt_pk_bf16_f32 v68, v24, v25
    v_cvt_pk_bf16_f32 v69, v26, v27
    v_fmac_f32 v90, v24, v24
    v_fmac_f32 v90, v25, v25
    v_fmac_f32 v90, v26, v26
    v_fmac_f32 v90, v27, v27
    v_sub_f32 v28, v28, v97
    v_sub_f32 v29, v29, v97
    v_sub_f32 v30, v30, v97
    v_sub_f32 v31, v31, v97
    v_cvt_pk_bf16_f32 v70, v28, v29
    v_cvt_pk_bf16_f32 v71, v30, v31
    v_fmac_f32 v91, v28, v28
    v_fmac_f32 v91, v29, v29
    v_fmac_f32 v91, v30, v30
    v_fmac_f32 v91, v31, v31
    s_nop 0
    v_permlane16_swap_b32 v68, v70
    v_permlane16_swap_b32 v69, v71
    buffer_store_dwordx4 v[68:71], v8, s[8:11], s44 offen offset:512 sc1
    v_sub_f32 v32, v32, v96
    v_sub_f32 v33, v33, v96
    v_sub_f32 v34, v34, v96
    v_sub_f32 v35, v35, v96
    v_cvt_pk_bf16_f32 v72, v32, v33
    v_cvt_pk_bf16_f32 v73, v34, v35
    v_fmac_f32 v90, v32, v32
    v_fmac_f32 v90, v33, v33
    v_fmac_f32 v90, v34, v34
    v_fmac_f32 v90, v35, v35
    v_sub_f32 v36, v36, v97
    v_sub_f32 v37, v37, v97
    v_sub_f32 v38, v38, v97
    v_sub_f32 v39, v39, v97
    v_cvt_pk_bf16_f32 v74, v36, v37
    v_cvt_pk_bf16_f32 v75, v38, v39
    v_fmac_f32 v91, v36, v36
    v_fmac_f32 v91, v37, v37
    v_fmac_f32 v91, v38, v38
    v_fmac_f32 v91, v39, v39
    s_nop 0
    v_permlane16_swap_b32 v72, v74
    v_permlane16_swap_b32 v73, v75
    buffer_store_dwordx4 v[72:75], v8, s[8:11], s44 offen offset:1024 sc1
    v_mov_b32 v92, v90
    v_mov_b32 v93, v91
    s_nop 1
    v_permlane32_swap_b32 v90, v92
    v_permlane32_swap_b32 v91, v93
    v_add_f32 v90, v90, v92
    v_add_f32 v91, v91, v93
    v_mov_b32 v92, v90
    v_mov_b32 v93, v91
    s_nop 1
    v_permlane16_swap_b32 v90, v92
    v_permlane16_swap_b32 v91, v93
    v_add_f32 v90, v90, v92
    v_add_f32 v91, v91, v93
    s_add_u32 s46, s41, 47491072
    s_mov_b64 exec, 0xffff
    buffer_store_dwordx2 v[90:91], v13, s[8:11], s46 offen sc1
    s_mov_b64 exec, -1
    v_cvt_pk_bf16_f32 v232, v40, v41
    v_cvt_pk_bf16_f32 v233, v42, v43
    v_cvt_pk_bf16_f32 v234, v44, v45
    v_cvt_pk_bf16_f32 v235, v46, v47
    v_cvt_pk_bf16_f32 v236, v48, v49
    v_cvt_pk_bf16_f32 v237, v50, v51
    v_cvt_pk_bf16_f32 v238, v52, v53
    v_cvt_pk_bf16_f32 v239, v54, v55
    v_cvt_pk_bf16_f32 v240, v56, v57
    v_cvt_pk_bf16_f32 v241, v58, v59
    v_cvt_pk_bf16_f32 v242, v60, v61
    v_cvt_pk_bf16_f32 v243, v62, v63
    s_waitcnt vmcnt(0)
    s_add_u32 s46, s55, 47638528
    s_mov_b64 exec, 1
    buffer_store_dword v250, v251, s[8:11], s46 offen sc1
    s_mov_b64 exec, -1
    s_barrier
    s_mul_i32 s40, s26, 73728
    s_mul_i32 s32, s3, 18432
    s_add_u32 s40, s40, s32
    s_add_u32 s40, s40, 9437184
    v_lshlrev_b32 v6, 3, v3
    v_mul_u32_u24 v7, 384, v2
    v_add_u32 v6, v6, v7
    s_lshl_b32 s37, s26, 12
    s_add_u32 s37, s37, 47491072
    s_lshr_b32 s33, s3, 1
    s_lshl_b32 s33, s33, 10
    s_and_b32 s36, s3, 1
    s_lshl_b32 s36, s36, 3
    s_add_u32 s33, s33, s36
    s_add_u32 s33, s33, 73728
    v_add_u32 v8, s33, v4
    v_add_u32 v9, 36864, v8
    v_add_u32 v12, 73728, v4
    v_add_u32 v13, 110592, v4
    v_add_u32 v14, s32, v4
    v_add_u32 v15, 4096, v4
    v_add_u32 v5, 8192, v4
    v_add_u32 v7, 12288, v4
    s_lshl_b32 s34, s26, 2
    s_add_u32 s34, s34, s3
    s_mul_i32 s34, s34, 18432
    s_mul_i32 s35, s28, 2359296
    s_add_u32 s34, s34, s35
    s_add_u32 s34, s34, 14155776
    s_barrier
    s_branch L_p6_22
L_w3_21:
    s_cmp_lg_u32 s56, 255
    s_cbranch_scc1 L_efd_26
    v_lshlrev_b32 v16, 3, v2
    v_lshrrev_b32 v17, 2, v3
    v_add_u32 v16, v16, v17
    v_lshlrev_b32 v16, 7, v16
    v_and_b32 v17, 3, v3
    v_lshl_add_u32 v16, v17, 3, v16
    v_add_u32 v17, 55296, v4
    v_add_u32 v18, 16384, v16
    ds_read_b64_tr_b16 a[0:1], v16 offset:49152
    ds_read_b64_tr_b16 a[2:3], v16 offset:49664
    ds_read_b64_tr_b16 a[4:5], v16 offset:49184
    ds_read_b64_tr_b16 a[6:7], v16 offset:49696
    ds_read_b64_tr_b16 a[8:9], v16 offset:49216
    ds_read_b64_tr_b16 a[10:11], v16 offset:49728
    ds_read_b64_tr_b16 a[12:13], v16 offset:49248
    ds_read_b64_tr_b16 a[14:15], v16 offset:49760
    s_waitcnt lgkmcnt(6)
    buffer_store_dwordx4 a[0:3], v4, s[8:11], s50 offen sc1
    s_waitcnt lgkmcnt(4)
    buffer_store_dwordx4 a[4:7], v10, s[8:11], s50 offen sc1
    s_waitcnt lgkmcnt(2)
    buffer_store_dwordx4 a[8:11], v11, s[8:11], s50 offen sc1
    s_waitcnt lgkmcnt(0)
    buffer_store_dwordx4 a[12:15], v17, s[8:11], s50 offen sc1
    s_add_u32 s50, s50, 73728
    ds_read_b64_tr_b16 a[16:17], v16 offset:53248
    ds_read_b64_tr_b16 a[18:19], v16 offset:53760
    ds_read_b64_tr_b16 a[20:21], v16 offset:53280
    ds_read_b64_tr_b16 a[22:23], v16 offset:53792
    ds_read_b64_tr_b16 a[24:25], v16 offset:53312
    ds_read_b64_tr_b16 a[26:27], v16 offset:53824
    ds_read_b64_tr_b16 a[28:29], v16 offset:53344
    ds_read_b64_tr_b16 a[30:31], v16 offset:53856
    s_waitcnt lgkmcnt(6)
    buffer_store_dwordx4 a[16:19], v4, s[8:11], s50 offen sc1
    s_waitcnt lgkmcnt(4)
    buffer_store_dwordx4 a[20:23], v10, s[8:11], s50 offen sc1
    s_waitcnt lgkmcnt(2)
    buffer_store_dwordx4 a[24:27], v11, s[8:11], s50 offen sc1
    s_waitcnt lgkmcnt(0)
    buffer_store_dwordx4 a[28:31], v17, s[8:11], s50 offen sc1
    s_add_u32 s50, s50, 73728
    ds_read_b64_tr_b16 a[32:33], v16 offset:57344
    ds_read_b64_tr_b16 a[34:35], v16 offset:57856
    ds_read_b64_tr_b16 a[36:37], v16 offset:57376
    ds_read_b64_tr_b16 a[38:39], v16 offset:57888
    ds_read_b64_tr_b16 a[40:41], v16 offset:57408
    ds_read_b64_tr_b16 a[42:43], v16 offset:57920
    ds_read_b64_tr_b16 a[44:45], v16 offset:57440
    ds_read_b64_tr_b16 a[46:47], v16 offset:57952
    s_waitcnt lgkmcnt(6)
    buffer_store_dwordx4 a[32:35], v4, s[8:11], s50 offen sc1
    s_waitcnt lgkmcnt(4)
    buffer_store_dwordx4 a[36:39], v10, s[8:11], s50 offen sc1
    s_waitcnt lgkmcnt(2)
    buffer_store_dwordx4 a[40:43], v11, s[8:11], s50 offen sc1
    s_waitcnt lgkmcnt(0)
    buffer_store_dwordx4 a[44:47], v17, s[8:11], s50 offen sc1
    s_bitcmp1_b32 s58, 0
    s_cbranch_scc1 L_efd_26
    ds_read_b64_tr_b16 a[48:49], v16 offset:61440
    ds_read_b64_tr_b16 a[50:51], v16 offset:61952
    ds_read_b64_tr_b16 a[52:53], v16 offset:61472
    ds_read_b64_tr_b16 a[54:55], v16 offset:61984
    ds_read_b64_tr_b16 a[56:57], v16 offset:61504
    ds_read_b64_tr_b16 a[58:59], v16 offset:62016
    ds_read_b64_tr_b16 a[60:61], v16 offset:61536
    ds_read_b64_tr_b16 a[62:63], v16 offset:62048
    s_waitcnt lgkmcnt(6)
    buffer_store_dwordx4 a[48:51], v4, s[8:11], s51 offen sc1
    s_waitcnt lgkmcnt(4)
    buffer_store_dwordx4 a[52:55], v10, s[8:11], s51 offen sc1
    s_waitcnt lgkmcnt(2)
    buffer_store_dwordx4 a[56:59], v11, s[8:11], s51 offen sc1
    s_waitcnt lgkmcnt(0)
    buffer_store_dwordx4 a[60:63], v17, s[8:11], s51 offen sc1
    s_add_u32 s51, s51, 73728
    ds_read_b64_tr_b16 a[64:65], v18 offset:49152
    ds_read_b64_tr_b16 a[66:67], v18 offset:49664
    ds_read_b64_tr_b16 a[68:69], v18 offset:49184
    ds_read_b64_tr_b16 a[70:71], v18 offset:49696
    ds_read_b64_tr_b16 a[72:73], v18 offset:49216
    ds_read_b64_tr_b16 a[74:75], v18 offset:49728
    ds_read_b64_tr_b16 a[76:77], v18 offset:49248
    ds_read_b64_tr_b16 a[78:79], v18 offset:49760
    s_waitcnt lgkmcnt(6)
    buffer_store_dwordx4 a[64:67], v4, s[8:11], s51 offen sc1
    s_waitcnt lgkmcnt(4)
    buffer_store_dwordx4 a[68:71], v10, s[8:11], s51 offen sc1
    s_waitcnt lgkmcnt(2)
    buffer_store_dwordx4 a[72:75], v11, s[8:11], s51 offen sc1
    s_waitcnt lgkmcnt(0)
    buffer_store_dwordx4 a[76:79], v17, s[8:11], s51 offen sc1
    s_add_u32 s51, s51, 73728
    ds_read_b64_tr_b16 a[80:81], v18 offset:53248
    ds_read_b64_tr_b16 a[82:83], v18 offset:53760
    ds_read_b64_tr_b16 a[84:85], v18 offset:53280
    ds_read_b64_tr_b16 a[86:87], v18 offset:53792
    ds_read_b64_tr_b16 a[88:89], v18 offset:53312
    ds_read_b64_tr_b16 a[90:91], v18 offset:53824
    ds_read_b64_tr_b16 a[92:93], v18 offset:53344
    ds_read_b64_tr_b16 a[94:95], v18 offset:53856
    s_waitcnt lgkmcnt(6)
    buffer_store_dwordx4 a[80:83], v4, s[8:11], s51 offen sc1
    s_waitcnt lgkmcnt(4)
    buffer_store_dwordx4 a[84:87], v10, s[8:11], s51 offen sc1
    s_waitcnt lgkmcnt(2)
    buffer_store_dwordx4 a[88:91], v11, s[8:11], s51 offen sc1
    s_waitcnt lgkmcnt(0)
    buffer_store_dwordx4 a[92:95], v17, s[8:11], s51 offen sc1
L_efd_26:
    v_mov_b32 v250, 1
    v_mov_b32 v251, 0
    v_and_b32 v19, 3, v1
    v_min_u32 v19, 2, v19
    v_lshlrev_b32 v19, 2, v19
    v_bfe_u32 v20, v1, 2, 2
    v_lshl_add_u32 v19, v20, 4, v19
    s_lshl_b32 s46, s25, 7
    v_add_u32 v247, s46, v19
    v_bfe_u32 v21, v1, 4, 1
    v_and_b32 v22, 1, v20
    v_lshlrev_b32 v22, 1, v22
    v_add_u32 v22, -1, v22
    v_mul_lo_u32 v22, v22, v21
    v_add_u32 v22, s25, v22
    v_and_b32 v22, 63, v22
    v_lshl_add_u32 v248, v22, 7, v19
    s_lshl_b32 s46, s26, 8
    v_lshl_add_u32 v249, v21, 7, v19
    v_add_u32 v249, s46, v249
    s_mul_i32 s46, s28, 27
    s_lshr_b32 s46, s46, 1
    v_min_u32 v18, 14, v1
    v_add_u32 v18, s46, v18
    v_min_u32 v18, 107, v18
    s_mul_i32 s46, s28, 18
    s_add_u32 s46, s46, 108
    v_subrev_u32 v19, 32, v1
    v_min_u32 v19, 17, v19
    v_cmp_lt_u32 vcc, 31, v1
    v_add_u32 v19, s46, v19
    s_nop 0
    v_cndmask_b32 v18, v18, v19, vcc
    v_lshlrev_b32 v18, 2, v18
    v_min_u32 v17, 15, v1
    v_lshlrev_b32 v17, 4, v17
    v_min_u32 v19, 35, v1
    v_lshlrev_b32 v19, 4, v19
    s_lshr_b32 s46, s2, 3
    s_and_b32 s46, s46, 3
    s_mul_i32 s46, s46, 2304
    s_add_u32 s46, s46, 47672320
    s_mov_b32 s47, 0x40000
    s_barrier
    s_cmp_eq_u32 s56, 255
    s_cbranch_scc1 L_gp_27s
    s_barrier
L_gp_27s:
    s_nop 0
L_gp_27:
    buffer_load_dword v20, v4, s[8:11], s46 offen sc1
    buffer_load_dword v21, v4, s[8:11], s46 offen offset:1024 sc1
    buffer_load_dword v22, v17, s[8:11], s46 offen offset:2048 sc1
    s_waitcnt vmcnt(0)
    v_and_b32 v20, v20, v21
    v_and_b32 v20, v20, v22
    v_cmp_ne_u32 vcc, 1, v20
    s_cbranch_vccz L_gpd_28
    s_sleep 8
    s_sub_u32 s47, s47, 1
    s_cbranch_scc0 L_gp_27
L_gpd_28:
    s_barrier
    s_add_u32 m0, s32, 0
    s_nop 0
    buffer_load_dwordx4 v253, s[8:11], s33 offen sc1 lds
    s_add_u32 m0, s32, 4096
    s_add_u32 s33, s33, 262144
    buffer_load_dwordx4 v253, s[8:11], s33 offen sc1 lds
    s_add_u32 m0, s32, 8192
    s_add_u32 s33, s33, 262144
    buffer_load_dwordx4 v253, s[8:11], s33 offen sc1 lds
    s_add_u32 m0, s32, 12288
    s_add_u32 s33, s33, 262144
    buffer_load_dwordx4 v253, s[8:11], s33 offen sc1 lds
    s_add_u32 m0, s32, 16384
    s_add_u32 s33, s33, 262144
    buffer_load_dwordx4 v253, s[8:11], s33 offen sc1 lds
    s_add_u32 m0, s32, 20480
    s_add_u32 s33, s33, 262144
    buffer_load_dwordx4 v253, s[8:11], s33 offen sc1 lds
    s_add_u32 m0, s32, 24576
    s_add_u32 s33, s33, 262144
    buffer_load_dwordx4 v253, s[8:11], s33 offen sc1 lds
    s_add_u32 m0, s32, 28672
    s_add_u32 s33, s33, 262144
    buffer_load_dwordx4 v253, s[8:11], s33 offen sc1 lds
    s_add_u32 m0, s32, 32768
    s_add_u32 s33, s33, 262144
    buffer_load_dwordx4 v253, s[8:11], s33 offen sc1 lds
    s_waitcnt vmcnt(7)
    s_barrier
    s_waitcnt vmcnt(4)
    s_barrier
    s_waitcnt vmcnt(0)
    s_barrier
    v_bfe_u32 v90, v3, 2, 1
    v_lshlrev_b32 v90, 4, v90
    v_lshrrev_b32 v91, 3, v3
    v_lshl_add_u32 v90, v91, 2, v90
    v_and_b32 v91, 3, v3
    s_lshl_b32 s48, s25, 5
    s_lshr_b32 s49, s3, 1
    s_lshl_b32 s49, s49, 3
    s_add_u32 s48, s48, s49
    v_add3_u32 v245, v90, v91, s48
    v_mov_b32 v95, 2048
    v_lshlrev_b32 v91, 8, v2
    v_add_u32 v90, -1, v245
    v_cmp_lt_u32 vcc, v90, v95
    v_bfe_u32 v92, v90, 5, 6
    v_mul_u32_u24 v92, 36864, v92
    v_bfe_u32 v93, v90, 3, 1
    v_mul_u32_u24 v93, 18432, v93
    v_bfe_u32 v94, v90, 2, 1
    v_lshl_add_u32 v92, v94, 7, v92
    v_bfe_u32 v94, v90, 4, 1
    v_lshl_add_u32 v92, v94, 6, v92
    v_and_b32 v94, 3, v90
    v_lshl_add_u32 v92, v94, 4, v92
    v_add3_u32 v92, v92, v93, v91
    v_bfrev_b32 v93, 2
    v_cndmask_b32 v240, v93, v92, vcc
    v_add_u32 v90, 1, v245
    v_cmp_lt_u32 vcc, v90, v95
    v_bfe_u32 v92, v90, 5, 6
    v_mul_u32_u24 v92, 36864, v92
    v_bfe_u32 v93, v90, 3, 1
    v_mul_u32_u24 v93, 18432, v93
    v_bfe_u32 v94, v90, 2, 1
    v_lshl_add_u32 v92, v94, 7, v92
    v_bfe_u32 v94, v90, 4, 1
    v_lshl_add_u32 v92, v94, 6, v92
    v_and_b32 v94, 3, v90
    v_lshl_add_u32 v92, v94, 4, v92
    v_add3_u32 v92, v92, v93, v91
    v_bfrev_b32 v93, 2
    v_cndmask_b32 v241, v93, v92, vcc
    v_add_u32 v90, -2, v245
    v_cmp_lt_u32 vcc, v90, v95
    v_bfe_u32 v92, v90, 5, 6
    v_mul_u32_u24 v92, 36864, v92
    v_bfe_u32 v93, v90, 3, 1
    v_mul_u32_u24 v93, 18432, v93
    v_bfe_u32 v94, v90, 2, 1
    v_lshl_add_u32 v92, v94, 7, v92
    v_bfe_u32 v94, v90, 4, 1
    v_lshl_add_u32 v92, v94, 6, v92
    v_and_b32 v94, 3, v90
    v_lshl_add_u32 v92, v94, 4, v92
    v_add3_u32 v92, v92, v93, v91
    v_bfrev_b32 v93, 2
    v_cndmask_b32 v242, v93, v92, vcc
    v_add_u32 v90, 2, v245
    v_cmp_lt_u32 vcc, v90, v95
    v_bfe_u32 v92, v90, 5, 6
    v_mul_u32_u24 v92, 36864, v92
    v_bfe_u32 v93, v90, 3, 1
    v_mul_u32_u24 v93, 18432, v93
    v_bfe_u32 v94, v90, 2, 1
    v_lshl_add_u32 v92, v94, 7, v92
    v_bfe_u32 v94, v90, 4, 1
    v_lshl_add_u32 v92, v94, 6, v92
    v_and_b32 v94, 3, v90
    v_lshl_add_u32 v92, v94, 4, v92
    v_add3_u32 v92, v92, v93, v91
    v_bfrev_b32 v93, 2
    v_cndmask_b32 v243, v93, v92, vcc
    v_cmp_gt_u32 vcc, 2, v2
    s_bitcmp1_b32 s3, 0
    s_cselect_b64 s[48:49], -1, 0
    v_cndmask_b32 v92, v241, v240, vcc
    v_cndmask_b32 v93, v243, v242, vcc
    v_cndmask_b32 v244, v92, v241, s[48:49]
    v_cndmask_b32 v245, v241, v242, s[48:49]
    v_cndmask_b32 v246, v242, v93, s[48:49]
    s_and_b32 s54, s3, 1
    s_lshl_b32 s54, s54, 10
    s_add_u32 s54, s54, 7077888
    s_mov_b32 s40, 47333376
    buffer_load_dwordx4 a[0:3], v4, s[8:11], s40 offen offset:0
    buffer_load_dwordx4 a[4:7], v4, s[8:11], s40 offen offset:1024
    buffer_load_dwordx4 a[8:11], v4, s[8:11], s40 offen offset:2048
    buffer_load_dwordx4 a[12:15], v4, s[8:11], s40 offen offset:3072
    s_mov_b32 s40, 47337472
    buffer_load_dwordx4 a[16:19], v4, s[8:11], s40 offen offset:0
    buffer_load_dwordx4 a[20:23], v4, s[8:11], s40 offen offset:1024
    buffer_load_dwordx4 a[24:27], v4, s[8:11], s40 offen offset:2048
    buffer_load_dwordx4 a[28:31], v4, s[8:11], s40 offen offset:3072
    s_mov_b32 s40, 47341568
    buffer_load_dwordx4 a[32:35], v4, s[8:11], s40 offen offset:0
    buffer_load_dwordx4 a[36:39], v4, s[8:11], s40 offen offset:1024
    buffer_load_dwordx4 a[40:43], v4, s[8:11], s40 offen offset:2048
    buffer_load_dwordx4 a[44:47], v4, s[8:11], s40 offen offset:3072
    s_mov_b32 s40, 47345664
    buffer_load_dwordx4 a[48:51], v4, s[8:11], s40 offen offset:0
    buffer_load_dwordx4 a[52:55], v4, s[8:11], s40 offen offset:1024
    buffer_load_dwordx4 a[56:59], v4, s[8:11], s40 offen offset:2048
    buffer_load_dwordx4 a[60:63], v4, s[8:11], s40 offen offset:3072
    s_mov_b32 s40, 47349760
    buffer_load_dwordx4 a[64:67], v4, s[8:11], s40 offen offset:0
    buffer_load_dwordx4 a[68:71], v4, s[8:11], s40 offen offset:1024
    s_barrier
    s_waitcnt vmcnt(0)
    s_add_u32 s46, s58, 108
    s_cmp_eq_u32 s56, 255
    s_cselect_b32 s46, s46, s56
    s_cselect_b32 s47, 0, s56
    s_cmp_ge_u32 s47, 108
    s_cbranch_scc1 L_nopf_29
    s_lshl_b32 s46, s46, 2
    s_add_u32 s46, s46, 47671296
    s_mov_b64 exec, 1
    buffer_store_dword v250, v251, s[8:11], s46 offen sc1
    s_mov_b64 exec, -1
L_nopf_29:
    s_mov_b32 s46, 47622144
    s_mov_b32 s47, 0x40000
    s_nop 0
L_poll_30:
    buffer_load_dword v252, v247, s[8:11], s46 offen sc1
    s_waitcnt vmcnt(0)
    v_cmp_ne_u32 vcc, 1, v252
    s_cbranch_vccz L_pd_31
    s_sub_u32 s47, s47, 1
    s_cbranch_scc0 L_poll_30
L_pd_31:
    s_barrier
    s_add_u32 s46, s53, 4718592
    s_add_u32 m0, s59, 0
    s_nop 0
    buffer_load_dwordx4 v4, s[8:11], s46 offen offset:0 sc1 lds
    buffer_load_dwordx4 v4, s[8:11], s46 offen offset:2048 sc1 lds
    s_add_u32 m0, s59, 4096
    s_add_u32 s46, s46, 4096
    buffer_load_dwordx4 v4, s[8:11], s46 offen offset:0 sc1 lds
    buffer_load_dwordx4 v4, s[8:11], s46 offen offset:2048 sc1 lds
    s_add_u32 m0, s59, 8192
    s_add_u32 s46, s46, 4096
    buffer_load_dwordx4 v4, s[8:11], s46 offen offset:0 sc1 lds
    buffer_load_dwordx4 v4, s[8:11], s46 offen offset:2048 sc1 lds
    s_add_u32 m0, s59, 12288
    s_add_u32 s46, s46, 4096
    buffer_load_dwordx4 v4, s[8:11], s46 offen offset:0 sc1 lds
    buffer_load_dwordx4 v4, s[8:11], s46 offen offset:2048 sc1 lds
    s_add_u32 m0, s59, 16384
    s_add_u32 s46, s46, 4096
    buffer_load_dwordx4 v4, s[8:11], s46 offen offset:0 sc1 lds
    s_waitcnt vmcnt(7)
    s_barrier
    s_waitcnt vmcnt(4)
    s_barrier
    s_waitcnt vmcnt(0)
    s_barrier
    s_mov_b32 s46, 47671296
    s_mov_b32 s47, 0x40000
    s_nop 0
L_poll_32:
    buffer_load_dword v252, v18, s[8:11], s46 offen sc1
    s_waitcnt vmcnt(0)
    v_cmp_ne_u32 vcc, 1, v252
    s_cbranch_vccz L_pd_33
    s_sub_u32 s47, s47, 1
    s_cbranch_scc0 L_poll_32
L_pd_33:
    s_barrier
    s_mov_b32 s46, 47630336
    s_mov_b32 s47, 0x40000
    s_nop 0
L_poll_34:
    buffer_load_dword v252, v248, s[8:11], s46 offen sc1
    s_waitcnt vmcnt(0)
    v_cmp_ne_u32 vcc, 1, v252
    s_cbranch_vccz L_pd_35
    s_sub_u32 s47, s47, 1
    s_cbranch_scc0 L_poll_34
L_pd_35:
    s_barrier
    s_add_u32 m0, s59, 0
    s_nop 0
    buffer_load_dwordx4 v240, s[8:11], s54 offen offset:0 sc1 lds
    buffer_load_dwordx4 v240, s[8:11], s54 offen offset:2048 sc1 lds
    s_add_u32 m0, s59, 4096
    s_add_u32 s54, s54, 4096
    buffer_load_dwordx4 v244, s[8:11], s54 offen offset:0 sc1 lds
    buffer_load_dwordx4 v241, s[8:11], s54 offen offset:2048 sc1 lds
    s_add_u32 m0, s59, 8192
    s_add_u32 s54, s54, 4096
    buffer_load_dwordx4 v245, s[8:11], s54 offen offset:0 sc1 lds
    buffer_load_dwordx4 v242, s[8:11], s54 offen offset:2048 sc1 lds
    s_add_u32 m0, s59, 12288
    s_add_u32 s54, s54, 4096
    buffer_load_dwordx4 v246, s[8:11], s54 offen offset:0 sc1 lds
    buffer_load_dwordx4 v243, s[8:11], s54 offen offset:2048 sc1 lds
    s_add_u32 m0, s59, 16384
    s_add_u32 s54, s54, 4096
    buffer_load_dwordx4 v243, s[8:11], s54 offen offset:0 sc1 lds
    s_waitcnt vmcnt(7)
    s_barrier
    s_waitcnt vmcnt(4)
    s_barrier
    s_waitcnt vmcnt(0)
    s_barrier
    ds_read_b128 v[40:43], v4 offset:0
    ds_read_b128 v[44:47], v4 offset:18432
    ds_read_b128 v[48:51], v4 offset:1024
    ds_read_b128 v[52:55], v4 offset:19456
    ds_read_b128 v[56:59], v4 offset:2048
    ds_read_b128 v[60:63], v4 offset:20480
    s_waitcnt lgkmcnt(4)
    v_mfma_f32_16x16x32_bf16 v[32:35], a[0:3], v[40:43], 0
    v_mfma_f32_16x16x32_bf16 v[36:39], a[0:3], v[44:47], 0
    ds_read_b128 v[40:43], v4 offset:3072
    ds_read_b128 v[44:47], v4 offset:21504
    s_waitcnt lgkmcnt(4)
    v_mfma_f32_16x16x32_bf16 v[32:35], a[4:7], v[48:51], v[32:35]
    v_mfma_f32_16x16x32_bf16 v[36:39], a[4:7], v[52:55], v[36:39]
    ds_read_b128 v[48:51], v4 offset:4096
    ds_read_b128 v[52:55], v4 offset:22528
    s_waitcnt lgkmcnt(4)
    v_mfma_f32_16x16x32_bf16 v[32:35], a[8:11], v[56:59], v[32:35]
    v_mfma_f32_16x16x32_bf16 v[36:39], a[8:11], v[60:63], v[36:39]
    ds_read_b128 v[56:59], v4 offset:5120
    ds_read_b128 v[60:63], v4 offset:23552
    s_waitcnt lgkmcnt(4)
    v_mfma_f32_16x16x32_bf16 v[32:35], a[12:15], v[40:43], v[32:35]
    v_mfma_f32_16x16x32_bf16 v[36:39], a[12:15], v[44:47], v[36:39]
    ds_read_b128 v[40:43], v4 offset:6144
    ds_read_b128 v[44:47], v4 offset:24576
    s_waitcnt lgkmcnt(4)
    v_mfma_f32_16x16x32_bf16 v[32:35], a[16:19], v[48:51], v[32:35]
    v_mfma_f32_16x16x32_bf16 v[36:39], a[16:19], v[52:55], v[36:39]
    ds_read_b128 v[48:51], v4 offset:7168
    ds_read_b128 v[52:55], v4 offset:25600
    s_waitcnt lgkmcnt(4)
    v_mfma_f32_16x16x32_bf16 v[32:35], a[20:23], v[56:59], v[32:35]
    v_mfma_f32_16x16x32_bf16 v[36:39], a[20:23], v[60:63], v[36:39]
    ds_read_b128 v[56:59], v4 offset:8192
    ds_read_b128 v[60:63], v4 offset:26624
    s_waitcnt lgkmcnt(4)
    v_mfma_f32_16x16x32_bf16 v[32:35], a[24:27], v[40:43], v[32:35]
    v_mfma_f32_16x16x32_bf16 v[36:39], a[24:27], v[44:47], v[36:39]
    ds_read_b128 v[40:43], v4 offset:9216
    ds_read_b128 v[44:47], v4 offset:27648
    s_waitcnt lgkmcnt(4)
    v_mfma_f32_16x16x32_bf16 v[32:35], a[28:31], v[48:51], v[32:35]
    v_mfma_f32_16x16x32_bf16 v[36:39], a[28:31], v[52:55], v[36:39]
    ds_read_b128 v[48:51], v4 offset:10240
    ds_read_b128 v[52:55], v4 offset:28672
    s_waitcnt lgkmcnt(4)
    v_mfma_f32_16x16x32_bf16 v[32:35], a[32:35], v[56:59], v[32:35]
    v_mfma_f32_16x16x32_bf16 v[36:39], a[32:35], v[60:63], v[36:39]
    ds_read_b128 v[56:59], v4 offset:11264
    ds_read_b128 v[60:63], v4 offset:29696
    s_waitcnt lgkmcnt(4)
    v_mfma_f32_16x16x32_bf16 v[32:35], a[36:39], v[40:43], v[32:35]
    v_mfma_f32_16x16x32_bf16 v[36:39], a[36:39], v[44:47], v[36:39]
    ds_read_b128 v[40:43], v4 offset:12288
    ds_read_b128 v[44:47], v4 offset:30720
    s_waitcnt lgkmcnt(4)
    v_mfma_f32_16x16x32_bf16 v[32:35], a[40:43], v[48:51], v[32:35]
    v_mfma_f32_16x16x32_bf16 v[36:39], a[40:43], v[52:55], v[36:39]
    ds_read_b128 v[48:51], v4 offset:13312
    ds_read_b128 v[52:55], v4 offset:31744
    s_waitcnt lgkmcnt(4)
    v_mfma_f32_16x16x32_bf16 v[32:35], a[44:47], v[56:59], v[32:35]
    v_mfma_f32_16x16x32_bf16 v[36:39], a[44:47], v[60:63], v[36:39]
    ds_read_b128 v[56:59], v4 offset:14336
    ds_read_b128 v[60:63], v4 offset:32768
    s_waitcnt lgkmcnt(4)
    v_mfma_f32_16x16x32_bf16 v[32:35], a[48:51], v[40:43], v[32:35]
    v_mfma_f32_16x16x32_bf16 v[36:39], a[48:51], v[44:47], v[36:39]
    ds_read_b128 v[40:43], v4 offset:15360
    ds_read_b128 v[44:47], v4 offset:33792
    s_waitcnt lgkmcnt(4)
    v_mfma_f32_16x16x32_bf16 v[32:35], a[52:55], v[48:51], v[32:35]
    v_mfma_f32_16x16x32_bf16 v[36:39], a[52:55], v[52:55], v[36:39]
    ds_read_b128 v[48:51], v4 offset:16384
    ds_read_b128 v[52:55], v4 offset:34816
    s_waitcnt lgkmcnt(4)
    v_mfma_f32_16x16x32_bf16 v[32:35], a[56:59], v[56:59], v[32:35]
    v_mfma_f32_16x16x32_bf16 v[36:39], a[56:59], v[60:63], v[36:39]
    ds_read_b128 v[56:59], v4 offset:17408
    ds_read_b128 v[60:63], v4 offset:35840
    s_waitcnt lgkmcnt(4)
    v_mfma_f32_16x16x32_bf16 v[32:35], a[60:63], v[40:43], v[32:35]
    v_mfma_f32_16x16x32_bf16 v[36:39], a[60:63], v[44:47], v[36:39]
    s_waitcnt lgkmcnt(2)
    v_mfma_f32_16x16x32_bf16 v[32:35], a[64:67], v[48:51], v[32:35]
    v_mfma_f32_16x16x32_bf16 v[36:39], a[64:67], v[52:55], v[36:39]
    s_waitcnt lgkmcnt(0)
    v_mfma_f32_16x16x32_bf16 v[32:35], a[68:71], v[56:59], v[32:35]
    v_mfma_f32_16x16x32_bf16 v[36:39], a[68:71], v[60:63], v[36:39]
    v_lshlrev_b32 v23, 2, v3
    s_nop 7
    v_add_f32 v32, v32, v33
    v_add_f32 v36, v36, v37
    s_mov_b64 exec, 0xffff
    ds_write_b32 v23, v32 offset:36864
    ds_write_b32 v23, v36 offset:36928
    s_mov_b64 exec, -1
    buffer_load_dwordx4 v[104:107], v4, s[8:11], s30 offen offset:0 sc1
    buffer_load_dwordx4 v[108:111], v4, s[8:11], s30 offen offset:1024 sc1
    buffer_load_dwordx4 v[112:115], v4, s[8:11], s30 offen offset:2048 sc1
    buffer_load_dwordx4 v[116:119], v4, s[8:11], s30 offen offset:3072 sc1
    s_add_u32 s30, s30, 4096
    buffer_load_dwordx4 v[120:123], v4, s[8:11], s30 offen offset:0 sc1
    buffer_load_dwordx4 v[124:127], v4, s[8:11], s30 offen offset:1024 sc1
    buffer_load_dwordx4 v[128:131], v4, s[8:11], s30 offen offset:2048 sc1
    buffer_load_dwordx4 v[132:135], v4, s[8:11], s30 offen offset:3072 sc1
    s_add_u32 s30, s30, 4096
    buffer_load_dwordx4 v[136:139], v4, s[8:11], s30 offen offset:0 sc1
    buffer_load_dwordx4 v[140:143], v4, s[8:11], s30 offen offset:1024 sc1
    buffer_load_dwordx4 v[144:147], v4, s[8:11], s30 offen offset:2048 sc1
    buffer_load_dwordx4 v[148:151], v4, s[8:11], s30 offen offset:3072 sc1
    s_add_u32 s30, s30, 4096
    buffer_load_dwordx4 v[152:155], v4, s[8:11], s30 offen offset:0 sc1
    buffer_load_dwordx4 v[156:159], v4, s[8:11], s30 offen offset:1024 sc1
    buffer_load_dwordx4 v[160:163], v4, s[8:11], s30 offen offset:2048 sc1
    buffer_load_dwordx4 v[164:167], v4, s[8:11], s30 offen offset:3072 sc1
    s_add_u32 s30, s30, 4096
    buffer_load_dwordx4 v[168:171], v4, s[8:11], s30 offen offset:0 sc1
    buffer_load_dwordx4 v[172:175], v4, s[8:11], s30 offen offset:1024 sc1
    buffer_load_dwordx4 v[176:179], v4, s[8:11], s30 offen offset:2048 sc1
    buffer_load_dwordx4 v[180:183], v4, s[8:11], s30 offen offset:3072 sc1
    s_add_u32 s30, s30, 4096
    buffer_load_dwordx4 v[184:187], v4, s[8:11], s30 offen offset:0 sc1
    buffer_load_dwordx4 v[188:191], v4, s[8:11], s30 offen offset:1024 sc1
    buffer_load_dwordx4 v[192:195], v4, s[8:11], s30 offen offset:2048 sc1
    buffer_load_dwordx4 v[196:199], v4, s[8:11], s30 offen offset:3072 sc1
    s_add_u32 s30, s30, 4096
    buffer_load_dwordx4 v[200:203], v4, s[8:11], s30 offen offset:0 sc1
    buffer_load_dwordx4 v[204:207], v4, s[8:11], s30 offen offset:1024 sc1
    buffer_load_dwordx4 v[208:211], v4, s[8:11], s30 offen offset:2048 sc1
    s_waitcnt lgkmcnt(0)
    s_barrier
    s_mul_i32 s40, s26, 73728
    s_mul_i32 s32, s3, 18432
    s_add_u32 s40, s40, s32
    s_add_u32 s40, s40, 9437184
    v_lshlrev_b32 v6, 3, v3
    v_mul_u32_u24 v7, 384, v2
    v_add_u32 v6, v6, v7
    s_lshl_b32 s37, s26, 12
    s_add_u32 s37, s37, 47491072
    s_lshr_b32 s33, s3, 1
    s_lshl_b32 s33, s33, 10
    s_and_b32 s36, s3, 1
    s_lshl_b32 s36, s36, 3
    s_add_u32 s33, s33, s36
    s_add_u32 s33, s33, 73728
    v_add_u32 v8, s33, v4
    v_add_u32 v9, 36864, v8
    v_add_u32 v12, 73728, v4
    v_add_u32 v13, 110592, v4
    v_add_u32 v14, s32, v4
    v_add_u32 v15, 4096, v4
    v_add_u32 v5, 8192, v4
    v_add_u32 v7, 12288, v4
    s_lshl_b32 s34, s26, 2
    s_add_u32 s34, s34, s3
    s_mul_i32 s34, s34, 18432
    s_mul_i32 s35, s28, 2359296
    s_add_u32 s34, s34, s35
    s_add_u32 s34, s34, 14155776
    s_waitcnt vmcnt(0)
    s_barrier
    s_mov_b32 s46, 47638528
    s_mov_b32 s47, 0x40000
    s_nop 0
L_poll_36:
    buffer_load_dword v252, v249, s[8:11], s46 offen sc1
    s_waitcnt vmcnt(0)
    v_cmp_ne_u32 vcc, 1, v252
    s_cbranch_vccz L_pd_37
    s_sub_u32 s47, s47, 1
    s_cbranch_scc0 L_poll_36
L_pd_37:
    s_barrier
L_p6_22:
    s_add_u32 m0, s32, 0
    s_nop 0
    buffer_load_dwordx4 v4, s[8:11], s40 offen offset:0 sc1 lds
    buffer_load_dwordx4 v4, s[8:11], s40 offen offset:1024 sc1 lds
    buffer_load_dwordx4 v4, s[8:11], s40 offen offset:2048 sc1 lds
    buffer_load_dwordx4 v4, s[8:11], s40 offen offset:3072 sc1 lds
    s_add_u32 m0, s32, 4096
    s_add_u32 s40, s40, 4096
    buffer_load_dwordx4 v4, s[8:11], s40 offen offset:0 sc1 lds
    buffer_load_dwordx4 v4, s[8:11], s40 offen offset:1024 sc1 lds
    buffer_load_dwordx4 v4, s[8:11], s40 offen offset:2048 sc1 lds
    buffer_load_dwordx4 v4, s[8:11], s40 offen offset:3072 sc1 lds
    s_add_u32 m0, s32, 8192
    s_add_u32 s40, s40, 4096
    buffer_load_dwordx4 v4, s[8:11], s40 offen offset:0 sc1 lds
    buffer_load_dwordx4 v4, s[8:11], s40 offen offset:1024 sc1 lds
    buffer_load_dwordx4 v4, s[8:11], s40 offen offset:2048 sc1 lds
    buffer_load_dwordx4 v4, s[8:11], s40 offen offset:3072 sc1 lds
    s_add_u32 m0, s32, 12288
    s_add_u32 s40, s40, 4096
    buffer_load_dwordx4 v4, s[8:11], s40 offen offset:0 sc1 lds
    buffer_load_dwordx4 v4, s[8:11], s40 offen offset:1024 sc1 lds
    buffer_load_dwordx4 v4, s[8:11], s40 offen offset:2048 sc1 lds
    buffer_load_dwordx4 v4, s[8:11], s40 offen offset:3072 sc1 lds
    s_add_u32 m0, s32, 16384
    s_add_u32 s40, s40, 4096
    buffer_load_dwordx4 v4, s[8:11], s40 offen offset:0 sc1 lds
    buffer_load_dwordx4 v4, s[8:11], s40 offen offset:1024 sc1 lds
    s_waitcnt vmcnt(14)
    s_barrier
    ds_read_b128 a[0:3], v4 offset:0
    ds_read_b128 a[4:7], v4 offset:18432
    ds_read_b128 a[8:11], v11 offset:0
    ds_read_b128 a[12:15], v11 offset:18432
    ds_read_b128 a[16:19], v4 offset:1024
    ds_read_b128 a[20:23], v4 offset:19456
    ds_read_b128 a[24:27], v11 offset:1024
    ds_read_b128 a[28:31], v11 offset:19456
    ds_read_b128 a[32:35], v4 offset:2048
    ds_read_b128 a[36:39], v4 offset:20480
    ds_read_b128 a[40:43], v11 offset:2048
    ds_read_b128 a[44:47], v11 offset:20480
    s_waitcnt lgkmcnt(8)
    v_mfma_f32_16x16x32_bf16 v[48:51], v[104:107], a[0:3], 0
    v_mfma_f32_16x16x32_bf16 v[52:55], v[104:107], a[4:7], 0
    buffer_load_dwordx4 v[212:215], v4, s[8:11], s30 offen offset:3072 sc1
    v_mfma_f32_16x16x32_bf16 v[56:59], v[104:107], a[8:11], 0
    v_mfma_f32_16x16x32_bf16 v[60:63], v[104:107], a[12:15], 0
    s_add_u32 s30, s30, 4096
    buffer_load_dwordx4 v[216:219], v4, s[8:11], s30 offen offset:0 sc1
    buffer_load_dwordx2 v[64:65], v6, s[8:11], s37 offen offset:0 sc1
    buffer_load_dwordx2 v[66:67], v6, s[8:11], s37 offen offset:128 sc1
    buffer_load_dwordx2 v[68:69], v6, s[8:11], s37 offen offset:256 sc1
    ds_read_b128 a[48:51], v4 offset:3072
    ds_read_b128 a[52:55], v4 offset:21504
    ds_read_b128 a[56:59], v11 offset:3072
    ds_read_b128 a[60:63], v11 offset:21504
    s_waitcnt lgkmcnt(8)
    v_mfma_f32_16x16x32_bf16 v[48:51], v[108:111], a[16:19], v[48:51]
    v_mfma_f32_16x16x32_bf16 v[52:55], v[108:111], a[20:23], v[52:55]
    buffer_load_dwordx4 v[220:223], v4, s[8:11], s30 offen offset:1024 sc1
    v_mfma_f32_16x16x32_bf16 v[56:59], v[108:111], a[24:27], v[56:59]
    v_mfma_f32_16x16x32_bf16 v[60:63], v[108:111], a[28:31], v[60:63]
    buffer_load_dwordx4 v[224:227], v4, s[8:11], s30 offen offset:2048 sc1
    buffer_load_dwordx2 v[70:71], v6, s[8:11], s37 offen offset:2048 sc1
    buffer_load_dwordx2 v[72:73], v6, s[8:11], s37 offen offset:2176 sc1
    buffer_load_dwordx2 v[74:75], v6, s[8:11], s37 offen offset:2304 sc1
    s_waitcnt vmcnt(18)
    s_barrier
    ds_read_b128 a[64:67], v4 offset:4096
    ds_read_b128 a[68:71], v4 offset:22528
    ds_read_b128 a[72:75], v11 offset:4096
    ds_read_b128 a[76:79], v11 offset:22528
    s_waitcnt lgkmcnt(8)
    v_mfma_f32_16x16x32_bf16 v[48:51], v[112:115], a[32:35], v[48:51]
    v_mfma_f32_16x16x32_bf16 v[52:55], v[112:115], a[36:39], v[52:55]
    buffer_load_dwordx4 v[228:231], v4, s[8:11], s30 offen offset:3072 sc1
    v_mfma_f32_16x16x32_bf16 v[56:59], v[112:115], a[40:43], v[56:59]
    v_mfma_f32_16x16x32_bf16 v[60:63], v[112:115], a[44:47], v[60:63]
    s_add_u32 s30, s30, 4096
    buffer_load_dwordx4 v[104:107], v4, s[8:11], s30 offen offset:0 sc1
    ds_read_b128 a[80:83], v4 offset:5120
    ds_read_b128 a[84:87], v4 offset:23552
    ds_read_b128 a[88:91], v11 offset:5120
    ds_read_b128 a[92:95], v11 offset:23552
    s_waitcnt lgkmcnt(8)
    v_mfma_f32_16x16x32_bf16 v[48:51], v[116:119], a[48:51], v[48:51]
    v_mfma_f32_16x16x32_bf16 v[52:55], v[116:119], a[52:55], v[52:55]
    buffer_load_dwordx4 v[108:111], v4, s[8:11], s30 offen offset:1024 sc1
    v_mfma_f32_16x16x32_bf16 v[56:59], v[116:119], a[56:59], v[56:59]
    v_mfma_f32_16x16x32_bf16 v[60:63], v[116:119], a[60:63], v[60:63]
    buffer_load_dwordx4 v[112:115], v4, s[8:11], s30 offen offset:2048 sc1
    ds_read_b128 a[96:99], v4 offset:6144
    ds_read_b128 a[100:103], v4 offset:24576
    ds_read_b128 a[104:107], v11 offset:6144
    ds_read_b128 a[108:111], v11 offset:24576
    s_waitcnt lgkmcnt(8)
    v_mfma_f32_16x16x32_bf16 v[48:51], v[120:123], a[64:67], v[48:51]
    v_mfma_f32_16x16x32_bf16 v[52:55], v[120:123], a[68:71], v[52:55]
    buffer_load_dwordx4 v[116:119], v4, s[8:11], s30 offen offset:3072 sc1
    v_mfma_f32_16x16x32_bf16 v[56:59], v[120:123], a[72:75], v[56:59]
    v_mfma_f32_16x16x32_bf16 v[60:63], v[120:123], a[76:79], v[60:63]
    s_add_u32 s30, s30, 4096
    buffer_load_dwordx4 v[120:123], v4, s[8:11], s30 offen offset:0 sc1
    ds_read_b128 a[112:115], v4 offset:7168
    ds_read_b128 a[116:119], v4 offset:25600
    ds_read_b128 a[120:123], v11 offset:7168
    ds_read_b128 a[124:127], v11 offset:25600
    s_waitcnt lgkmcnt(8)
    v_mfma_f32_16x16x32_bf16 v[48:51], v[124:127], a[80:83], v[48:51]
    v_mfma_f32_16x16x32_bf16 v[52:55], v[124:127], a[84:87], v[52:55]
    v_mfma_f32_16x16x32_bf16 v[56:59], v[124:127], a[88:91], v[56:59]
    v_mfma_f32_16x16x32_bf16 v[60:63], v[124:127], a[92:95], v[60:63]
    buffer_load_dwordx4 v[124:127], v4, s[8:11], s30 offen offset:1024 sc1
    ds_read_b128 a[128:131], v4 offset:8192
    ds_read_b128 a[132:135], v4 offset:26624
    ds_read_b128 a[136:139], v11 offset:8192
    ds_read_b128 a[140:143], v11 offset:26624
    s_waitcnt lgkmcnt(8)
    v_mfma_f32_16x16x32_bf16 v[48:51], v[128:131], a[96:99], v[48:51]
    v_mfma_f32_16x16x32_bf16 v[52:55], v[128:131], a[100:103], v[52:55]
    v_mfma_f32_16x16x32_bf16 v[56:59], v[128:131], a[104:107], v[56:59]
    v_mfma_f32_16x16x32_bf16 v[60:63], v[128:131], a[108:111], v[60:63]
    buffer_load_dwordx4 v[128:131], v4, s[8:11], s30 offen offset:2048 sc1
    ds_read_b128 a[144:147], v4 offset:9216
    ds_read_b128 a[148:151], v4 offset:27648
    ds_read_b128 a[152:155], v11 offset:9216
    ds_read_b128 a[156:159], v11 offset:27648
    s_waitcnt lgkmcnt(8)
    v_mfma_f32_16x16x32_bf16 v[48:51], v[132:135], a[112:115], v[48:51]
    v_mfma_f32_16x16x32_bf16 v[52:55], v[132:135], a[116:119], v[52:55]
    v_mfma_f32_16x16x32_bf16 v[56:59], v[132:135], a[120:123], v[56:59]
    v_mfma_f32_16x16x32_bf16 v[60:63], v[132:135], a[124:127], v[60:63]
    buffer_load_dwordx4 v[132:135], v4, s[8:11], s30 offen offset:3072 sc1
    s_waitcnt vmcnt(19)
    s_barrier
    ds_read_b128 a[160:163], v4 offset:10240
    ds_read_b128 a[164:167], v4 offset:28672
    ds_read_b128 a[168:171], v11 offset:10240
    ds_read_b128 a[172:175], v11 offset:28672
    s_waitcnt lgkmcnt(8)
    v_mfma_f32_16x16x32_bf16 v[48:51], v[136:139], a[128:131], v[48:51]
    v_mfma_f32_16x16x32_bf16 v[52:55], v[136:139], a[132:135], v[52:55]
    v_mfma_f32_16x16x32_bf16 v[56:59], v[136:139], a[136:139], v[56:59]
    v_mfma_f32_16x16x32_bf16 v[60:63], v[136:139], a[140:143], v[60:63]
    s_add_u32 s30, s30, 4096
    buffer_load_dwordx4 v[136:139], v4, s[8:11], s30 offen offset:0 sc1
    ds_read_b128 a[176:179], v4 offset:11264
    ds_read_b128 a[180:183], v4 offset:29696
    ds_read_b128 a[184:187], v11 offset:11264
    ds_read_b128 a[188:191], v11 offset:29696
    s_waitcnt lgkmcnt(8)
    v_mfma_f32_16x16x32_bf16 v[48:51], v[140:143], a[144:147], v[48:51]
    s_waitcnt vmcnt(10)
    v_add_f32 v76, v64, v66
    v_add_f32 v76, v76, v68
    v_mfma_f32_16x16x32_bf16 v[52:55], v[140:143], a[148:151], v[52:55]
    v_add_f32 v77, v65, v67
    v_add_f32 v77, v77, v69
    v_mfma_f32_16x16x32_bf16 v[56:59], v[140:143], a[152:155], v[56:59]
    v_add_f32 v78, v70, v72
    v_add_f32 v78, v78, v74
    v_mfma_f32_16x16x32_bf16 v[60:63], v[140:143], a[156:159], v[60:63]
    buffer_load_dwordx4 v[140:143], v4, s[8:11], s30 offen offset:1024 sc1
    v_add_f32 v79, v71, v73
    v_add_f32 v79, v79, v75
    v_mov_b32 v92, v76
    ds_read_b128 a[192:195], v4 offset:12288
    ds_read_b128 a[196:199], v4 offset:30720
    ds_read_b128 a[200:203], v11 offset:12288
    ds_read_b128 a[204:207], v11 offset:30720
    s_waitcnt lgkmcnt(8)
    v_mfma_f32_16x16x32_bf16 v[48:51], v[144:147], a[160:163], v[48:51]
    v_mov_b32 v93, v77
    v_mov_b32 v94, v78
    v_mfma_f32_16x16x32_bf16 v[52:55], v[144:147], a[164:167], v[52:55]
    v_mov_b32 v95, v79
    s_nop 0
    v_mfma_f32_16x16x32_bf16 v[56:59], v[144:147], a[168:171], v[56:59]
    v_permlane32_swap_b32 v76, v92
    v_permlane32_swap_b32 v77, v93
    v_mfma_f32_16x16x32_bf16 v[60:63], v[144:147], a[172:175], v[60:63]
    buffer_load_dwordx4 v[144:147], v4, s[8:11], s30 offen offset:2048 sc1
    v_permlane32_swap_b32 v78, v94
    v_permlane32_swap_b32 v79, v95
    v_add_f32 v76, v76, v92
    ds_read_b128 a[208:211], v4 offset:13312
    ds_read_b128 a[212:215], v4 offset:31744
    ds_read_b128 a[216:219], v11 offset:13312
    ds_read_b128 a[220:223], v11 offset:31744
    s_waitcnt lgkmcnt(8)
    v_mfma_f32_16x16x32_bf16 v[48:51], v[148:151], a[176:179], v[48:51]
    v_add_f32 v77, v77, v93
    v_add_f32 v78, v78, v94
    v_mfma_f32_16x16x32_bf16 v[52:55], v[148:151], a[180:183], v[52:55]
    v_add_f32 v79, v79, v95
    v_mov_b32 v92, v76
    v_mfma_f32_16x16x32_bf16 v[56:59], v[148:151], a[184:187], v[56:59]
    v_mov_b32 v93, v77
    v_mov_b32 v94, v78
    v_mfma_f32_16x16x32_bf16 v[60:63], v[148:151], a[188:191], v[60:63]
    buffer_load_dwordx4 v[148:151], v4, s[8:11], s30 offen offset:3072 sc1
    v_mov_b32 v95, v79
    s_nop 0
    v_permlane16_swap_b32 v76, v92
    ds_read_b128 a[224:227], v4 offset:14336
    ds_read_b128 a[228:231], v4 offset:32768
    ds_read_b128 a[232:235], v11 offset:14336
    ds_read_b128 a[236:239], v11 offset:32768
    s_waitcnt lgkmcnt(8)
    v_mfma_f32_16x16x32_bf16 v[48:51], v[152:155], a[192:195], v[48:51]
    v_permlane16_swap_b32 v77, v93
    v_permlane16_swap_b32 v78, v94
    v_mfma_f32_16x16x32_bf16 v[52:55], v[152:155], a[196:199], v[52:55]
    v_permlane16_swap_b32 v79, v95
    v_add_f32 v76, v76, v92
    v_mfma_f32_16x16x32_bf16 v[56:59], v[152:155], a[200:203], v[56:59]
    v_add_f32 v77, v77, v93
    v_add_f32 v78, v78, v94
    v_mfma_f32_16x16x32_bf16 v[60:63], v[152:155], a[204:207], v[60:63]
    s_add_u32 s30, s30, 4096
    buffer_load_dwordx4 v[152:155], v4, s[8:11], s30 offen offset:0 sc1
    v_add_f32 v79, v79, v95
    v_mul_f32 v76, 0x3ae38e39, v76
    v_mul_f32 v77, 0x3ae38e39, v77
    ds_read_b128 a[240:243], v4 offset:15360
    ds_read_b128 a[244:247], v4 offset:33792
    ds_read_b128 a[248:251], v11 offset:15360
    ds_read_b128 a[252:255], v11 offset:33792
    s_waitcnt lgkmcnt(8)
    v_mfma_f32_16x16x32_bf16 v[48:51], v[156:159], a[208:211], v[48:51]
    v_mul_f32 v78, 0x3ae38e39, v78
    v_mul_f32 v79, 0x3ae38e39, v79
    v_mfma_f32_16x16x32_bf16 v[52:55], v[156:159], a[212:215], v[52:55]
    v_add_f32 v76, 0x3727c5ac, v76
    v_add_f32 v77, 0x3727c5ac, v77
    v_mfma_f32_16x16x32_bf16 v[56:59], v[156:159], a[216:219], v[56:59]
    v_add_f32 v78, 0x3727c5ac, v78
    v_add_f32 v79, 0x3727c5ac, v79
    v_rsq_f32 v76, v76
    v_mfma_f32_16x16x32_bf16 v[60:63], v[156:159], a[220:223], v[60:63]
    buffer_load_dwordx4 v[156:159], v4, s[8:11], s30 offen offset:1024 sc1
    v_rsq_f32 v77, v77
    v_rsq_f32 v78, v78
    ds_read_b128 v[16:19], v4 offset:16384
    ds_read_b128 v[20:23], v4 offset:34816
    ds_read_b128 v[24:27], v11 offset:16384
    ds_read_b128 v[28:31], v11 offset:34816
    s_waitcnt lgkmcnt(8)
    v_mfma_f32_16x16x32_bf16 v[48:51], v[160:163], a[224:227], v[48:51]
    v_rsq_f32 v79, v79
    s_nop 0
    v_mfma_f32_16x16x32_bf16 v[52:55], v[160:163], a[228:231], v[52:55]
    v_rcp_f32 v88, v76
    v_mul_f32 v80, 0xc0135761, v76
    v_mfma_f32_16x16x32_bf16 v[56:59], v[160:163], a[232:235], v[56:59]
    v_mul_f32 v84, v76, v76
    v_mul_f32 v84, v84, v76
    v_mul_f32 v84, 0xbdd2d3e8, v84
    v_mfma_f32_16x16x32_bf16 v[60:63], v[160:163], a[236:239], v[60:63]
    buffer_load_dwordx4 v[160:163], v4, s[8:11], s30 offen offset:2048 sc1
    v_rcp_f32 v89, v77
    v_mul_f32 v81, 0xc0135761, v77
    ds_read_b128 v[32:35], v4 offset:17408
    ds_read_b128 v[36:39], v4 offset:35840
    ds_read_b128 v[40:43], v11 offset:17408
    ds_read_b128 v[44:47], v11 offset:35840
    s_waitcnt lgkmcnt(8)
    v_mfma_f32_16x16x32_bf16 v[48:51], v[164:167], a[240:243], v[48:51]
    v_mul_f32 v85, v77, v77
    v_mul_f32 v85, v85, v77
    v_mfma_f32_16x16x32_bf16 v[52:55], v[164:167], a[244:247], v[52:55]
    v_mul_f32 v85, 0xbdd2d3e8, v85
    v_rcp_f32 v90, v78
    v_mfma_f32_16x16x32_bf16 v[56:59], v[164:167], a[248:251], v[56:59]
    v_mul_f32 v82, 0xc0135761, v78
    v_mul_f32 v86, v78, v78
    v_mul_f32 v86, v86, v78
    v_mfma_f32_16x16x32_bf16 v[60:63], v[164:167], a[252:255], v[60:63]
    buffer_load_dwordx4 v[164:167], v4, s[8:11], s30 offen offset:3072 sc1
    v_mul_f32 v86, 0xbdd2d3e8, v86
    v_rcp_f32 v91, v79
    s_waitcnt lgkmcnt(4)
    v_mfma_f32_16x16x32_bf16 v[48:51], v[168:171], v[16:19], v[48:51]
    v_mul_f32 v83, 0xc0135761, v79
    v_mul_f32 v87, v79, v79
    v_mfma_f32_16x16x32_bf16 v[52:55], v[168:171], v[20:23], v[52:55]
    v_mul_f32 v87, v87, v79
    v_mul_f32 v87, 0xbdd2d3e8, v87
    v_mfma_f32_16x16x32_bf16 v[56:59], v[168:171], v[24:27], v[56:59]
    v_mfma_f32_16x16x32_bf16 v[60:63], v[168:171], v[28:31], v[60:63]
    s_add_u32 s30, s30, 4096
    buffer_load_dwordx4 v[168:171], v4, s[8:11], s30 offen offset:0 sc1
    s_waitcnt lgkmcnt(0)
    v_mfma_f32_16x16x32_bf16 v[64:67], v[172:175], v[32:35], v[48:51]
    v_mfma_f32_16x16x32_bf16 v[68:71], v[172:175], v[36:39], v[52:55]
    v_mfma_f32_16x16x32_bf16 v[72:75], v[172:175], v[40:43], v[56:59]
    v_mfma_f32_16x16x32_bf16 v[76:79], v[172:175], v[44:47], v[60:63]
    buffer_load_dwordx4 v[172:175], v4, s[8:11], s30 offen offset:1024 sc1
    v_mfma_f32_16x16x32_bf16 v[48:51], v[176:179], a[0:3], 0
    v_mfma_f32_16x16x32_bf16 v[52:55], v[176:179], a[4:7], 0
    v_mfma_f32_16x16x32_bf16 v[56:59], v[176:179], a[8:11], 0
    v_mfma_f32_16x16x32_bf16 v[60:63], v[176:179], a[12:15], 0
    buffer_load_dwordx4 v[176:179], v4, s[8:11], s30 offen offset:2048 sc1
    v_mfma_f32_16x16x32_bf16 v[48:51], v[180:183], a[16:19], v[48:51]
    v_mul_f32 v92, v64, v64
    v_mul_f32 v93, v65, v65
    v_mfma_f32_16x16x32_bf16 v[52:55], v[180:183], a[20:23], v[52:55]
    v_mul_f32 v94, v66, v66
    v_mul_f32 v95, v67, v67
    v_mfma_f32_16x16x32_bf16 v[56:59], v[180:183], a[24:27], v[56:59]
    v_fma_f32 v92, v92, v84, v80
    v_fma_f32 v93, v93, v84, v80
    v_mfma_f32_16x16x32_bf16 v[60:63], v[180:183], a[28:31], v[60:63]
    buffer_load_dwordx4 v[180:183], v4, s[8:11], s30 offen offset:3072 sc1
    v_fma_f32 v94, v94, v84, v80
    v_fma_f32 v95, v95, v84, v80
    v_mfma_f32_16x16x32_bf16 v[48:51], v[184:187], a[32:35], v[48:51]
    v_mul_f32 v92, v92, v64
    v_mul_f32 v93, v93, v65
    v_mfma_f32_16x16x32_bf16 v[52:55], v[184:187], a[36:39], v[52:55]
    v_mul_f32 v94, v94, v66
    v_mul_f32 v95, v95, v67
    v_mfma_f32_16x16x32_bf16 v[56:59], v[184:187], a[40:43], v[56:59]
    v_exp_f32 v92, v92
    v_exp_f32 v93, v93
    v_mfma_f32_16x16x32_bf16 v[60:63], v[184:187], a[44:47], v[60:63]
    s_add_u32 s30, s30, 4096
    buffer_load_dwordx4 v[184:187], v4, s[8:11], s30 offen offset:0 sc1
    v_exp_f32 v94, v94
    v_exp_f32 v95, v95
    v_mfma_f32_16x16x32_bf16 v[48:51], v[188:191], a[48:51], v[48:51]
    v_fma_f32 v92, v92, v88, v88
    v_fma_f32 v93, v93, v88, v88
    v_mfma_f32_16x16x32_bf16 v[52:55], v[188:191], a[52:55], v[52:55]
    v_fma_f32 v94, v94, v88, v88
    v_fma_f32 v95, v95, v88, v88
    v_mfma_f32_16x16x32_bf16 v[56:59], v[188:191], a[56:59], v[56:59]
    v_rcp_f32 v92, v92
    v_rcp_f32 v93, v93
    v_mfma_f32_16x16x32_bf16 v[60:63], v[188:191], a[60:63], v[60:63]
    buffer_load_dwordx4 v[188:191], v4, s[8:11], s30 offen offset:1024 sc1
    v_rcp_f32 v94, v94
    v_rcp_f32 v95, v95
    v_mfma_f32_16x16x32_bf16 v[48:51], v[192:195], a[64:67], v[48:51]
    v_mul_f32 v92, v92, v64
    v_mul_f32 v93, v93, v65
    v_mfma_f32_16x16x32_bf16 v[52:55], v[192:195], a[68:71], v[52:55]
    v_mul_f32 v94, v94, v66
    v_mul_f32 v95, v95, v67
    v_mfma_f32_16x16x32_bf16 v[56:59], v[192:195], a[72:75], v[56:59]
    v_cvt_pk_bf16_f32 v96, v92, v93
    v_cvt_pk_bf16_f32 v97, v94, v95
    v_mfma_f32_16x16x32_bf16 v[60:63], v[192:195], a[76:79], v[60:63]
    buffer_load_dwordx4 v[192:195], v4, s[8:11], s30 offen offset:2048 sc1
    ds_write_b64 v8, v[96:97] offset:0
    v_mul_f32 v92, v68, v68
    v_mfma_f32_16x16x32_bf16 v[48:51], v[196:199], a[80:83], v[48:51]
    v_mul_f32 v93, v69, v69
    v_mul_f32 v94, v70, v70
    v_mfma_f32_16x16x32_bf16 v[52:55], v[196:199], a[84:87], v[52:55]
    v_mul_f32 v95, v71, v71
    v_fma_f32 v92, v92, v85, v81
    v_mfma_f32_16x16x32_bf16 v[56:59], v[196:199], a[88:91], v[56:59]
    v_fma_f32 v93, v93, v85, v81
    v_fma_f32 v94, v94, v85, v81
    v_mfma_f32_16x16x32_bf16 v[60:63], v[196:199], a[92:95], v[60:63]
    buffer_load_dwordx4 v[196:199], v4, s[8:11], s30 offen offset:3072 sc1
    v_fma_f32 v95, v95, v85, v81
    v_mul_f32 v92, v92, v68
    v_mfma_f32_16x16x32_bf16 v[48:51], v[200:203], a[96:99], v[48:51]
    v_mul_f32 v93, v93, v69
    v_mul_f32 v94, v94, v70
    v_mfma_f32_16x16x32_bf16 v[52:55], v[200:203], a[100:103], v[52:55]
    v_mul_f32 v95, v95, v71
    v_exp_f32 v92, v92
    v_mfma_f32_16x16x32_bf16 v[56:59], v[200:203], a[104:107], v[56:59]
    v_exp_f32 v93, v93
    v_exp_f32 v94, v94
    v_mfma_f32_16x16x32_bf16 v[60:63], v[200:203], a[108:111], v[60:63]
    s_add_u32 s30, s30, 4096
    buffer_load_dwordx4 v[200:203], v4, s[8:11], s30 offen offset:0 sc1
    v_exp_f32 v95, v95
    v_fma_f32 v92, v92, v89, v89
    v_mfma_f32_16x16x32_bf16 v[48:51], v[204:207], a[112:115], v[48:51]
    v_fma_f32 v93, v93, v89, v89
    v_fma_f32 v94, v94, v89, v89
    v_mfma_f32_16x16x32_bf16 v[52:55], v[204:207], a[116:119], v[52:55]
    v_fma_f32 v95, v95, v89, v89
    v_rcp_f32 v92, v92
    v_mfma_f32_16x16x32_bf16 v[56:59], v[204:207], a[120:123], v[56:59]
    v_rcp_f32 v93, v93
    v_rcp_f32 v94, v94
    v_mfma_f32_16x16x32_bf16 v[60:63], v[204:207], a[124:127], v[60:63]
    buffer_load_dwordx4 v[204:207], v4, s[8:11], s30 offen offset:1024 sc1
    v_rcp_f32 v95, v95
    v_mul_f32 v92, v92, v68
    v_mfma_f32_16x16x32_bf16 v[48:51], v[208:211], a[128:131], v[48:51]
    v_mul_f32 v93, v93, v69
    v_mul_f32 v94, v94, v70
    v_mfma_f32_16x16x32_bf16 v[52:55], v[208:211], a[132:135], v[52:55]
    v_mul_f32 v95, v95, v71
    v_cvt_pk_bf16_f32 v98, v92, v93
    v_mfma_f32_16x16x32_bf16 v[56:59], v[208:211], a[136:139], v[56:59]
    v_cvt_pk_bf16_f32 v99, v94, v95
    ds_write_b64 v8, v[98:99] offset:18432
    v_mfma_f32_16x16x32_bf16 v[60:63], v[208:211], a[140:143], v[60:63]
    buffer_load_dwordx4 v[208:211], v4, s[8:11], s30 offen offset:2048 sc1
    v_mul_f32 v92, v72, v72
    v_mul_f32 v93, v73, v73
    v_mfma_f32_16x16x32_bf16 v[48:51], v[212:215], a[144:147], v[48:51]
    v_mul_f32 v94, v74, v74
    v_mul_f32 v95, v75, v75
    v_mfma_f32_16x16x32_bf16 v[52:55], v[212:215], a[148:151], v[52:55]
    v_fma_f32 v92, v92, v86, v82
    v_fma_f32 v93, v93, v86, v82
    v_mfma_f32_16x16x32_bf16 v[56:59], v[212:215], a[152:155], v[56:59]
    v_fma_f32 v94, v94, v86, v82
    v_fma_f32 v95, v95, v86, v82
    v_mfma_f32_16x16x32_bf16 v[60:63], v[212:215], a[156:159], v[60:63]
    buffer_load_dwordx4 v[212:215], v4, s[8:11], s30 offen offset:3072 sc1
    v_mul_f32 v92, v92, v72
    v_mul_f32 v93, v93, v73
    v_mfma_f32_16x16x32_bf16 v[48:51], v[216:219], a[160:163], v[48:51]
    v_mul_f32 v94, v94, v74
    v_mul_f32 v95, v95, v75
    v_mfma_f32_16x16x32_bf16 v[52:55], v[216:219], a[164:167], v[52:55]
    v_exp_f32 v92, v92
    v_exp_f32 v93, v93
    v_mfma_f32_16x16x32_bf16 v[56:59], v[216:219], a[168:171], v[56:59]
    v_exp_f32 v94, v94
    v_exp_f32 v95, v95
    v_mfma_f32_16x16x32_bf16 v[60:63], v[216:219], a[172:175], v[60:63]
    s_add_u32 s30, s30, 4096
    buffer_load_dwordx4 v[216:219], v4, s[8:11], s30 offen offset:0 sc1
    v_fma_f32 v92, v92, v90, v90
    v_fma_f32 v93, v93, v90, v90
    v_mfma_f32_16x16x32_bf16 v[48:51], v[220:223], a[176:179], v[48:51]
    v_fma_f32 v94, v94, v90, v90
    v_fma_f32 v95, v95, v90, v90
    v_mfma_f32_16x16x32_bf16 v[52:55], v[220:223], a[180:183], v[52:55]
    v_rcp_f32 v92, v92
    v_rcp_f32 v93, v93
    v_mfma_f32_16x16x32_bf16 v[56:59], v[220:223], a[184:187], v[56:59]
    v_rcp_f32 v94, v94
    v_rcp_f32 v95, v95
    v_mfma_f32_16x16x32_bf16 v[60:63], v[220:223], a[188:191], v[60:63]
    buffer_load_dwordx4 v[220:223], v4, s[8:11], s30 offen offset:1024 sc1
    v_mul_f32 v92, v92, v72
    v_mul_f32 v93, v93, v73
    s_waitcnt vmcnt(30)
    v_mfma_f32_16x16x32_bf16 v[48:51], v[224:227], a[192:195], v[48:51]
    v_mul_f32 v94, v94, v74
    v_mul_f32 v95, v95, v75
    v_mfma_f32_16x16x32_bf16 v[52:55], v[224:227], a[196:199], v[52:55]
    v_cvt_pk_bf16_f32 v100, v92, v93
    v_cvt_pk_bf16_f32 v101, v94, v95
    v_mfma_f32_16x16x32_bf16 v[56:59], v[224:227], a[200:203], v[56:59]
    ds_write_b64 v9, v[100:101] offset:0
    v_mul_f32 v92, v76, v76
    v_mfma_f32_16x16x32_bf16 v[60:63], v[224:227], a[204:207], v[60:63]
    buffer_load_dwordx4 v[224:227], v4, s[8:11], s30 offen offset:2048 sc1
    v_mul_f32 v93, v77, v77
    v_mul_f32 v94, v78, v78
    v_mfma_f32_16x16x32_bf16 v[48:51], v[228:231], a[208:211], v[48:51]
    v_mul_f32 v95, v79, v79
    v_fma_f32 v92, v92, v87, v83
    v_mfma_f32_16x16x32_bf16 v[52:55], v[228:231], a[212:215], v[52:55]
    v_fma_f32 v93, v93, v87, v83
    v_fma_f32 v94, v94, v87, v83
    v_mfma_f32_16x16x32_bf16 v[56:59], v[228:231], a[216:219], v[56:59]
    v_fma_f32 v95, v95, v87, v83
    v_mul_f32 v92, v92, v76
    v_mfma_f32_16x16x32_bf16 v[60:63], v[228:231], a[220:223], v[60:63]
    buffer_load_dwordx4 v[228:231], v4, s[8:11], s30 offen offset:3072 sc1
    v_mul_f32 v93, v93, v77
    v_mul_f32 v94, v94, v78
    s_waitcnt vmcnt(30)
    v_mfma_f32_16x16x32_bf16 v[48:51], v[104:107], a[224:227], v[48:51]
    v_mul_f32 v95, v95, v79
    v_exp_f32 v92, v92
    v_mfma_f32_16x16x32_bf16 v[52:55], v[104:107], a[228:231], v[52:55]
    v_exp_f32 v93, v93
    v_exp_f32 v94, v94
    v_mfma_f32_16x16x32_bf16 v[56:59], v[104:107], a[232:235], v[56:59]
    v_exp_f32 v95, v95
    v_fma_f32 v92, v92, v91, v91
    v_mfma_f32_16x16x32_bf16 v[60:63], v[104:107], a[236:239], v[60:63]
    s_add_u32 s30, s30, 4096
    buffer_load_dwordx4 v[104:107], v4, s[8:11], s30 offen offset:0 sc1
    v_fma_f32 v93, v93, v91, v91
    v_fma_f32 v94, v94, v91, v91
    v_mfma_f32_16x16x32_bf16 v[48:51], v[108:111], a[240:243], v[48:51]
    v_fma_f32 v95, v95, v91, v91
    v_rcp_f32 v92, v92
    v_mfma_f32_16x16x32_bf16 v[52:55], v[108:111], a[244:247], v[52:55]
    v_rcp_f32 v93, v93
    v_rcp_f32 v94, v94
    v_mfma_f32_16x16x32_bf16 v[56:59], v[108:111], a[248:251], v[56:59]
    v_rcp_f32 v95, v95
    v_mul_f32 v92, v92, v76
    v_mfma_f32_16x16x32_bf16 v[60:63], v[108:111], a[252:255], v[60:63]
    buffer_load_dwordx4 v[108:111], v4, s[8:11], s30 offen offset:1024 sc1
    v_mul_f32 v93, v93, v77
    v_mul_f32 v94, v94, v78
    s_waitcnt vmcnt(30)
    v_mfma_f32_16x16x32_bf16 v[48:51], v[112:115], v[16:19], v[48:51]
    v_mul_f32 v95, v95, v79
    v_cvt_pk_bf16_f32 v102, v92, v93
    v_mfma_f32_16x16x32_bf16 v[52:55], v[112:115], v[20:23], v[52:55]
    v_cvt_pk_bf16_f32 v103, v94, v95
    ds_write_b64 v9, v[102:103] offset:18432
    v_mfma_f32_16x16x32_bf16 v[56:59], v[112:115], v[24:27], v[56:59]
    v_mfma_f32_16x16x32_bf16 v[60:63], v[112:115], v[28:31], v[60:63]
    buffer_load_dwordx4 v[112:115], v4, s[8:11], s30 offen offset:2048 sc1
    v_mfma_f32_16x16x32_bf16 v[64:67], v[116:119], v[32:35], v[48:51]
    v_mfma_f32_16x16x32_bf16 v[68:71], v[116:119], v[36:39], v[52:55]
    v_mfma_f32_16x16x32_bf16 v[72:75], v[116:119], v[40:43], v[56:59]
    v_mfma_f32_16x16x32_bf16 v[76:79], v[116:119], v[44:47], v[60:63]
    buffer_load_dwordx4 v[116:119], v4, s[8:11], s30 offen offset:3072 sc1
    s_waitcnt vmcnt(30)
    v_mfma_f32_16x16x32_bf16 v[48:51], v[120:123], a[0:3], 0
    v_mfma_f32_16x16x32_bf16 v[52:55], v[120:123], a[4:7], 0
    v_mfma_f32_16x16x32_bf16 v[56:59], v[120:123], a[8:11], 0
    v_mfma_f32_16x16x32_bf16 v[60:63], v[120:123], a[12:15], 0
    s_add_u32 s30, s30, 4096
    buffer_load_dwordx4 v[120:123], v4, s[8:11], s30 offen offset:0 sc1
    v_mfma_f32_16x16x32_bf16 v[48:51], v[124:127], a[16:19], v[48:51]
    v_mul_f32 v92, v64, v64
    v_mul_f32 v93, v65, v65
    v_mfma_f32_16x16x32_bf16 v[52:55], v[124:127], a[20:23], v[52:55]
    v_mul_f32 v94, v66, v66
    v_mul_f32 v95, v67, v67
    v_mfma_f32_16x16x32_bf16 v[56:59], v[124:127], a[24:27], v[56:59]
    v_fma_f32 v92, v92, v84, v80
    v_fma_f32 v93, v93, v84, v80
    v_mfma_f32_16x16x32_bf16 v[60:63], v[124:127], a[28:31], v[60:63]
    buffer_load_dwordx4 v[124:127], v4, s[8:11], s30 offen offset:1024 sc1
    v_fma_f32 v94, v94, v84, v80
    v_fma_f32 v95, v95, v84, v80
    s_waitcnt vmcnt(30)
    v_mfma_f32_16x16x32_bf16 v[48:51], v[128:131], a[32:35], v[48:51]
    v_mul_f32 v92, v92, v64
    v_mul_f32 v93, v93, v65
    v_mfma_f32_16x16x32_bf16 v[52:55], v[128:131], a[36:39], v[52:55]
    v_mul_f32 v94, v94, v66
    v_mul_f32 v95, v95, v67
    v_mfma_f32_16x16x32_bf16 v[56:59], v[128:131], a[40:43], v[56:59]
    v_exp_f32 v92, v92
    v_exp_f32 v93, v93
    v_mfma_f32_16x16x32_bf16 v[60:63], v[128:131], a[44:47], v[60:63]
    buffer_load_dwordx4 v[128:131], v4, s[8:11], s30 offen offset:2048 sc1
    v_exp_f32 v94, v94
    v_exp_f32 v95, v95
    v_mfma_f32_16x16x32_bf16 v[48:51], v[132:135], a[48:51], v[48:51]
    v_fma_f32 v92, v92, v88, v88
    v_fma_f32 v93, v93, v88, v88
    v_mfma_f32_16x16x32_bf16 v[52:55], v[132:135], a[52:55], v[52:55]
    v_fma_f32 v94, v94, v88, v88
    v_fma_f32 v95, v95, v88, v88
    v_mfma_f32_16x16x32_bf16 v[56:59], v[132:135], a[56:59], v[56:59]
    v_rcp_f32 v92, v92
    v_rcp_f32 v93, v93
    v_mfma_f32_16x16x32_bf16 v[60:63], v[132:135], a[60:63], v[60:63]
    buffer_load_dwordx4 v[132:135], v4, s[8:11], s30 offen offset:3072 sc1
    v_rcp_f32 v94, v94
    v_rcp_f32 v95, v95
    s_waitcnt vmcnt(30)
    v_mfma_f32_16x16x32_bf16 v[48:51], v[136:139], a[64:67], v[48:51]
    v_mul_f32 v92, v92, v64
    v_mul_f32 v93, v93, v65
    v_mfma_f32_16x16x32_bf16 v[52:55], v[136:139], a[68:71], v[52:55]
    v_mul_f32 v94, v94, v66
    v_mul_f32 v95, v95, v67
    v_mfma_f32_16x16x32_bf16 v[56:59], v[136:139], a[72:75], v[56:59]
    v_cvt_pk_bf16_f32 v96, v92, v93
    v_cvt_pk_bf16_f32 v97, v94, v95
    v_mfma_f32_16x16x32_bf16 v[60:63], v[136:139], a[76:79], v[60:63]
    s_add_u32 s30, s30, 4096
    buffer_load_dwordx4 v[136:139], v4, s[8:11], s30 offen offset:0 sc1
    ds_write_b64 v8, v[96:97] offset:2048
    v_mul_f32 v92, v68, v68
    v_mfma_f32_16x16x32_bf16 v[48:51], v[140:143], a[80:83], v[48:51]
    v_mul_f32 v93, v69, v69
    v_mul_f32 v94, v70, v70
    v_mfma_f32_16x16x32_bf16 v[52:55], v[140:143], a[84:87], v[52:55]
    v_mul_f32 v95, v71, v71
    v_fma_f32 v92, v92, v85, v81
    v_mfma_f32_16x16x32_bf16 v[56:59], v[140:143], a[88:91], v[56:59]
    v_fma_f32 v93, v93, v85, v81
    v_fma_f32 v94, v94, v85, v81
    v_mfma_f32_16x16x32_bf16 v[60:63], v[140:143], a[92:95], v[60:63]
    buffer_load_dwordx4 v[140:143], v4, s[8:11], s30 offen offset:1024 sc1
    v_fma_f32 v95, v95, v85, v81
    v_mul_f32 v92, v92, v68
    s_waitcnt vmcnt(30)
    v_mfma_f32_16x16x32_bf16 v[48:51], v[144:147], a[96:99], v[48:51]
    v_mul_f32 v93, v93, v69
    v_mul_f32 v94, v94, v70
    v_mfma_f32_16x16x32_bf16 v[52:55], v[144:147], a[100:103], v[52:55]
    v_mul_f32 v95, v95, v71
    v_exp_f32 v92, v92
    v_mfma_f32_16x16x32_bf16 v[56:59], v[144:147], a[104:107], v[56:59]
    v_exp_f32 v93, v93
    v_exp_f32 v94, v94
    v_mfma_f32_16x16x32_bf16 v[60:63], v[144:147], a[108:111], v[60:63]
    buffer_load_dwordx4 v[144:147], v4, s[8:11], s30 offen offset:2048 sc1
    v_exp_f32 v95, v95
    v_fma_f32 v92, v92, v89, v89
    v_mfma_f32_16x16x32_bf16 v[48:51], v[148:151], a[112:115], v[48:51]
    v_fma_f32 v93, v93, v89, v89
    v_fma_f32 v94, v94, v89, v89
    v_mfma_f32_16x16x32_bf16 v[52:55], v[148:151], a[116:119], v[52:55]
    v_fma_f32 v95, v95, v89, v89
    v_rcp_f32 v92, v92
    v_mfma_f32_16x16x32_bf16 v[56:59], v[148:151], a[120:123], v[56:59]
    v_rcp_f32 v93, v93
    v_rcp_f32 v94, v94
    v_mfma_f32_16x16x32_bf16 v[60:63], v[148:151], a[124:127], v[60:63]
    buffer_load_dwordx4 v[148:151], v4, s[8:11], s30 offen offset:3072 sc1
    v_rcp_f32 v95, v95
    v_mul_f32 v92, v92, v68
    s_waitcnt vmcnt(30)
    v_mfma_f32_16x16x32_bf16 v[48:51], v[152:155], a[128:131], v[48:51]
    v_mul_f32 v93, v93, v69
    v_mul_f32 v94, v94, v70
    v_mfma_f32_16x16x32_bf16 v[52:55], v[152:155], a[132:135], v[52:55]
    v_mul_f32 v95, v95, v71
    v_cvt_pk_bf16_f32 v98, v92, v93
    v_mfma_f32_16x16x32_bf16 v[56:59], v[152:155], a[136:139], v[56:59]
    v_cvt_pk_bf16_f32 v99, v94, v95
    ds_write_b64 v8, v[98:99] offset:20480
    v_mfma_f32_16x16x32_bf16 v[60:63], v[152:155], a[140:143], v[60:63]
    s_add_u32 s30, s30, 4096
    buffer_load_dwordx4 v[152:155], v4, s[8:11], s30 offen offset:0 sc1
    v_mul_f32 v92, v72, v72
    v_mul_f32 v93, v73, v73
    v_mfma_f32_16x16x32_bf16 v[48:51], v[156:159], a[144:147], v[48:51]
    v_mul_f32 v94, v74, v74
    v_mul_f32 v95, v75, v75
    v_mfma_f32_16x16x32_bf16 v[52:55], v[156:159], a[148:151], v[52:55]
    v_fma_f32 v92, v92, v86, v82
    v_fma_f32 v93, v93, v86, v82
    v_mfma_f32_16x16x32_bf16 v[56:59], v[156:159], a[152:155], v[56:59]
    v_fma_f32 v94, v94, v86, v82
    v_fma_f32 v95, v95, v86, v82
    v_mfma_f32_16x16x32_bf16 v[60:63], v[156:159], a[156:159], v[60:63]
    buffer_load_dwordx4 v[156:159], v4, s[8:11], s30 offen offset:1024 sc1
    v_mul_f32 v92, v92, v72
    v_mul_f32 v93, v93, v73
    s_waitcnt vmcnt(30)
    v_mfma_f32_16x16x32_bf16 v[48:51], v[160:163], a[160:163], v[48:51]
    v_mul_f32 v94, v94, v74
    v_mul_f32 v95, v95, v75
    v_mfma_f32_16x16x32_bf16 v[52:55], v[160:163], a[164:167], v[52:55]
    v_exp_f32 v92, v92
    v_exp_f32 v93, v93
    v_mfma_f32_16x16x32_bf16 v[56:59], v[160:163], a[168:171], v[56:59]
    v_exp_f32 v94, v94
    v_exp_f32 v95, v95
    v_mfma_f32_16x16x32_bf16 v[60:63], v[160:163], a[172:175], v[60:63]
    buffer_load_dwordx4 v[160:163], v4, s[8:11], s30 offen offset:2048 sc1
    v_fma_f32 v92, v92, v90, v90
    v_fma_f32 v93, v93, v90, v90
    v_mfma_f32_16x16x32_bf16 v[48:51], v[164:167], a[176:179], v[48:51]
    v_fma_f32 v94, v94, v90, v90
    v_fma_f32 v95, v95, v90, v90
    v_mfma_f32_16x16x32_bf16 v[52:55], v[164:167], a[180:183], v[52:55]
    v_rcp_f32 v92, v92
    v_rcp_f32 v93, v93
    v_mfma_f32_16x16x32_bf16 v[56:59], v[164:167], a[184:187], v[56:59]
    v_rcp_f32 v94, v94
    v_rcp_f32 v95, v95
    v_mfma_f32_16x16x32_bf16 v[60:63], v[164:167], a[188:191], v[60:63]
    buffer_load_dwordx4 v[164:167], v4, s[8:11], s30 offen offset:3072 sc1
    v_mul_f32 v92, v92, v72
    v_mul_f32 v93, v93, v73
    s_waitcnt vmcnt(30)
    v_mfma_f32_16x16x32_bf16 v[48:51], v[168:171], a[192:195], v[48:51]
    v_mul_f32 v94, v94, v74
    v_mul_f32 v95, v95, v75
    v_mfma_f32_16x16x32_bf16 v[52:55], v[168:171], a[196:199], v[52:55]
    v_cvt_pk_bf16_f32 v100, v92, v93
    v_cvt_pk_bf16_f32 v101, v94, v95
    v_mfma_f32_16x16x32_bf16 v[56:59], v[168:171], a[200:203], v[56:59]
    ds_write_b64 v9, v[100:101] offset:2048
    v_mul_f32 v92, v76, v76
    v_mfma_f32_16x16x32_bf16 v[60:63], v[168:171], a[204:207], v[60:63]
    s_add_u32 s30, s30, 4096
    buffer_load_dwordx4 v[168:171], v4, s[8:11], s30 offen offset:0 sc1
    v_mul_f32 v93, v77, v77
    v_mul_f32 v94, v78, v78
    v_mfma_f32_16x16x32_bf16 v[48:51], v[172:175], a[208:211], v[48:51]
    v_mul_f32 v95, v79, v79
    v_fma_f32 v92, v92, v87, v83
    v_mfma_f32_16x16x32_bf16 v[52:55], v[172:175], a[212:215], v[52:55]
    v_fma_f32 v93, v93, v87, v83
    v_fma_f32 v94, v94, v87, v83
    v_mfma_f32_16x16x32_bf16 v[56:59], v[172:175], a[216:219], v[56:59]
    v_fma_f32 v95, v95, v87, v83
    v_mul_f32 v92, v92, v76
    v_mfma_f32_16x16x32_bf16 v[60:63], v[172:175], a[220:223], v[60:63]
    buffer_load_dwordx4 v[172:175], v4, s[8:11], s30 offen offset:1024 sc1
    v_mul_f32 v93, v93, v77
    v_mul_f32 v94, v94, v78
    s_waitcnt vmcnt(30)
    v_mfma_f32_16x16x32_bf16 v[48:51], v[176:179], a[224:227], v[48:51]
    v_mul_f32 v95, v95, v79
    v_exp_f32 v92, v92
    v_mfma_f32_16x16x32_bf16 v[52:55], v[176:179], a[228:231], v[52:55]
    v_exp_f32 v93, v93
    v_exp_f32 v94, v94
    v_mfma_f32_16x16x32_bf16 v[56:59], v[176:179], a[232:235], v[56:59]
    v_exp_f32 v95, v95
    v_fma_f32 v92, v92, v91, v91
    v_mfma_f32_16x16x32_bf16 v[60:63], v[176:179], a[236:239], v[60:63]
    buffer_load_dwordx4 v[176:179], v4, s[8:11], s30 offen offset:2048 sc1
    v_fma_f32 v93, v93, v91, v91
    v_fma_f32 v94, v94, v91, v91
    v_mfma_f32_16x16x32_bf16 v[48:51], v[180:183], a[240:243], v[48:51]
    v_fma_f32 v95, v95, v91, v91
    v_rcp_f32 v92, v92
    v_mfma_f32_16x16x32_bf16 v[52:55], v[180:183], a[244:247], v[52:55]
    v_rcp_f32 v93, v93
    v_rcp_f32 v94, v94
    v_mfma_f32_16x16x32_bf16 v[56:59], v[180:183], a[248:251], v[56:59]
    v_rcp_f32 v95, v95
    v_mul_f32 v92, v92, v76
    v_mfma_f32_16x16x32_bf16 v[60:63], v[180:183], a[252:255], v[60:63]
    buffer_load_dwordx4 v[180:183], v4, s[8:11], s30 offen offset:3072 sc1
    v_mul_f32 v93, v93, v77
    v_mul_f32 v94, v94, v78
    s_waitcnt vmcnt(30)
    v_mfma_f32_16x16x32_bf16 v[48:51], v[184:187], v[16:19], v[48:51]
    v_mul_f32 v95, v95, v79
    v_cvt_pk_bf16_f32 v102, v92, v93
    v_mfma_f32_16x16x32_bf16 v[52:55], v[184:187], v[20:23], v[52:55]
    v_cvt_pk_bf16_f32 v103, v94, v95
    ds_write_b64 v9, v[102:103] offset:20480
    v_mfma_f32_16x16x32_bf16 v[56:59], v[184:187], v[24:27], v[56:59]
    v_mfma_f32_16x16x32_bf16 v[60:63], v[184:187], v[28:31], v[60:63]
    s_add_u32 s30, s30, 4096
    buffer_load_dwordx4 v[184:187], v4, s[8:11], s30 offen offset:0 sc1
    v_mfma_f32_16x16x32_bf16 v[64:67], v[188:191], v[32:35], v[48:51]
    v_mfma_f32_16x16x32_bf16 v[68:71], v[188:191], v[36:39], v[52:55]
    v_mfma_f32_16x16x32_bf16 v[72:75], v[188:191], v[40:43], v[56:59]
    v_mfma_f32_16x16x32_bf16 v[76:79], v[188:191], v[44:47], v[60:63]
    buffer_load_dwordx4 v[188:191], v4, s[8:11], s30 offen offset:1024 sc1
    s_waitcnt vmcnt(30)
    v_mfma_f32_16x16x32_bf16 v[48:51], v[192:195], a[0:3], 0
    v_mfma_f32_16x16x32_bf16 v[52:55], v[192:195], a[4:7], 0
    v_mfma_f32_16x16x32_bf16 v[56:59], v[192:195], a[8:11], 0
    v_mfma_f32_16x16x32_bf16 v[60:63], v[192:195], a[12:15], 0
    buffer_load_dwordx4 v[192:195], v4, s[8:11], s30 offen offset:2048 sc1
    v_mfma_f32_16x16x32_bf16 v[48:51], v[196:199], a[16:19], v[48:51]
    v_mul_f32 v92, v64, v64
    v_mul_f32 v93, v65, v65
    v_mfma_f32_16x16x32_bf16 v[52:55], v[196:199], a[20:23], v[52:55]
    v_mul_f32 v94, v66, v66
    v_mul_f32 v95, v67, v67
    v_mfma_f32_16x16x32_bf16 v[56:59], v[196:199], a[24:27], v[56:59]
    v_fma_f32 v92, v92, v84, v80
    v_fma_f32 v93, v93, v84, v80
    v_mfma_f32_16x16x32_bf16 v[60:63], v[196:199], a[28:31], v[60:63]
    buffer_load_dwordx4 v[196:199], v4, s[8:11], s30 offen offset:3072 sc1
    v_fma_f32 v94, v94, v84, v80
    v_fma_f32 v95, v95, v84, v80
    s_waitcnt vmcnt(30)
    v_mfma_f32_16x16x32_bf16 v[48:51], v[200:203], a[32:35], v[48:51]
    v_mul_f32 v92, v92, v64
    v_mul_f32 v93, v93, v65
    v_mfma_f32_16x16x32_bf16 v[52:55], v[200:203], a[36:39], v[52:55]
    v_mul_f32 v94, v94, v66
    v_mul_f32 v95, v95, v67
    v_mfma_f32_16x16x32_bf16 v[56:59], v[200:203], a[40:43], v[56:59]
    v_exp_f32 v92, v92
    v_exp_f32 v93, v93
    v_mfma_f32_16x16x32_bf16 v[60:63], v[200:203], a[44:47], v[60:63]
    s_add_u32 s30, s30, 4096
    buffer_load_dwordx4 v[200:203], v4, s[8:11], s30 offen offset:0 sc1
    v_exp_f32 v94, v94
    v_exp_f32 v95, v95
    v_mfma_f32_16x16x32_bf16 v[48:51], v[204:207], a[48:51], v[48:51]
    v_fma_f32 v92, v92, v88, v88
    v_fma_f32 v93, v93, v88, v88
    v_mfma_f32_16x16x32_bf16 v[52:55], v[204:207], a[52:55], v[52:55]
    v_fma_f32 v94, v94, v88, v88
    v_fma_f32 v95, v95, v88, v88
    v_mfma_f32_16x16x32_bf16 v[56:59], v[204:207], a[56:59], v[56:59]
    v_rcp_f32 v92, v92
    v_rcp_f32 v93, v93
    v_mfma_f32_16x16x32_bf16 v[60:63], v[204:207], a[60:63], v[60:63]
    buffer_load_dwordx4 v[204:207], v4, s[8:11], s30 offen offset:1024 sc1
    v_rcp_f32 v94, v94
    v_rcp_f32 v95, v95
    s_waitcnt vmcnt(30)
    v_mfma_f32_16x16x32_bf16 v[48:51], v[208:211], a[64:67], v[48:51]
    v_mul_f32 v92, v92, v64
    v_mul_f32 v93, v93, v65
    v_mfma_f32_16x16x32_bf16 v[52:55], v[208:211], a[68:71], v[52:55]
    v_mul_f32 v94, v94, v66
    v_mul_f32 v95, v95, v67
    v_mfma_f32_16x16x32_bf16 v[56:59], v[208:211], a[72:75], v[56:59]
    v_cvt_pk_bf16_f32 v96, v92, v93
    v_cvt_pk_bf16_f32 v97, v94, v95
    v_mfma_f32_16x16x32_bf16 v[60:63], v[208:211], a[76:79], v[60:63]
    buffer_load_dwordx4 v[208:211], v4, s[8:11], s30 offen offset:2048 sc1
    ds_write_b64 v8, v[96:97] offset:4096
    v_mul_f32 v92, v68, v68
    v_mfma_f32_16x16x32_bf16 v[48:51], v[212:215], a[80:83], v[48:51]
    v_mul_f32 v93, v69, v69
    v_mul_f32 v94, v70, v70
    v_mfma_f32_16x16x32_bf16 v[52:55], v[212:215], a[84:87], v[52:55]
    v_mul_f32 v95, v71, v71
    v_fma_f32 v92, v92, v85, v81
    v_mfma_f32_16x16x32_bf16 v[56:59], v[212:215], a[88:91], v[56:59]
    v_fma_f32 v93, v93, v85, v81
    v_fma_f32 v94, v94, v85, v81
    v_mfma_f32_16x16x32_bf16 v[60:63], v[212:215], a[92:95], v[60:63]
    buffer_load_dwordx4 v[212:215], v4, s[8:11], s30 offen offset:3072 sc1
    v_fma_f32 v95, v95, v85, v81
    v_mul_f32 v92, v92, v68
    s_waitcnt vmcnt(30)
    v_mfma_f32_16x16x32_bf16 v[48:51], v[216:219], a[96:99], v[48:51]
    v_mul_f32 v93, v93, v69
    v_mul_f32 v94, v94, v70
    v_mfma_f32_16x16x32_bf16 v[52:55], v[216:219], a[100:103], v[52:55]
    v_mul_f32 v95, v95, v71
    v_exp_f32 v92, v92
    v_mfma_f32_16x16x32_bf16 v[56:59], v[216:219], a[104:107], v[56:59]
    v_exp_f32 v93, v93
    v_exp_f32 v94, v94
    v_mfma_f32_16x16x32_bf16 v[60:63], v[216:219], a[108:111], v[60:63]
    s_add_u32 s30, s30, 4096
    buffer_load_dwordx4 v[216:219], v4, s[8:11], s30 offen offset:0 sc1
    v_exp_f32 v95, v95
    v_fma_f32 v92, v92, v89, v89
    v_mfma_f32_16x16x32_bf16 v[48:51], v[220:223], a[112:115], v[48:51]
    v_fma_f32 v93, v93, v89, v89
    v_fma_f32 v94, v94, v89, v89
    v_mfma_f32_16x16x32_bf16 v[52:55], v[220:223], a[116:119], v[52:55]
    v_fma_f32 v95, v95, v89, v89
    v_rcp_f32 v92, v92
    v_mfma_f32_16x16x32_bf16 v[56:59], v[220:223], a[120:123], v[56:59]
    v_rcp_f32 v93, v93
    v_rcp_f32 v94, v94
    v_mfma_f32_16x16x32_bf16 v[60:63], v[220:223], a[124:127], v[60:63]
    buffer_load_dwordx4 v[220:223], v4, s[8:11], s30 offen offset:1024 sc1
    v_rcp_f32 v95, v95
    v_mul_f32 v92, v92, v68
    s_waitcnt vmcnt(30)
    v_mfma_f32_16x16x32_bf16 v[48:51], v[224:227], a[128:131], v[48:51]
    v_mul_f32 v93, v93, v69
    v_mul_f32 v94, v94, v70
    v_mfma_f32_16x16x32_bf16 v[52:55], v[224:227], a[132:135], v[52:55]
    v_mul_f32 v95, v95, v71
    v_cvt_pk_bf16_f32 v98, v92, v93
    v_mfma_f32_16x16x32_bf16 v[56:59], v[224:227], a[136:139], v[56:59]
    v_cvt_pk_bf16_f32 v99, v94, v95
    ds_write_b64 v8, v[98:99] offset:22528
    v_mfma_f32_16x16x32_bf16 v[60:63], v[224:227], a[140:143], v[60:63]
    buffer_load_dwordx4 v[224:227], v4, s[8:11], s30 offen offset:2048 sc1
    v_mul_f32 v92, v72, v72
    v_mul_f32 v93, v73, v73
    v_mfma_f32_16x16x32_bf16 v[48:51], v[228:231], a[144:147], v[48:51]
    v_mul_f32 v94, v74, v74
    v_mul_f32 v95, v75, v75
    v_mfma_f32_16x16x32_bf16 v[52:55], v[228:231], a[148:151], v[52:55]
    v_fma_f32 v92, v92, v86, v82
    v_fma_f32 v93, v93, v86, v82
    v_mfma_f32_16x16x32_bf16 v[56:59], v[228:231], a[152:155], v[56:59]
    v_fma_f32 v94, v94, v86, v82
    v_fma_f32 v95, v95, v86, v82
    v_mfma_f32_16x16x32_bf16 v[60:63], v[228:231], a[156:159], v[60:63]
    buffer_load_dwordx4 v[228:231], v4, s[8:11], s30 offen offset:3072 sc1
    v_mul_f32 v92, v92, v72
    v_mul_f32 v93, v93, v73
    s_waitcnt vmcnt(30)
    v_mfma_f32_16x16x32_bf16 v[48:51], v[104:107], a[160:163], v[48:51]
    v_mul_f32 v94, v94, v74
    v_mul_f32 v95, v95, v75
    v_mfma_f32_16x16x32_bf16 v[52:55], v[104:107], a[164:167], v[52:55]
    v_exp_f32 v92, v92
    v_exp_f32 v93, v93
    v_mfma_f32_16x16x32_bf16 v[56:59], v[104:107], a[168:171], v[56:59]
    v_exp_f32 v94, v94
    v_exp_f32 v95, v95
    v_mfma_f32_16x16x32_bf16 v[60:63], v[104:107], a[172:175], v[60:63]
    s_add_u32 s30, s30, 4096
    buffer_load_dwordx4 v[104:107], v4, s[8:11], s30 offen offset:0 sc1
    v_fma_f32 v92, v92, v90, v90
    v_fma_f32 v93, v93, v90, v90
    v_mfma_f32_16x16x32_bf16 v[48:51], v[108:111], a[176:179], v[48:51]
    v_fma_f32 v94, v94, v90, v90
    v_fma_f32 v95, v95, v90, v90
    v_mfma_f32_16x16x32_bf16 v[52:55], v[108:111], a[180:183], v[52:55]
    v_rcp_f32 v92, v92
    v_rcp_f32 v93, v93
    v_mfma_f32_16x16x32_bf16 v[56:59], v[108:111], a[184:187], v[56:59]
    v_rcp_f32 v94, v94
    v_rcp_f32 v95, v95
    v_mfma_f32_16x16x32_bf16 v[60:63], v[108:111], a[188:191], v[60:63]
    buffer_load_dwordx4 v[108:111], v4, s[8:11], s30 offen offset:1024 sc1
    v_mul_f32 v92, v92, v72
    v_mul_f32 v93, v93, v73
    s_waitcnt vmcnt(30)
    v_mfma_f32_16x16x32_bf16 v[48:51], v[112:115], a[192:195], v[48:51]
    v_mul_f32 v94, v94, v74
    v_mul_f32 v95, v95, v75
    v_mfma_f32_16x16x32_bf16 v[52:55], v[112:115], a[196:199], v[52:55]
    v_cvt_pk_bf16_f32 v100, v92, v93
    v_cvt_pk_bf16_f32 v101, v94, v95
    v_mfma_f32_16x16x32_bf16 v[56:59], v[112:115], a[200:203], v[56:59]
    ds_write_b64 v9, v[100:101] offset:4096
    v_mul_f32 v92, v76, v76
    v_mfma_f32_16x16x32_bf16 v[60:63], v[112:115], a[204:207], v[60:63]
    buffer_load_dwordx4 v[112:115], v4, s[8:11], s30 offen offset:2048 sc1
    v_mul_f32 v93, v77, v77
    v_mul_f32 v94, v78, v78
    v_mfma_f32_16x16x32_bf16 v[48:51], v[116:119], a[208:211], v[48:51]
    v_mul_f32 v95, v79, v79
    v_fma_f32 v92, v92, v87, v83
    v_mfma_f32_16x16x32_bf16 v[52:55], v[116:119], a[212:215], v[52:55]
    v_fma_f32 v93, v93, v87, v83
    v_fma_f32 v94, v94, v87, v83
    v_mfma_f32_16x16x32_bf16 v[56:59], v[116:119], a[216:219], v[56:59]
    v_fma_f32 v95, v95, v87, v83
    v_mul_f32 v92, v92, v76
    v_mfma_f32_16x16x32_bf16 v[60:63], v[116:119], a[220:223], v[60:63]
    buffer_load_dwordx4 v[116:119], v4, s[8:11], s30 offen offset:3072 sc1
    v_mul_f32 v93, v93, v77
    v_mul_f32 v94, v94, v78
    s_waitcnt vmcnt(30)
    v_mfma_f32_16x16x32_bf16 v[48:51], v[120:123], a[224:227], v[48:51]
    v_mul_f32 v95, v95, v79
    v_exp_f32 v92, v92
    v_mfma_f32_16x16x32_bf16 v[52:55], v[120:123], a[228:231], v[52:55]
    v_exp_f32 v93, v93
    v_exp_f32 v94, v94
    v_mfma_f32_16x16x32_bf16 v[56:59], v[120:123], a[232:235], v[56:59]
    v_exp_f32 v95, v95
    v_fma_f32 v92, v92, v91, v91
    v_mfma_f32_16x16x32_bf16 v[60:63], v[120:123], a[236:239], v[60:63]
    s_add_u32 s30, s30, 4096
    buffer_load_dwordx4 v[120:123], v4, s[8:11], s30 offen offset:0 sc1
    v_fma_f32 v93, v93, v91, v91
    v_fma_f32 v94, v94, v91, v91
    v_mfma_f32_16x16x32_bf16 v[48:51], v[124:127], a[240:243], v[48:51]
    v_fma_f32 v95, v95, v91, v91
    v_rcp_f32 v92, v92
    v_mfma_f32_16x16x32_bf16 v[52:55], v[124:127], a[244:247], v[52:55]
    v_rcp_f32 v93, v93
    v_rcp_f32 v94, v94
    v_mfma_f32_16x16x32_bf16 v[56:59], v[124:127], a[248:251], v[56:59]
    v_rcp_f32 v95, v95
    v_mul_f32 v92, v92, v76
    v_mfma_f32_16x16x32_bf16 v[60:63], v[124:127], a[252:255], v[60:63]
    buffer_load_dwordx4 v[124:127], v4, s[8:11], s30 offen offset:1024 sc1
    v_mul_f32 v93, v93, v77
    v_mul_f32 v94, v94, v78
    s_waitcnt vmcnt(30)
    v_mfma_f32_16x16x32_bf16 v[48:51], v[128:131], v[16:19], v[48:51]
    v_mul_f32 v95, v95, v79
    v_cvt_pk_bf16_f32 v102, v92, v93
    v_mfma_f32_16x16x32_bf16 v[52:55], v[128:131], v[20:23], v[52:55]
    v_cvt_pk_bf16_f32 v103, v94, v95
    ds_write_b64 v9, v[102:103] offset:22528
    v_mfma_f32_16x16x32_bf16 v[56:59], v[128:131], v[24:27], v[56:59]
    v_mfma_f32_16x16x32_bf16 v[60:63], v[128:131], v[28:31], v[60:63]
    buffer_load_dwordx4 v[128:131], v4, s[8:11], s30 offen offset:2048 sc1
    v_mfma_f32_16x16x32_bf16 v[64:67], v[132:135], v[32:35], v[48:51]
    v_mfma_f32_16x16x32_bf16 v[68:71], v[132:135], v[36:39], v[52:55]
    v_mfma_f32_16x16x32_bf16 v[72:75], v[132:135], v[40:43], v[56:59]
    v_mfma_f32_16x16x32_bf16 v[76:79], v[132:135], v[44:47], v[60:63]
    buffer_load_dwordx4 v[132:135], v4, s[8:11], s30 offen offset:3072 sc1
    s_waitcnt vmcnt(30)
    v_mfma_f32_16x16x32_bf16 v[48:51], v[136:139], a[0:3], 0
    v_mfma_f32_16x16x32_bf16 v[52:55], v[136:139], a[4:7], 0
    v_mfma_f32_16x16x32_bf16 v[56:59], v[136:139], a[8:11], 0
    v_mfma_f32_16x16x32_bf16 v[60:63], v[136:139], a[12:15], 0
    s_add_u32 s30, s30, 4096
    buffer_load_dwordx4 v[136:139], v4, s[8:11], s30 offen offset:0 sc1
    v_mfma_f32_16x16x32_bf16 v[48:51], v[140:143], a[16:19], v[48:51]
    v_mul_f32 v92, v64, v64
    v_mul_f32 v93, v65, v65
    v_mfma_f32_16x16x32_bf16 v[52:55], v[140:143], a[20:23], v[52:55]
    v_mul_f32 v94, v66, v66
    v_mul_f32 v95, v67, v67
    v_mfma_f32_16x16x32_bf16 v[56:59], v[140:143], a[24:27], v[56:59]
    v_fma_f32 v92, v92, v84, v80
    v_fma_f32 v93, v93, v84, v80
    v_mfma_f32_16x16x32_bf16 v[60:63], v[140:143], a[28:31], v[60:63]
    buffer_load_dwordx4 v[140:143], v4, s[8:11], s30 offen offset:1024 sc1
    v_fma_f32 v94, v94, v84, v80
    v_fma_f32 v95, v95, v84, v80
    s_waitcnt vmcnt(30)
    v_mfma_f32_16x16x32_bf16 v[48:51], v[144:147], a[32:35], v[48:51]
    v_mul_f32 v92, v92, v64
    v_mul_f32 v93, v93, v65
    v_mfma_f32_16x16x32_bf16 v[52:55], v[144:147], a[36:39], v[52:55]
    v_mul_f32 v94, v94, v66
    v_mul_f32 v95, v95, v67
    v_mfma_f32_16x16x32_bf16 v[56:59], v[144:147], a[40:43], v[56:59]
    v_exp_f32 v92, v92
    v_exp_f32 v93, v93
    v_mfma_f32_16x16x32_bf16 v[60:63], v[144:147], a[44:47], v[60:63]
    buffer_load_dwordx4 v[144:147], v4, s[8:11], s30 offen offset:2048 sc1
    v_exp_f32 v94, v94
    v_exp_f32 v95, v95
    v_mfma_f32_16x16x32_bf16 v[48:51], v[148:151], a[48:51], v[48:51]
    v_fma_f32 v92, v92, v88, v88
    v_fma_f32 v93, v93, v88, v88
    v_mfma_f32_16x16x32_bf16 v[52:55], v[148:151], a[52:55], v[52:55]
    v_fma_f32 v94, v94, v88, v88
    v_fma_f32 v95, v95, v88, v88
    v_mfma_f32_16x16x32_bf16 v[56:59], v[148:151], a[56:59], v[56:59]
    v_rcp_f32 v92, v92
    v_rcp_f32 v93, v93
    v_mfma_f32_16x16x32_bf16 v[60:63], v[148:151], a[60:63], v[60:63]
    buffer_load_dwordx4 v[148:151], v4, s[8:11], s30 offen offset:3072 sc1
    v_rcp_f32 v94, v94
    v_rcp_f32 v95, v95
    s_waitcnt vmcnt(30)
    v_mfma_f32_16x16x32_bf16 v[48:51], v[152:155], a[64:67], v[48:51]
    v_mul_f32 v92, v92, v64
    v_mul_f32 v93, v93, v65
    v_mfma_f32_16x16x32_bf16 v[52:55], v[152:155], a[68:71], v[52:55]
    v_mul_f32 v94, v94, v66
    v_mul_f32 v95, v95, v67
    v_mfma_f32_16x16x32_bf16 v[56:59], v[152:155], a[72:75], v[56:59]
    v_cvt_pk_bf16_f32 v96, v92, v93
    v_cvt_pk_bf16_f32 v97, v94, v95
    v_mfma_f32_16x16x32_bf16 v[60:63], v[152:155], a[76:79], v[60:63]
    s_add_u32 s30, s30, 4096
    buffer_load_dwordx4 v[152:155], v4, s[8:11], s30 offen offset:0 sc1
    ds_write_b64 v8, v[96:97] offset:6144
    v_mul_f32 v92, v68, v68
    v_mfma_f32_16x16x32_bf16 v[48:51], v[156:159], a[80:83], v[48:51]
    v_mul_f32 v93, v69, v69
    v_mul_f32 v94, v70, v70
    v_mfma_f32_16x16x32_bf16 v[52:55], v[156:159], a[84:87], v[52:55]
    v_mul_f32 v95, v71, v71
    v_fma_f32 v92, v92, v85, v81
    v_mfma_f32_16x16x32_bf16 v[56:59], v[156:159], a[88:91], v[56:59]
    v_fma_f32 v93, v93, v85, v81
    v_fma_f32 v94, v94, v85, v81
    v_mfma_f32_16x16x32_bf16 v[60:63], v[156:159], a[92:95], v[60:63]
    buffer_load_dwordx4 v[156:159], v4, s[8:11], s30 offen offset:1024 sc1
    v_fma_f32 v95, v95, v85, v81
    v_mul_f32 v92, v92, v68
    s_waitcnt vmcnt(30)
    v_mfma_f32_16x16x32_bf16 v[48:51], v[160:163], a[96:99], v[48:51]
    v_mul_f32 v93, v93, v69
    v_mul_f32 v94, v94, v70
    v_mfma_f32_16x16x32_bf16 v[52:55], v[160:163], a[100:103], v[52:55]
    v_mul_f32 v95, v95, v71
    v_exp_f32 v92, v92
    v_mfma_f32_16x16x32_bf16 v[56:59], v[160:163], a[104:107], v[56:59]
    v_exp_f32 v93, v93
    v_exp_f32 v94, v94
    v_mfma_f32_16x16x32_bf16 v[60:63], v[160:163], a[108:111], v[60:63]
    buffer_load_dwordx4 v[160:163], v4, s[8:11], s30 offen offset:2048 sc1
    v_exp_f32 v95, v95
    v_fma_f32 v92, v92, v89, v89
    v_mfma_f32_16x16x32_bf16 v[48:51], v[164:167], a[112:115], v[48:51]
    v_fma_f32 v93, v93, v89, v89
    v_fma_f32 v94, v94, v89, v89
    v_mfma_f32_16x16x32_bf16 v[52:55], v[164:167], a[116:119], v[52:55]
    v_fma_f32 v95, v95, v89, v89
    v_rcp_f32 v92, v92
    v_mfma_f32_16x16x32_bf16 v[56:59], v[164:167], a[120:123], v[56:59]
    v_rcp_f32 v93, v93
    v_rcp_f32 v94, v94
    v_mfma_f32_16x16x32_bf16 v[60:63], v[164:167], a[124:127], v[60:63]
    buffer_load_dwordx4 v[164:167], v4, s[8:11], s30 offen offset:3072 sc1
    v_rcp_f32 v95, v95
    v_mul_f32 v92, v92, v68
    s_waitcnt vmcnt(30)
    v_mfma_f32_16x16x32_bf16 v[48:51], v[168:171], a[128:131], v[48:51]
    v_mul_f32 v93, v93, v69
    v_mul_f32 v94, v94, v70
    v_mfma_f32_16x16x32_bf16 v[52:55], v[168:171], a[132:135], v[52:55]
    v_mul_f32 v95, v95, v71
    v_cvt_pk_bf16_f32 v98, v92, v93
    v_mfma_f32_16x16x32_bf16 v[56:59], v[168:171], a[136:139], v[56:59]
    v_cvt_pk_bf16_f32 v99, v94, v95
    ds_write_b64 v8, v[98:99] offset:24576
    v_mfma_f32_16x16x32_bf16 v[60:63], v[168:171], a[140:143], v[60:63]
    s_add_u32 s30, s30, 4096
    buffer_load_dwordx4 v[168:171], v4, s[8:11], s30 offen offset:0 sc1
    v_mul_f32 v92, v72, v72
    v_mul_f32 v93, v73, v73
    v_mfma_f32_16x16x32_bf16 v[48:51], v[172:175], a[144:147], v[48:51]
    v_mul_f32 v94, v74, v74
    v_mul_f32 v95, v75, v75
    v_mfma_f32_16x16x32_bf16 v[52:55], v[172:175], a[148:151], v[52:55]
    v_fma_f32 v92, v92, v86, v82
    v_fma_f32 v93, v93, v86, v82
    v_mfma_f32_16x16x32_bf16 v[56:59], v[172:175], a[152:155], v[56:59]
    v_fma_f32 v94, v94, v86, v82
    v_fma_f32 v95, v95, v86, v82
    v_mfma_f32_16x16x32_bf16 v[60:63], v[172:175], a[156:159], v[60:63]
    buffer_load_dwordx4 v[172:175], v4, s[8:11], s30 offen offset:1024 sc1
    v_mul_f32 v92, v92, v72
    v_mul_f32 v93, v93, v73
    s_waitcnt vmcnt(30)
    v_mfma_f32_16x16x32_bf16 v[48:51], v[176:179], a[160:163], v[48:51]
    v_mul_f32 v94, v94, v74
    v_mul_f32 v95, v95, v75
    v_mfma_f32_16x16x32_bf16 v[52:55], v[176:179], a[164:167], v[52:55]
    v_exp_f32 v92, v92
    v_exp_f32 v93, v93
    v_mfma_f32_16x16x32_bf16 v[56:59], v[176:179], a[168:171], v[56:59]
    v_exp_f32 v94, v94
    v_exp_f32 v95, v95
    v_mfma_f32_16x16x32_bf16 v[60:63], v[176:179], a[172:175], v[60:63]
    buffer_load_dwordx4 v[176:179], v4, s[8:11], s30 offen offset:2048 sc1
    v_fma_f32 v92, v92, v90, v90
    v_fma_f32 v93, v93, v90, v90
    v_mfma_f32_16x16x32_bf16 v[48:51], v[180:183], a[176:179], v[48:51]
    v_fma_f32 v94, v94, v90, v90
    v_fma_f32 v95, v95, v90, v90
    v_mfma_f32_16x16x32_bf16 v[52:55], v[180:183], a[180:183], v[52:55]
    v_rcp_f32 v92, v92
    v_rcp_f32 v93, v93
    v_mfma_f32_16x16x32_bf16 v[56:59], v[180:183], a[184:187], v[56:59]
    v_rcp_f32 v94, v94
    v_rcp_f32 v95, v95
    v_mfma_f32_16x16x32_bf16 v[60:63], v[180:183], a[188:191], v[60:63]
    buffer_load_dwordx4 v[180:183], v4, s[8:11], s30 offen offset:3072 sc1
    v_mul_f32 v92, v92, v72
    v_mul_f32 v93, v93, v73
    s_waitcnt vmcnt(30)
    v_mfma_f32_16x16x32_bf16 v[48:51], v[184:187], a[192:195], v[48:51]
    v_mul_f32 v94, v94, v74
    v_mul_f32 v95, v95, v75
    v_mfma_f32_16x16x32_bf16 v[52:55], v[184:187], a[196:199], v[52:55]
    v_cvt_pk_bf16_f32 v100, v92, v93
    v_cvt_pk_bf16_f32 v101, v94, v95
    v_mfma_f32_16x16x32_bf16 v[56:59], v[184:187], a[200:203], v[56:59]
    ds_write_b64 v9, v[100:101] offset:6144
    v_mul_f32 v92, v76, v76
    v_mfma_f32_16x16x32_bf16 v[60:63], v[184:187], a[204:207], v[60:63]
    s_add_u32 s30, s30, 4096
    buffer_load_dwordx4 v[184:187], v4, s[8:11], s30 offen offset:0 sc1
    v_mul_f32 v93, v77, v77
    v_mul_f32 v94, v78, v78
    v_mfma_f32_16x16x32_bf16 v[48:51], v[188:191], a[208:211], v[48:51]
    v_mul_f32 v95, v79, v79
    v_fma_f32 v92, v92, v87, v83
    v_mfma_f32_16x16x32_bf16 v[52:55], v[188:191], a[212:215], v[52:55]
    v_fma_f32 v93, v93, v87, v83
    v_fma_f32 v94, v94, v87, v83
    v_mfma_f32_16x16x32_bf16 v[56:59], v[188:191], a[216:219], v[56:59]
    v_fma_f32 v95, v95, v87, v83
    v_mul_f32 v92, v92, v76
    v_mfma_f32_16x16x32_bf16 v[60:63], v[188:191], a[220:223], v[60:63]
    buffer_load_dwordx4 v[188:191], v4, s[8:11], s30 offen offset:1024 sc1
    v_mul_f32 v93, v93, v77
    v_mul_f32 v94, v94, v78
    s_waitcnt vmcnt(30)
    v_mfma_f32_16x16x32_bf16 v[48:51], v[192:195], a[224:227], v[48:51]
    v_mul_f32 v95, v95, v79
    v_exp_f32 v92, v92
    v_mfma_f32_16x16x32_bf16 v[52:55], v[192:195], a[228:231], v[52:55]
    v_exp_f32 v93, v93
    v_exp_f32 v94, v94
    v_mfma_f32_16x16x32_bf16 v[56:59], v[192:195], a[232:235], v[56:59]
    v_exp_f32 v95, v95
    v_fma_f32 v92, v92, v91, v91
    v_mfma_f32_16x16x32_bf16 v[60:63], v[192:195], a[236:239], v[60:63]
    buffer_load_dwordx4 v[192:195], v4, s[8:11], s30 offen offset:2048 sc1
    v_fma_f32 v93, v93, v91, v91
    v_fma_f32 v94, v94, v91, v91
    v_mfma_f32_16x16x32_bf16 v[48:51], v[196:199], a[240:243], v[48:51]
    v_fma_f32 v95, v95, v91, v91
    v_rcp_f32 v92, v92
    v_mfma_f32_16x16x32_bf16 v[52:55], v[196:199], a[244:247], v[52:55]
    v_rcp_f32 v93, v93
    v_rcp_f32 v94, v94
    v_mfma_f32_16x16x32_bf16 v[56:59], v[196:199], a[248:251], v[56:59]
    v_rcp_f32 v95, v95
    v_mul_f32 v92, v92, v76
    v_mfma_f32_16x16x32_bf16 v[60:63], v[196:199], a[252:255], v[60:63]
    buffer_load_dwordx4 v[196:199], v4, s[8:11], s30 offen offset:3072 sc1
    v_mul_f32 v93, v93, v77
    v_mul_f32 v94, v94, v78
    s_waitcnt vmcnt(30)
    v_mfma_f32_16x16x32_bf16 v[48:51], v[200:203], v[16:19], v[48:51]
    v_mul_f32 v95, v95, v79
    v_cvt_pk_bf16_f32 v102, v92, v93
    v_mfma_f32_16x16x32_bf16 v[52:55], v[200:203], v[20:23], v[52:55]
    v_cvt_pk_bf16_f32 v103, v94, v95
    ds_write_b64 v9, v[102:103] offset:24576
    v_mfma_f32_16x16x32_bf16 v[56:59], v[200:203], v[24:27], v[56:59]
    v_mfma_f32_16x16x32_bf16 v[60:63], v[200:203], v[28:31], v[60:63]
    s_add_u32 s30, s30, 4096
    buffer_load_dwordx4 v[200:203], v4, s[8:11], s30 offen offset:0 sc1
    v_mfma_f32_16x16x32_bf16 v[64:67], v[204:207], v[32:35], v[48:51]
    v_mfma_f32_16x16x32_bf16 v[68:71], v[204:207], v[36:39], v[52:55]
    v_mfma_f32_16x16x32_bf16 v[72:75], v[204:207], v[40:43], v[56:59]
    v_mfma_f32_16x16x32_bf16 v[76:79], v[204:207], v[44:47], v[60:63]
    buffer_load_dwordx4 v[204:207], v4, s[8:11], s30 offen offset:1024 sc1
    s_waitcnt vmcnt(30)
    v_mfma_f32_16x16x32_bf16 v[48:51], v[208:211], a[0:3], 0
    v_mfma_f32_16x16x32_bf16 v[52:55], v[208:211], a[4:7], 0
    v_mfma_f32_16x16x32_bf16 v[56:59], v[208:211], a[8:11], 0
    v_mfma_f32_16x16x32_bf16 v[60:63], v[208:211], a[12:15], 0
    buffer_load_dwordx4 v[208:211], v4, s[8:11], s30 offen offset:2048 sc1
    v_mfma_f32_16x16x32_bf16 v[48:51], v[212:215], a[16:19], v[48:51]
    v_mul_f32 v92, v64, v64
    v_mul_f32 v93, v65, v65
    v_mfma_f32_16x16x32_bf16 v[52:55], v[212:215], a[20:23], v[52:55]
    v_mul_f32 v94, v66, v66
    v_mul_f32 v95, v67, v67
    v_mfma_f32_16x16x32_bf16 v[56:59], v[212:215], a[24:27], v[56:59]
    v_fma_f32 v92, v92, v84, v80
    v_fma_f32 v93, v93, v84, v80
    v_mfma_f32_16x16x32_bf16 v[60:63], v[212:215], a[28:31], v[60:63]
    buffer_load_dwordx4 v[212:215], v4, s[8:11], s30 offen offset:3072 sc1
    v_fma_f32 v94, v94, v84, v80
    v_fma_f32 v95, v95, v84, v80
    s_waitcnt vmcnt(30)
    v_mfma_f32_16x16x32_bf16 v[48:51], v[216:219], a[32:35], v[48:51]
    v_mul_f32 v92, v92, v64
    v_mul_f32 v93, v93, v65
    v_mfma_f32_16x16x32_bf16 v[52:55], v[216:219], a[36:39], v[52:55]
    v_mul_f32 v94, v94, v66
    v_mul_f32 v95, v95, v67
    v_mfma_f32_16x16x32_bf16 v[56:59], v[216:219], a[40:43], v[56:59]
    v_exp_f32 v92, v92
    v_exp_f32 v93, v93
    v_mfma_f32_16x16x32_bf16 v[60:63], v[216:219], a[44:47], v[60:63]
    s_add_u32 s30, s30, 4096
    buffer_load_dwordx4 v[216:219], v4, s[8:11], s30 offen offset:0 sc1
    v_exp_f32 v94, v94
    v_exp_f32 v95, v95
    v_mfma_f32_16x16x32_bf16 v[48:51], v[220:223], a[48:51], v[48:51]
    v_fma_f32 v92, v92, v88, v88
    v_fma_f32 v93, v93, v88, v88
    v_mfma_f32_16x16x32_bf16 v[52:55], v[220:223], a[52:55], v[52:55]
    v_fma_f32 v94, v94, v88, v88
    v_fma_f32 v95, v95, v88, v88
    v_mfma_f32_16x16x32_bf16 v[56:59], v[220:223], a[56:59], v[56:59]
    v_rcp_f32 v92, v92
    v_rcp_f32 v93, v93
    v_mfma_f32_16x16x32_bf16 v[60:63], v[220:223], a[60:63], v[60:63]
    buffer_load_dwordx4 v[220:223], v4, s[8:11], s30 offen offset:1024 sc1
    v_rcp_f32 v94, v94
    v_rcp_f32 v95, v95
    s_waitcnt vmcnt(30)
    v_mfma_f32_16x16x32_bf16 v[48:51], v[224:227], a[64:67], v[48:51]
    v_mul_f32 v92, v92, v64
    v_mul_f32 v93, v93, v65
    v_mfma_f32_16x16x32_bf16 v[52:55], v[224:227], a[68:71], v[52:55]
    v_mul_f32 v94, v94, v66
    v_mul_f32 v95, v95, v67
    v_mfma_f32_16x16x32_bf16 v[56:59], v[224:227], a[72:75], v[56:59]
    v_cvt_pk_bf16_f32 v96, v92, v93
    v_cvt_pk_bf16_f32 v97, v94, v95
    v_mfma_f32_16x16x32_bf16 v[60:63], v[224:227], a[76:79], v[60:63]
    buffer_load_dwordx4 v[224:227], v4, s[8:11], s30 offen offset:2048 sc1
    ds_write_b64 v8, v[96:97] offset:8192
    v_mul_f32 v92, v68, v68
    v_mfma_f32_16x16x32_bf16 v[48:51], v[228:231], a[80:83], v[48:51]
    v_mul_f32 v93, v69, v69
    v_mul_f32 v94, v70, v70
    v_mfma_f32_16x16x32_bf16 v[52:55], v[228:231], a[84:87], v[52:55]
    v_mul_f32 v95, v71, v71
    v_fma_f32 v92, v92, v85, v81
    v_mfma_f32_16x16x32_bf16 v[56:59], v[228:231], a[88:91], v[56:59]
    v_fma_f32 v93, v93, v85, v81
    v_fma_f32 v94, v94, v85, v81
    v_mfma_f32_16x16x32_bf16 v[60:63], v[228:231], a[92:95], v[60:63]
    buffer_load_dwordx4 v[228:231], v4, s[8:11], s30 offen offset:3072 sc1
    v_fma_f32 v95, v95, v85, v81
    v_mul_f32 v92, v92, v68
    s_waitcnt vmcnt(30)
    v_mfma_f32_16x16x32_bf16 v[48:51], v[104:107], a[96:99], v[48:51]
    v_mul_f32 v93, v93, v69
    v_mul_f32 v94, v94, v70
    v_mfma_f32_16x16x32_bf16 v[52:55], v[104:107], a[100:103], v[52:55]
    v_mul_f32 v95, v95, v71
    v_exp_f32 v92, v92
    v_mfma_f32_16x16x32_bf16 v[56:59], v[104:107], a[104:107], v[56:59]
    v_exp_f32 v93, v93
    v_exp_f32 v94, v94
    v_mfma_f32_16x16x32_bf16 v[60:63], v[104:107], a[108:111], v[60:63]
    s_add_u32 s30, s30, 4096
    buffer_load_dwordx4 v[104:107], v4, s[8:11], s30 offen offset:0 sc1
    v_exp_f32 v95, v95
    v_fma_f32 v92, v92, v89, v89
    v_mfma_f32_16x16x32_bf16 v[48:51], v[108:111], a[112:115], v[48:51]
    v_fma_f32 v93, v93, v89, v89
    v_fma_f32 v94, v94, v89, v89
    v_mfma_f32_16x16x32_bf16 v[52:55], v[108:111], a[116:119], v[52:55]
    v_fma_f32 v95, v95, v89, v89
    v_rcp_f32 v92, v92
    v_mfma_f32_16x16x32_bf16 v[56:59], v[108:111], a[120:123], v[56:59]
    v_rcp_f32 v93, v93
    v_rcp_f32 v94, v94
    v_mfma_f32_16x16x32_bf16 v[60:63], v[108:111], a[124:127], v[60:63]
    buffer_load_dwordx4 v[108:111], v4, s[8:11], s30 offen offset:1024 sc1
    v_rcp_f32 v95, v95
    v_mul_f32 v92, v92, v68
    s_waitcnt vmcnt(30)
    v_mfma_f32_16x16x32_bf16 v[48:51], v[112:115], a[128:131], v[48:51]
    v_mul_f32 v93, v93, v69
    v_mul_f32 v94, v94, v70
    v_mfma_f32_16x16x32_bf16 v[52:55], v[112:115], a[132:135], v[52:55]
    v_mul_f32 v95, v95, v71
    v_cvt_pk_bf16_f32 v98, v92, v93
    v_mfma_f32_16x16x32_bf16 v[56:59], v[112:115], a[136:139], v[56:59]
    v_cvt_pk_bf16_f32 v99, v94, v95
    ds_write_b64 v8, v[98:99] offset:26624
    v_mfma_f32_16x16x32_bf16 v[60:63], v[112:115], a[140:143], v[60:63]
    buffer_load_dwordx4 v[112:115], v4, s[8:11], s30 offen offset:2048 sc1
    v_mul_f32 v92, v72, v72
    v_mul_f32 v93, v73, v73
    v_mfma_f32_16x16x32_bf16 v[48:51], v[116:119], a[144:147], v[48:51]
    v_mul_f32 v94, v74, v74
    v_mul_f32 v95, v75, v75
    v_mfma_f32_16x16x32_bf16 v[52:55], v[116:119], a[148:151], v[52:55]
    v_fma_f32 v92, v92, v86, v82
    v_fma_f32 v93, v93, v86, v82
    v_mfma_f32_16x16x32_bf16 v[56:59], v[116:119], a[152:155], v[56:59]
    v_fma_f32 v94, v94, v86, v82
    v_fma_f32 v95, v95, v86, v82
    v_mfma_f32_16x16x32_bf16 v[60:63], v[116:119], a[156:159], v[60:63]
    buffer_load_dwordx4 v[116:119], v4, s[8:11], s30 offen offset:3072 sc1
    v_mul_f32 v92, v92, v72
    v_mul_f32 v93, v93, v73
    s_waitcnt vmcnt(30)
    v_mfma_f32_16x16x32_bf16 v[48:51], v[120:123], a[160:163], v[48:51]
    v_mul_f32 v94, v94, v74
    v_mul_f32 v95, v95, v75
    v_mfma_f32_16x16x32_bf16 v[52:55], v[120:123], a[164:167], v[52:55]
    v_exp_f32 v92, v92
    v_exp_f32 v93, v93
    v_mfma_f32_16x16x32_bf16 v[56:59], v[120:123], a[168:171], v[56:59]
    v_exp_f32 v94, v94
    v_exp_f32 v95, v95
    v_mfma_f32_16x16x32_bf16 v[60:63], v[120:123], a[172:175], v[60:63]
    s_add_u32 s30, s30, 4096
    buffer_load_dwordx4 v[120:123], v4, s[8:11], s30 offen offset:0 sc1
    v_fma_f32 v92, v92, v90, v90
    v_fma_f32 v93, v93, v90, v90
    v_mfma_f32_16x16x32_bf16 v[48:51], v[124:127], a[176:179], v[48:51]
    v_fma_f32 v94, v94, v90, v90
    v_fma_f32 v95, v95, v90, v90
    v_mfma_f32_16x16x32_bf16 v[52:55], v[124:127], a[180:183], v[52:55]
    v_rcp_f32 v92, v92
    v_rcp_f32 v93, v93
    v_mfma_f32_16x16x32_bf16 v[56:59], v[124:127], a[184:187], v[56:59]
    v_rcp_f32 v94, v94
    v_rcp_f32 v95, v95
    v_mfma_f32_16x16x32_bf16 v[60:63], v[124:127], a[188:191], v[60:63]
    buffer_load_dwordx4 v[124:127], v4, s[8:11], s30 offen offset:1024 sc1
    v_mul_f32 v92, v92, v72
    v_mul_f32 v93, v93, v73
    s_waitcnt vmcnt(30)
    v_mfma_f32_16x16x32_bf16 v[48:51], v[128:131], a[192:195], v[48:51]
    v_mul_f32 v94, v94, v74
    v_mul_f32 v95, v95, v75
    v_mfma_f32_16x16x32_bf16 v[52:55], v[128:131], a[196:199], v[52:55]
    v_cvt_pk_bf16_f32 v100, v92, v93
    v_cvt_pk_bf16_f32 v101, v94, v95
    v_mfma_f32_16x16x32_bf16 v[56:59], v[128:131], a[200:203], v[56:59]
    ds_write_b64 v9, v[100:101] offset:8192
    v_mul_f32 v92, v76, v76
    v_mfma_f32_16x16x32_bf16 v[60:63], v[128:131], a[204:207], v[60:63]
    buffer_load_dwordx4 v[128:131], v4, s[8:11], s30 offen offset:2048 sc1
    v_mul_f32 v93, v77, v77
    v_mul_f32 v94, v78, v78
    v_mfma_f32_16x16x32_bf16 v[48:51], v[132:135], a[208:211], v[48:51]
    v_mul_f32 v95, v79, v79
    v_fma_f32 v92, v92, v87, v83
    v_mfma_f32_16x16x32_bf16 v[52:55], v[132:135], a[212:215], v[52:55]
    v_fma_f32 v93, v93, v87, v83
    v_fma_f32 v94, v94, v87, v83
    v_mfma_f32_16x16x32_bf16 v[56:59], v[132:135], a[216:219], v[56:59]
    v_fma_f32 v95, v95, v87, v83
    v_mul_f32 v92, v92, v76
    v_mfma_f32_16x16x32_bf16 v[60:63], v[132:135], a[220:223], v[60:63]
    buffer_load_dwordx4 v[132:135], v4, s[8:11], s30 offen offset:3072 sc1
    v_mul_f32 v93, v93, v77
    v_mul_f32 v94, v94, v78
    s_waitcnt vmcnt(30)
    v_mfma_f32_16x16x32_bf16 v[48:51], v[136:139], a[224:227], v[48:51]
    v_mul_f32 v95, v95, v79
    v_exp_f32 v92, v92
    v_mfma_f32_16x16x32_bf16 v[52:55], v[136:139], a[228:231], v[52:55]
    v_exp_f32 v93, v93
    v_exp_f32 v94, v94
    v_mfma_f32_16x16x32_bf16 v[56:59], v[136:139], a[232:235], v[56:59]
    v_exp_f32 v95, v95
    v_fma_f32 v92, v92, v91, v91
    v_mfma_f32_16x16x32_bf16 v[60:63], v[136:139], a[236:239], v[60:63]
    s_add_u32 s30, s30, 4096
    buffer_load_dwordx4 v[136:139], v4, s[8:11], s30 offen offset:0 sc1
    v_fma_f32 v93, v93, v91, v91
    v_fma_f32 v94, v94, v91, v91
    v_mfma_f32_16x16x32_bf16 v[48:51], v[140:143], a[240:243], v[48:51]
    v_fma_f32 v95, v95, v91, v91
    v_rcp_f32 v92, v92
    v_mfma_f32_16x16x32_bf16 v[52:55], v[140:143], a[244:247], v[52:55]
    v_rcp_f32 v93, v93
    v_rcp_f32 v94, v94
    v_mfma_f32_16x16x32_bf16 v[56:59], v[140:143], a[248:251], v[56:59]
    v_rcp_f32 v95, v95
    v_mul_f32 v92, v92, v76
    v_mfma_f32_16x16x32_bf16 v[60:63], v[140:143], a[252:255], v[60:63]
    buffer_load_dwordx4 v[140:143], v4, s[8:11], s30 offen offset:1024 sc1
    v_mul_f32 v93, v93, v77
    v_mul_f32 v94, v94, v78
    s_waitcnt vmcnt(30)
    v_mfma_f32_16x16x32_bf16 v[48:51], v[144:147], v[16:19], v[48:51]
    v_mul_f32 v95, v95, v79
    v_cvt_pk_bf16_f32 v102, v92, v93
    v_mfma_f32_16x16x32_bf16 v[52:55], v[144:147], v[20:23], v[52:55]
    v_cvt_pk_bf16_f32 v103, v94, v95
    ds_write_b64 v9, v[102:103] offset:26624
    v_mfma_f32_16x16x32_bf16 v[56:59], v[144:147], v[24:27], v[56:59]
    v_mfma_f32_16x16x32_bf16 v[60:63], v[144:147], v[28:31], v[60:63]
    buffer_load_dwordx4 v[144:147], v4, s[8:11], s30 offen offset:2048 sc1
    v_mfma_f32_16x16x32_bf16 v[64:67], v[148:151], v[32:35], v[48:51]
    v_mfma_f32_16x16x32_bf16 v[68:71], v[148:151], v[36:39], v[52:55]
    v_mfma_f32_16x16x32_bf16 v[72:75], v[148:151], v[40:43], v[56:59]
    v_mfma_f32_16x16x32_bf16 v[76:79], v[148:151], v[44:47], v[60:63]
    buffer_load_dwordx4 v[148:151], v4, s[8:11], s30 offen offset:3072 sc1
    s_waitcnt vmcnt(30)
    v_mfma_f32_16x16x32_bf16 v[48:51], v[152:155], a[0:3], 0
    v_mfma_f32_16x16x32_bf16 v[52:55], v[152:155], a[4:7], 0
    v_mfma_f32_16x16x32_bf16 v[56:59], v[152:155], a[8:11], 0
    v_mfma_f32_16x16x32_bf16 v[60:63], v[152:155], a[12:15], 0
    s_add_u32 s30, s30, 4096
    buffer_load_dwordx4 v[152:155], v4, s[8:11], s30 offen offset:0 sc1
    v_mfma_f32_16x16x32_bf16 v[48:51], v[156:159], a[16:19], v[48:51]
    v_mul_f32 v92, v64, v64
    v_mul_f32 v93, v65, v65
    v_mfma_f32_16x16x32_bf16 v[52:55], v[156:159], a[20:23], v[52:55]
    v_mul_f32 v94, v66, v66
    v_mul_f32 v95, v67, v67
    v_mfma_f32_16x16x32_bf16 v[56:59], v[156:159], a[24:27], v[56:59]
    v_fma_f32 v92, v92, v84, v80
    v_fma_f32 v93, v93, v84, v80
    v_mfma_f32_16x16x32_bf16 v[60:63], v[156:159], a[28:31], v[60:63]
    buffer_load_dwordx4 v[156:159], v4, s[8:11], s30 offen offset:1024 sc1
    v_fma_f32 v94, v94, v84, v80
    v_fma_f32 v95, v95, v84, v80
    s_waitcnt vmcnt(30)
    v_mfma_f32_16x16x32_bf16 v[48:51], v[160:163], a[32:35], v[48:51]
    v_mul_f32 v92, v92, v64
    v_mul_f32 v93, v93, v65
    v_mfma_f32_16x16x32_bf16 v[52:55], v[160:163], a[36:39], v[52:55]
    v_mul_f32 v94, v94, v66
    v_mul_f32 v95, v95, v67
    v_mfma_f32_16x16x32_bf16 v[56:59], v[160:163], a[40:43], v[56:59]
    v_exp_f32 v92, v92
    v_exp_f32 v93, v93
    v_mfma_f32_16x16x32_bf16 v[60:63], v[160:163], a[44:47], v[60:63]
    buffer_load_dwordx4 v[160:163], v4, s[8:11], s30 offen offset:2048 sc1
    v_exp_f32 v94, v94
    v_exp_f32 v95, v95
    v_mfma_f32_16x16x32_bf16 v[48:51], v[164:167], a[48:51], v[48:51]
    v_fma_f32 v92, v92, v88, v88
    v_fma_f32 v93, v93, v88, v88
    v_mfma_f32_16x16x32_bf16 v[52:55], v[164:167], a[52:55], v[52:55]
    v_fma_f32 v94, v94, v88, v88
    v_fma_f32 v95, v95, v88, v88
    v_mfma_f32_16x16x32_bf16 v[56:59], v[164:167], a[56:59], v[56:59]
    v_rcp_f32 v92, v92
    v_rcp_f32 v93, v93
    v_mfma_f32_16x16x32_bf16 v[60:63], v[164:167], a[60:63], v[60:63]
    buffer_load_dwordx4 v[164:167], v4, s[8:11], s30 offen offset:3072 sc1
    v_rcp_f32 v94, v94
    v_rcp_f32 v95, v95
    s_waitcnt vmcnt(30)
    v_mfma_f32_16x16x32_bf16 v[48:51], v[168:171], a[64:67], v[48:51]
    v_mul_f32 v92, v92, v64
    v_mul_f32 v93, v93, v65
    v_mfma_f32_16x16x32_bf16 v[52:55], v[168:171], a[68:71], v[52:55]
    v_mul_f32 v94, v94, v66
    v_mul_f32 v95, v95, v67
    v_mfma_f32_16x16x32_bf16 v[56:59], v[168:171], a[72:75], v[56:59]
    v_cvt_pk_bf16_f32 v96, v92, v93
    v_cvt_pk_bf16_f32 v97, v94, v95
    v_mfma_f32_16x16x32_bf16 v[60:63], v[168:171], a[76:79], v[60:63]
    s_add_u32 s30, s30, 4096
    buffer_load_dwordx4 v[168:171], v4, s[8:11], s30 offen offset:0 sc1
    ds_write_b64 v8, v[96:97] offset:10240
    v_mul_f32 v92, v68, v68
    v_mfma_f32_16x16x32_bf16 v[48:51], v[172:175], a[80:83], v[48:51]
    v_mul_f32 v93, v69, v69
    v_mul_f32 v94, v70, v70
    v_mfma_f32_16x16x32_bf16 v[52:55], v[172:175], a[84:87], v[52:55]
    v_mul_f32 v95, v71, v71
    v_fma_f32 v92, v92, v85, v81
    v_mfma_f32_16x16x32_bf16 v[56:59], v[172:175], a[88:91], v[56:59]
    v_fma_f32 v93, v93, v85, v81
    v_fma_f32 v94, v94, v85, v81
    v_mfma_f32_16x16x32_bf16 v[60:63], v[172:175], a[92:95], v[60:63]
    buffer_load_dwordx4 v[172:175], v4, s[8:11], s30 offen offset:1024 sc1
    v_fma_f32 v95, v95, v85, v81
    v_mul_f32 v92, v92, v68
    s_waitcnt vmcnt(30)
    v_mfma_f32_16x16x32_bf16 v[48:51], v[176:179], a[96:99], v[48:51]
    v_mul_f32 v93, v93, v69
    v_mul_f32 v94, v94, v70
    v_mfma_f32_16x16x32_bf16 v[52:55], v[176:179], a[100:103], v[52:55]
    v_mul_f32 v95, v95, v71
    v_exp_f32 v92, v92
    v_mfma_f32_16x16x32_bf16 v[56:59], v[176:179], a[104:107], v[56:59]
    v_exp_f32 v93, v93
    v_exp_f32 v94, v94
    v_mfma_f32_16x16x32_bf16 v[60:63], v[176:179], a[108:111], v[60:63]
    buffer_load_dwordx4 v[176:179], v4, s[8:11], s30 offen offset:2048 sc1
    v_exp_f32 v95, v95
    v_fma_f32 v92, v92, v89, v89
    v_mfma_f32_16x16x32_bf16 v[48:51], v[180:183], a[112:115], v[48:51]
    v_fma_f32 v93, v93, v89, v89
    v_fma_f32 v94, v94, v89, v89
    v_mfma_f32_16x16x32_bf16 v[52:55], v[180:183], a[116:119], v[52:55]
    v_fma_f32 v95, v95, v89, v89
    v_rcp_f32 v92, v92
    v_mfma_f32_16x16x32_bf16 v[56:59], v[180:183], a[120:123], v[56:59]
    v_rcp_f32 v93, v93
    v_rcp_f32 v94, v94
    v_mfma_f32_16x16x32_bf16 v[60:63], v[180:183], a[124:127], v[60:63]
    buffer_load_dwordx4 v[180:183], v4, s[8:11], s30 offen offset:3072 sc1
    v_rcp_f32 v95, v95
    v_mul_f32 v92, v92, v68
    s_waitcnt vmcnt(30)
    v_mfma_f32_16x16x32_bf16 v[48:51], v[184:187], a[128:131], v[48:51]
    v_mul_f32 v93, v93, v69
    v_mul_f32 v94, v94, v70
    v_mfma_f32_16x16x32_bf16 v[52:55], v[184:187], a[132:135], v[52:55]
    v_mul_f32 v95, v95, v71
    v_cvt_pk_bf16_f32 v98, v92, v93
    v_mfma_f32_16x16x32_bf16 v[56:59], v[184:187], a[136:139], v[56:59]
    v_cvt_pk_bf16_f32 v99, v94, v95
    ds_write_b64 v8, v[98:99] offset:28672
    v_mfma_f32_16x16x32_bf16 v[60:63], v[184:187], a[140:143], v[60:63]
    s_add_u32 s30, s30, 4096
    buffer_load_dwordx4 v[184:187], v4, s[8:11], s30 offen offset:0 sc1
    v_mul_f32 v92, v72, v72
    v_mul_f32 v93, v73, v73
    v_mfma_f32_16x16x32_bf16 v[48:51], v[188:191], a[144:147], v[48:51]
    v_mul_f32 v94, v74, v74
    v_mul_f32 v95, v75, v75
    v_mfma_f32_16x16x32_bf16 v[52:55], v[188:191], a[148:151], v[52:55]
    v_fma_f32 v92, v92, v86, v82
    v_fma_f32 v93, v93, v86, v82
    v_mfma_f32_16x16x32_bf16 v[56:59], v[188:191], a[152:155], v[56:59]
    v_fma_f32 v94, v94, v86, v82
    v_fma_f32 v95, v95, v86, v82
    v_mfma_f32_16x16x32_bf16 v[60:63], v[188:191], a[156:159], v[60:63]
    buffer_load_dwordx4 v[188:191], v4, s[8:11], s30 offen offset:1024 sc1
    v_mul_f32 v92, v92, v72
    v_mul_f32 v93, v93, v73
    s_waitcnt vmcnt(30)
    v_mfma_f32_16x16x32_bf16 v[48:51], v[192:195], a[160:163], v[48:51]
    v_mul_f32 v94, v94, v74
    v_mul_f32 v95, v95, v75
    v_mfma_f32_16x16x32_bf16 v[52:55], v[192:195], a[164:167], v[52:55]
    v_exp_f32 v92, v92
    v_exp_f32 v93, v93
    v_mfma_f32_16x16x32_bf16 v[56:59], v[192:195], a[168:171], v[56:59]
    v_exp_f32 v94, v94
    v_exp_f32 v95, v95
    v_mfma_f32_16x16x32_bf16 v[60:63], v[192:195], a[172:175], v[60:63]
    buffer_load_dwordx4 v[192:195], v4, s[8:11], s30 offen offset:2048 sc1
    v_fma_f32 v92, v92, v90, v90
    v_fma_f32 v93, v93, v90, v90
    v_mfma_f32_16x16x32_bf16 v[48:51], v[196:199], a[176:179], v[48:51]
    v_fma_f32 v94, v94, v90, v90
    v_fma_f32 v95, v95, v90, v90
    v_mfma_f32_16x16x32_bf16 v[52:55], v[196:199], a[180:183], v[52:55]
    v_rcp_f32 v92, v92
    v_rcp_f32 v93, v93
    v_mfma_f32_16x16x32_bf16 v[56:59], v[196:199], a[184:187], v[56:59]
    v_rcp_f32 v94, v94
    v_rcp_f32 v95, v95
    v_mfma_f32_16x16x32_bf16 v[60:63], v[196:199], a[188:191], v[60:63]
    buffer_load_dwordx4 v[196:199], v4, s[8:11], s30 offen offset:3072 sc1
    v_mul_f32 v92, v92, v72
    v_mul_f32 v93, v93, v73
    s_waitcnt vmcnt(30)
    v_mfma_f32_16x16x32_bf16 v[48:51], v[200:203], a[192:195], v[48:51]
    v_mul_f32 v94, v94, v74
    v_mul_f32 v95, v95, v75
    v_mfma_f32_16x16x32_bf16 v[52:55], v[200:203], a[196:199], v[52:55]
    v_cvt_pk_bf16_f32 v100, v92, v93
    v_cvt_pk_bf16_f32 v101, v94, v95
    v_mfma_f32_16x16x32_bf16 v[56:59], v[200:203], a[200:203], v[56:59]
    ds_write_b64 v9, v[100:101] offset:10240
    v_mul_f32 v92, v76, v76
    v_mfma_f32_16x16x32_bf16 v[60:63], v[200:203], a[204:207], v[60:63]
    s_add_u32 s30, s30, 4096
    buffer_load_dwordx4 v[200:203], v4, s[8:11], s30 offen offset:0 sc1
    v_mul_f32 v93, v77, v77
    v_mul_f32 v94, v78, v78
    v_mfma_f32_16x16x32_bf16 v[48:51], v[204:207], a[208:211], v[48:51]
    v_mul_f32 v95, v79, v79
    v_fma_f32 v92, v92, v87, v83
    v_mfma_f32_16x16x32_bf16 v[52:55], v[204:207], a[212:215], v[52:55]
    v_fma_f32 v93, v93, v87, v83
    v_fma_f32 v94, v94, v87, v83
    v_mfma_f32_16x16x32_bf16 v[56:59], v[204:207], a[216:219], v[56:59]
    v_fma_f32 v95, v95, v87, v83
    v_mul_f32 v92, v92, v76
    v_mfma_f32_16x16x32_bf16 v[60:63], v[204:207], a[220:223], v[60:63]
    buffer_load_dwordx4 v[204:207], v4, s[8:11], s30 offen offset:1024 sc1
    v_mul_f32 v93, v93, v77
    v_mul_f32 v94, v94, v78
    s_waitcnt vmcnt(30)
    v_mfma_f32_16x16x32_bf16 v[48:51], v[208:211], a[224:227], v[48:51]
    v_mul_f32 v95, v95, v79
    v_exp_f32 v92, v92
    v_mfma_f32_16x16x32_bf16 v[52:55], v[208:211], a[228:231], v[52:55]
    v_exp_f32 v93, v93
    v_exp_f32 v94, v94
    v_mfma_f32_16x16x32_bf16 v[56:59], v[208:211], a[232:235], v[56:59]
    v_exp_f32 v95, v95
    v_fma_f32 v92, v92, v91, v91
    v_mfma_f32_16x16x32_bf16 v[60:63], v[208:211], a[236:239], v[60:63]
    buffer_load_dwordx4 v[208:211], v4, s[8:11], s30 offen offset:2048 sc1
    v_fma_f32 v93, v93, v91, v91
    v_fma_f32 v94, v94, v91, v91
    v_mfma_f32_16x16x32_bf16 v[48:51], v[212:215], a[240:243], v[48:51]
    v_fma_f32 v95, v95, v91, v91
    v_rcp_f32 v92, v92
    v_mfma_f32_16x16x32_bf16 v[52:55], v[212:215], a[244:247], v[52:55]
    v_rcp_f32 v93, v93
    v_rcp_f32 v94, v94
    v_mfma_f32_16x16x32_bf16 v[56:59], v[212:215], a[248:251], v[56:59]
    v_rcp_f32 v95, v95
    v_mul_f32 v92, v92, v76
    v_mfma_f32_16x16x32_bf16 v[60:63], v[212:215], a[252:255], v[60:63]
    buffer_load_dwordx4 v[212:215], v4, s[8:11], s30 offen offset:3072 sc1
    v_mul_f32 v93, v93, v77
    v_mul_f32 v94, v94, v78
    s_waitcnt vmcnt(30)
    v_mfma_f32_16x16x32_bf16 v[48:51], v[216:219], v[16:19], v[48:51]
    v_mul_f32 v95, v95, v79
    v_cvt_pk_bf16_f32 v102, v92, v93
    v_mfma_f32_16x16x32_bf16 v[52:55], v[216:219], v[20:23], v[52:55]
    v_cvt_pk_bf16_f32 v103, v94, v95
    ds_write_b64 v9, v[102:103] offset:28672
    v_mfma_f32_16x16x32_bf16 v[56:59], v[216:219], v[24:27], v[56:59]
    v_mfma_f32_16x16x32_bf16 v[60:63], v[216:219], v[28:31], v[60:63]
    s_add_u32 s30, s30, 4096
    buffer_load_dwordx4 v[216:219], v4, s[8:11], s30 offen offset:0 sc1
    v_mfma_f32_16x16x32_bf16 v[64:67], v[220:223], v[32:35], v[48:51]
    v_mfma_f32_16x16x32_bf16 v[68:71], v[220:223], v[36:39], v[52:55]
    v_mfma_f32_16x16x32_bf16 v[72:75], v[220:223], v[40:43], v[56:59]
    v_mfma_f32_16x16x32_bf16 v[76:79], v[220:223], v[44:47], v[60:63]
    buffer_load_dwordx4 v[220:223], v4, s[8:11], s30 offen offset:1024 sc1
    s_waitcnt vmcnt(30)
    v_mfma_f32_16x16x32_bf16 v[48:51], v[224:227], a[0:3], 0
    v_mfma_f32_16x16x32_bf16 v[52:55], v[224:227], a[4:7], 0
    v_mfma_f32_16x16x32_bf16 v[56:59], v[224:227], a[8:11], 0
    v_mfma_f32_16x16x32_bf16 v[60:63], v[224:227], a[12:15], 0
    buffer_load_dwordx4 v[224:227], v4, s[8:11], s30 offen offset:2048 sc1
    v_mfma_f32_16x16x32_bf16 v[48:51], v[228:231], a[16:19], v[48:51]
    v_mul_f32 v92, v64, v64
    v_mul_f32 v93, v65, v65
    v_mfma_f32_16x16x32_bf16 v[52:55], v[228:231], a[20:23], v[52:55]
    v_mul_f32 v94, v66, v66
    v_mul_f32 v95, v67, v67
    v_mfma_f32_16x16x32_bf16 v[56:59], v[228:231], a[24:27], v[56:59]
    v_fma_f32 v92, v92, v84, v80
    v_fma_f32 v93, v93, v84, v80
    v_mfma_f32_16x16x32_bf16 v[60:63], v[228:231], a[28:31], v[60:63]
    buffer_load_dwordx4 v[228:231], v4, s[8:11], s30 offen offset:3072 sc1
    v_fma_f32 v94, v94, v84, v80
    v_fma_f32 v95, v95, v84, v80
    s_waitcnt vmcnt(30)
    v_mfma_f32_16x16x32_bf16 v[48:51], v[104:107], a[32:35], v[48:51]
    v_mul_f32 v92, v92, v64
    v_mul_f32 v93, v93, v65
    v_mfma_f32_16x16x32_bf16 v[52:55], v[104:107], a[36:39], v[52:55]
    v_mul_f32 v94, v94, v66
    v_mul_f32 v95, v95, v67
    v_mfma_f32_16x16x32_bf16 v[56:59], v[104:107], a[40:43], v[56:59]
    v_exp_f32 v92, v92
    v_exp_f32 v93, v93
    v_mfma_f32_16x16x32_bf16 v[60:63], v[104:107], a[44:47], v[60:63]
    s_add_u32 s30, s30, 4096
    buffer_load_dwordx4 v[104:107], v4, s[8:11], s30 offen offset:0 sc1
    v_exp_f32 v94, v94
    v_exp_f32 v95, v95
    v_mfma_f32_16x16x32_bf16 v[48:51], v[108:111], a[48:51], v[48:51]
    v_fma_f32 v92, v92, v88, v88
    v_fma_f32 v93, v93, v88, v88
    v_mfma_f32_16x16x32_bf16 v[52:55], v[108:111], a[52:55], v[52:55]
    v_fma_f32 v94, v94, v88, v88
    v_fma_f32 v95, v95, v88, v88
    v_mfma_f32_16x16x32_bf16 v[56:59], v[108:111], a[56:59], v[56:59]
    v_rcp_f32 v92, v92
    v_rcp_f32 v93, v93
    v_mfma_f32_16x16x32_bf16 v[60:63], v[108:111], a[60:63], v[60:63]
    buffer_load_dwordx4 v[108:111], v4, s[8:11], s30 offen offset:1024 sc1
    v_rcp_f32 v94, v94
    v_rcp_f32 v95, v95
    s_waitcnt vmcnt(30)
    v_mfma_f32_16x16x32_bf16 v[48:51], v[112:115], a[64:67], v[48:51]
    v_mul_f32 v92, v92, v64
    v_mul_f32 v93, v93, v65
    v_mfma_f32_16x16x32_bf16 v[52:55], v[112:115], a[68:71], v[52:55]
    v_mul_f32 v94, v94, v66
    v_mul_f32 v95, v95, v67
    v_mfma_f32_16x16x32_bf16 v[56:59], v[112:115], a[72:75], v[56:59]
    v_cvt_pk_bf16_f32 v96, v92, v93
    v_cvt_pk_bf16_f32 v97, v94, v95
    v_mfma_f32_16x16x32_bf16 v[60:63], v[112:115], a[76:79], v[60:63]
    s_add_u32 s30, s31, 0
    buffer_load_dwordx4 v[112:115], v4, s[8:11], s30 offen offset:0 sc1
    ds_write_b64 v8, v[96:97] offset:12288
    v_mul_f32 v92, v68, v68
    v_mfma_f32_16x16x32_bf16 v[48:51], v[116:119], a[80:83], v[48:51]
    v_mul_f32 v93, v69, v69
    v_mul_f32 v94, v70, v70
    v_mfma_f32_16x16x32_bf16 v[52:55], v[116:119], a[84:87], v[52:55]
    v_mul_f32 v95, v71, v71
    v_fma_f32 v92, v92, v85, v81
    v_mfma_f32_16x16x32_bf16 v[56:59], v[116:119], a[88:91], v[56:59]
    v_fma_f32 v93, v93, v85, v81
    v_fma_f32 v94, v94, v85, v81
    v_mfma_f32_16x16x32_bf16 v[60:63], v[116:119], a[92:95], v[60:63]
    buffer_load_dwordx4 v[116:119], v4, s[8:11], s30 offen offset:1024 sc1
    v_fma_f32 v95, v95, v85, v81
    v_mul_f32 v92, v92, v68
    s_waitcnt vmcnt(30)
    v_mfma_f32_16x16x32_bf16 v[48:51], v[120:123], a[96:99], v[48:51]
    v_mul_f32 v93, v93, v69
    v_mul_f32 v94, v94, v70
    v_mfma_f32_16x16x32_bf16 v[52:55], v[120:123], a[100:103], v[52:55]
    v_mul_f32 v95, v95, v71
    v_exp_f32 v92, v92
    v_mfma_f32_16x16x32_bf16 v[56:59], v[120:123], a[104:107], v[56:59]
    v_exp_f32 v93, v93
    v_exp_f32 v94, v94
    v_mfma_f32_16x16x32_bf16 v[60:63], v[120:123], a[108:111], v[60:63]
    buffer_load_dwordx4 v[120:123], v4, s[8:11], s30 offen offset:2048 sc1
    v_exp_f32 v95, v95
    v_fma_f32 v92, v92, v89, v89
    v_mfma_f32_16x16x32_bf16 v[48:51], v[124:127], a[112:115], v[48:51]
    v_fma_f32 v93, v93, v89, v89
    v_fma_f32 v94, v94, v89, v89
    v_mfma_f32_16x16x32_bf16 v[52:55], v[124:127], a[116:119], v[52:55]
    v_fma_f32 v95, v95, v89, v89
    v_rcp_f32 v92, v92
    v_mfma_f32_16x16x32_bf16 v[56:59], v[124:127], a[120:123], v[56:59]
    v_rcp_f32 v93, v93
    v_rcp_f32 v94, v94
    v_mfma_f32_16x16x32_bf16 v[60:63], v[124:127], a[124:127], v[60:63]
    buffer_load_dwordx4 v[124:127], v4, s[8:11], s30 offen offset:3072 sc1
    v_rcp_f32 v95, v95
    v_mul_f32 v92, v92, v68
    s_waitcnt vmcnt(30)
    v_mfma_f32_16x16x32_bf16 v[48:51], v[128:131], a[128:131], v[48:51]
    v_mul_f32 v93, v93, v69
    v_mul_f32 v94, v94, v70
    v_mfma_f32_16x16x32_bf16 v[52:55], v[128:131], a[132:135], v[52:55]
    v_mul_f32 v95, v95, v71
    v_cvt_pk_bf16_f32 v98, v92, v93
    v_mfma_f32_16x16x32_bf16 v[56:59], v[128:131], a[136:139], v[56:59]
    v_cvt_pk_bf16_f32 v99, v94, v95
    ds_write_b64 v8, v[98:99] offset:30720
    v_mfma_f32_16x16x32_bf16 v[60:63], v[128:131], a[140:143], v[60:63]
    s_add_u32 s30, s31, 4096
    buffer_load_dwordx4 v[128:131], v4, s[8:11], s30 offen offset:0 sc1
    v_mul_f32 v92, v72, v72
    v_mul_f32 v93, v73, v73
    v_mfma_f32_16x16x32_bf16 v[48:51], v[132:135], a[144:147], v[48:51]
    v_mul_f32 v94, v74, v74
    v_mul_f32 v95, v75, v75
    v_mfma_f32_16x16x32_bf16 v[52:55], v[132:135], a[148:151], v[52:55]
    v_fma_f32 v92, v92, v86, v82
    v_fma_f32 v93, v93, v86, v82
    v_mfma_f32_16x16x32_bf16 v[56:59], v[132:135], a[152:155], v[56:59]
    v_fma_f32 v94, v94, v86, v82
    v_fma_f32 v95, v95, v86, v82
    v_mfma_f32_16x16x32_bf16 v[60:63], v[132:135], a[156:159], v[60:63]
    buffer_load_dwordx4 v[132:135], v4, s[8:11], s30 offen offset:1024 sc1
    v_mul_f32 v92, v92, v72
    v_mul_f32 v93, v93, v73
    s_waitcnt vmcnt(30)
    v_mfma_f32_16x16x32_bf16 v[48:51], v[136:139], a[160:163], v[48:51]
    v_mul_f32 v94, v94, v74
    v_mul_f32 v95, v95, v75
    v_mfma_f32_16x16x32_bf16 v[52:55], v[136:139], a[164:167], v[52:55]
    v_exp_f32 v92, v92
    v_exp_f32 v93, v93
    v_mfma_f32_16x16x32_bf16 v[56:59], v[136:139], a[168:171], v[56:59]
    v_exp_f32 v94, v94
    v_exp_f32 v95, v95
    v_mfma_f32_16x16x32_bf16 v[60:63], v[136:139], a[172:175], v[60:63]
    buffer_load_dwordx4 v[136:139], v4, s[8:11], s30 offen offset:2048 sc1
    v_fma_f32 v92, v92, v90, v90
    v_fma_f32 v93, v93, v90, v90
    v_mfma_f32_16x16x32_bf16 v[48:51], v[140:143], a[176:179], v[48:51]
    v_fma_f32 v94, v94, v90, v90
    v_fma_f32 v95, v95, v90, v90
    v_mfma_f32_16x16x32_bf16 v[52:55], v[140:143], a[180:183], v[52:55]
    v_rcp_f32 v92, v92
    v_rcp_f32 v93, v93
    v_mfma_f32_16x16x32_bf16 v[56:59], v[140:143], a[184:187], v[56:59]
    v_rcp_f32 v94, v94
    v_rcp_f32 v95, v95
    v_mfma_f32_16x16x32_bf16 v[60:63], v[140:143], a[188:191], v[60:63]
    buffer_load_dwordx4 v[140:143], v4, s[8:11], s30 offen offset:3072 sc1
    v_mul_f32 v92, v92, v72
    v_mul_f32 v93, v93, v73
    s_waitcnt vmcnt(30)
    v_mfma_f32_16x16x32_bf16 v[48:51], v[144:147], a[192:195], v[48:51]
    v_mul_f32 v94, v94, v74
    v_mul_f32 v95, v95, v75
    v_mfma_f32_16x16x32_bf16 v[52:55], v[144:147], a[196:199], v[52:55]
    v_cvt_pk_bf16_f32 v100, v92, v93
    v_cvt_pk_bf16_f32 v101, v94, v95
    v_mfma_f32_16x16x32_bf16 v[56:59], v[144:147], a[200:203], v[56:59]
    ds_write_b64 v9, v[100:101] offset:12288
    v_mul_f32 v92, v76, v76
    v_mfma_f32_16x16x32_bf16 v[60:63], v[144:147], a[204:207], v[60:63]
    s_add_u32 s30, s31, 8192
    buffer_load_dwordx4 v[144:147], v4, s[8:11], s30 offen offset:0 sc1
    v_mul_f32 v93, v77, v77
    v_mul_f32 v94, v78, v78
    v_mfma_f32_16x16x32_bf16 v[48:51], v[148:151], a[208:211], v[48:51]
    v_mul_f32 v95, v79, v79
    v_fma_f32 v92, v92, v87, v83
    v_mfma_f32_16x16x32_bf16 v[52:55], v[148:151], a[212:215], v[52:55]
    v_fma_f32 v93, v93, v87, v83
    v_fma_f32 v94, v94, v87, v83
    v_mfma_f32_16x16x32_bf16 v[56:59], v[148:151], a[216:219], v[56:59]
    v_fma_f32 v95, v95, v87, v83
    v_mul_f32 v92, v92, v76
    v_mfma_f32_16x16x32_bf16 v[60:63], v[148:151], a[220:223], v[60:63]
    buffer_load_dwordx4 v[148:151], v4, s[8:11], s30 offen offset:1024 sc1
    v_mul_f32 v93, v93, v77
    v_mul_f32 v94, v94, v78
    s_waitcnt vmcnt(30)
    v_mfma_f32_16x16x32_bf16 v[48:51], v[152:155], a[224:227], v[48:51]
    v_mul_f32 v95, v95, v79
    v_exp_f32 v92, v92
    v_mfma_f32_16x16x32_bf16 v[52:55], v[152:155], a[228:231], v[52:55]
    v_exp_f32 v93, v93
    v_exp_f32 v94, v94
    v_mfma_f32_16x16x32_bf16 v[56:59], v[152:155], a[232:235], v[56:59]
    v_exp_f32 v95, v95
    v_fma_f32 v92, v92, v91, v91
    v_mfma_f32_16x16x32_bf16 v[60:63], v[152:155], a[236:239], v[60:63]
    buffer_load_dwordx4 v[152:155], v4, s[8:11], s30 offen offset:2048 sc1
    v_fma_f32 v93, v93, v91, v91
    v_fma_f32 v94, v94, v91, v91
    v_mfma_f32_16x16x32_bf16 v[48:51], v[156:159], a[240:243], v[48:51]
    v_fma_f32 v95, v95, v91, v91
    v_rcp_f32 v92, v92
    v_mfma_f32_16x16x32_bf16 v[52:55], v[156:159], a[244:247], v[52:55]
    v_rcp_f32 v93, v93
    v_rcp_f32 v94, v94
    v_mfma_f32_16x16x32_bf16 v[56:59], v[156:159], a[248:251], v[56:59]
    v_rcp_f32 v95, v95
    v_mul_f32 v92, v92, v76
    v_mfma_f32_16x16x32_bf16 v[60:63], v[156:159], a[252:255], v[60:63]
    buffer_load_dwordx4 v[156:159], v4, s[8:11], s30 offen offset:3072 sc1
    v_mul_f32 v93, v93, v77
    v_mul_f32 v94, v94, v78
    s_waitcnt vmcnt(30)
    v_mfma_f32_16x16x32_bf16 v[48:51], v[160:163], v[16:19], v[48:51]
    v_mul_f32 v95, v95, v79
    v_cvt_pk_bf16_f32 v102, v92, v93
    v_mfma_f32_16x16x32_bf16 v[52:55], v[160:163], v[20:23], v[52:55]
    v_cvt_pk_bf16_f32 v103, v94, v95
    ds_write_b64 v9, v[102:103] offset:30720
    v_mfma_f32_16x16x32_bf16 v[56:59], v[160:163], v[24:27], v[56:59]
    v_mfma_f32_16x16x32_bf16 v[60:63], v[160:163], v[28:31], v[60:63]
    s_add_u32 s30, s31, 12288
    buffer_load_dwordx4 v[160:163], v4, s[8:11], s30 offen offset:0 sc1
    v_mfma_f32_16x16x32_bf16 v[64:67], v[164:167], v[32:35], v[48:51]
    v_mfma_f32_16x16x32_bf16 v[68:71], v[164:167], v[36:39], v[52:55]
    v_mfma_f32_16x16x32_bf16 v[72:75], v[164:167], v[40:43], v[56:59]
    v_mfma_f32_16x16x32_bf16 v[76:79], v[164:167], v[44:47], v[60:63]
    buffer_load_dwordx4 v[164:167], v4, s[8:11], s30 offen offset:1024 sc1
    s_waitcnt lgkmcnt(0)
    s_barrier
    s_waitcnt vmcnt(30)
    v_mfma_f32_16x16x32_bf16 v[48:51], v[168:171], a[0:3], 0
    v_mfma_f32_16x16x32_bf16 v[52:55], v[168:171], a[4:7], 0
    v_mfma_f32_16x16x32_bf16 v[56:59], v[168:171], a[8:11], 0
    v_mfma_f32_16x16x32_bf16 v[60:63], v[168:171], a[12:15], 0
    buffer_load_dwordx4 v[168:171], v4, s[8:11], s30 offen offset:2048 sc1
    ds_read_b128 a[0:3], v12 offset:0
    ds_read_b128 a[4:7], v12 offset:18432
    ds_read_b128 a[8:11], v13 offset:0
    ds_read_b128 a[12:15], v13 offset:18432
    v_mfma_f32_16x16x32_bf16 v[48:51], v[172:175], a[16:19], v[48:51]
    v_mul_f32 v92, v64, v64
    v_mul_f32 v93, v65, v65
    v_mfma_f32_16x16x32_bf16 v[52:55], v[172:175], a[20:23], v[52:55]
    v_mul_f32 v94, v66, v66
    v_mul_f32 v95, v67, v67
    v_mfma_f32_16x16x32_bf16 v[56:59], v[172:175], a[24:27], v[56:59]
    v_fma_f32 v92, v92, v84, v80
    v_fma_f32 v93, v93, v84, v80
    v_mfma_f32_16x16x32_bf16 v[60:63], v[172:175], a[28:31], v[60:63]
    buffer_load_dwordx4 v[172:175], v4, s[8:11], s30 offen offset:3072 sc1
    ds_read_b128 a[16:19], v12 offset:1024
    ds_read_b128 a[20:23], v12 offset:19456
    ds_read_b128 a[24:27], v13 offset:1024
    ds_read_b128 a[28:31], v13 offset:19456
    v_fma_f32 v94, v94, v84, v80
    v_fma_f32 v95, v95, v84, v80
    s_waitcnt vmcnt(30)
    v_mfma_f32_16x16x32_bf16 v[48:51], v[176:179], a[32:35], v[48:51]
    v_mul_f32 v92, v92, v64
    v_mul_f32 v93, v93, v65
    v_mfma_f32_16x16x32_bf16 v[52:55], v[176:179], a[36:39], v[52:55]
    v_mul_f32 v94, v94, v66
    v_mul_f32 v95, v95, v67
    v_mfma_f32_16x16x32_bf16 v[56:59], v[176:179], a[40:43], v[56:59]
    v_exp_f32 v92, v92
    v_exp_f32 v93, v93
    v_mfma_f32_16x16x32_bf16 v[60:63], v[176:179], a[44:47], v[60:63]
    s_add_u32 s30, s31, 16384
    buffer_load_dwordx4 v[176:179], v4, s[8:11], s30 offen offset:0 sc1
    ds_read_b128 a[32:35], v12 offset:2048
    ds_read_b128 a[36:39], v12 offset:20480
    ds_read_b128 a[40:43], v13 offset:2048
    ds_read_b128 a[44:47], v13 offset:20480
    v_exp_f32 v94, v94
    v_exp_f32 v95, v95
    v_mfma_f32_16x16x32_bf16 v[48:51], v[180:183], a[48:51], v[48:51]
    v_fma_f32 v92, v92, v88, v88
    v_fma_f32 v93, v93, v88, v88
    v_mfma_f32_16x16x32_bf16 v[52:55], v[180:183], a[52:55], v[52:55]
    v_fma_f32 v94, v94, v88, v88
    v_fma_f32 v95, v95, v88, v88
    v_mfma_f32_16x16x32_bf16 v[56:59], v[180:183], a[56:59], v[56:59]
    v_rcp_f32 v92, v92
    v_rcp_f32 v93, v93
    v_mfma_f32_16x16x32_bf16 v[60:63], v[180:183], a[60:63], v[60:63]
    buffer_load_dwordx4 v[180:183], v4, s[8:11], s30 offen offset:1024 sc1
    ds_read_b128 a[48:51], v12 offset:3072
    ds_read_b128 a[52:55], v12 offset:21504
    ds_read_b128 a[56:59], v13 offset:3072
    ds_read_b128 a[60:63], v13 offset:21504
    v_rcp_f32 v94, v94
    v_rcp_f32 v95, v95
    s_waitcnt vmcnt(30)
    v_mfma_f32_16x16x32_bf16 v[48:51], v[184:187], a[64:67], v[48:51]
    v_mul_f32 v92, v92, v64
    v_mul_f32 v93, v93, v65
    v_mfma_f32_16x16x32_bf16 v[52:55], v[184:187], a[68:71], v[52:55]
    v_mul_f32 v94, v94, v66
    v_mul_f32 v95, v95, v67
    v_mfma_f32_16x16x32_bf16 v[56:59], v[184:187], a[72:75], v[56:59]
    v_cvt_pk_bf16_f32 v96, v92, v93
    v_cvt_pk_bf16_f32 v97, v94, v95
    v_mfma_f32_16x16x32_bf16 v[60:63], v[184:187], a[76:79], v[60:63]
    s_add_u32 s30, s31, 55296
    buffer_load_dwordx4 v[184:187], v4, s[8:11], s30 offen offset:0 sc1
    ds_read_b128 a[64:67], v12 offset:4096
    ds_read_b128 a[68:71], v12 offset:22528
    ds_read_b128 a[72:75], v13 offset:4096
    ds_read_b128 a[76:79], v13 offset:22528
    ds_write_b64 v8, v[96:97] offset:14336
    v_mul_f32 v92, v68, v68
    v_mfma_f32_16x16x32_bf16 v[48:51], v[188:191], a[80:83], v[48:51]
    v_mul_f32 v93, v69, v69
    v_mul_f32 v94, v70, v70
    v_mfma_f32_16x16x32_bf16 v[52:55], v[188:191], a[84:87], v[52:55]
    v_mul_f32 v95, v71, v71
    v_fma_f32 v92, v92, v85, v81
    v_mfma_f32_16x16x32_bf16 v[56:59], v[188:191], a[88:91], v[56:59]
    v_fma_f32 v93, v93, v85, v81
    v_fma_f32 v94, v94, v85, v81
    v_mfma_f32_16x16x32_bf16 v[60:63], v[188:191], a[92:95], v[60:63]
    buffer_load_dwordx4 v[188:191], v4, s[8:11], s30 offen offset:1024 sc1
    ds_read_b128 a[80:83], v12 offset:5120
    ds_read_b128 a[84:87], v12 offset:23552
    ds_read_b128 a[88:91], v13 offset:5120
    ds_read_b128 a[92:95], v13 offset:23552
    v_fma_f32 v95, v95, v85, v81
    v_mul_f32 v92, v92, v68
    s_waitcnt vmcnt(30)
    v_mfma_f32_16x16x32_bf16 v[48:51], v[192:195], a[96:99], v[48:51]
    v_mul_f32 v93, v93, v69
    v_mul_f32 v94, v94, v70
    v_mfma_f32_16x16x32_bf16 v[52:55], v[192:195], a[100:103], v[52:55]
    v_mul_f32 v95, v95, v71
    v_exp_f32 v92, v92
    v_mfma_f32_16x16x32_bf16 v[56:59], v[192:195], a[104:107], v[56:59]
    v_exp_f32 v93, v93
    v_exp_f32 v94, v94
    v_mfma_f32_16x16x32_bf16 v[60:63], v[192:195], a[108:111], v[60:63]
    buffer_load_dwordx4 v[192:195], v4, s[8:11], s30 offen offset:2048 sc1
    ds_read_b128 a[96:99], v12 offset:6144
    ds_read_b128 a[100:103], v12 offset:24576
    ds_read_b128 a[104:107], v13 offset:6144
    ds_read_b128 a[108:111], v13 offset:24576
    v_exp_f32 v95, v95
    v_fma_f32 v92, v92, v89, v89
    v_mfma_f32_16x16x32_bf16 v[48:51], v[196:199], a[112:115], v[48:51]
    v_fma_f32 v93, v93, v89, v89
    v_fma_f32 v94, v94, v89, v89
    v_mfma_f32_16x16x32_bf16 v[52:55], v[196:199], a[116:119], v[52:55]
    v_fma_f32 v95, v95, v89, v89
    v_rcp_f32 v92, v92
    v_mfma_f32_16x16x32_bf16 v[56:59], v[196:199], a[120:123], v[56:59]
    v_rcp_f32 v93, v93
    v_rcp_f32 v94, v94
    v_mfma_f32_16x16x32_bf16 v[60:63], v[196:199], a[124:127], v[60:63]
    buffer_load_dwordx4 v[196:199], v4, s[8:11], s30 offen offset:3072 sc1
    ds_read_b128 a[112:115], v12 offset:7168
    ds_read_b128 a[116:119], v12 offset:25600
    ds_read_b128 a[120:123], v13 offset:7168
    ds_read_b128 a[124:127], v13 offset:25600
    v_rcp_f32 v95, v95
    v_mul_f32 v92, v92, v68
    s_waitcnt vmcnt(30)
    v_mfma_f32_16x16x32_bf16 v[48:51], v[200:203], a[128:131], v[48:51]
    v_mul_f32 v93, v93, v69
    v_mul_f32 v94, v94, v70
    v_mfma_f32_16x16x32_bf16 v[52:55], v[200:203], a[132:135], v[52:55]
    v_mul_f32 v95, v95, v71
    v_cvt_pk_bf16_f32 v98, v92, v93
    v_mfma_f32_16x16x32_bf16 v[56:59], v[200:203], a[136:139], v[56:59]
    v_cvt_pk_bf16_f32 v99, v94, v95
    ds_write_b64 v8, v[98:99] offset:32768
    v_mfma_f32_16x16x32_bf16 v[60:63], v[200:203], a[140:143], v[60:63]
    s_add_u32 s30, s31, 59392
    buffer_load_dwordx4 v[200:203], v4, s[8:11], s30 offen offset:0 sc1
    ds_read_b128 a[128:131], v12 offset:8192
    ds_read_b128 a[132:135], v12 offset:26624
    ds_read_b128 a[136:139], v13 offset:8192
    ds_read_b128 a[140:143], v13 offset:26624
    v_mul_f32 v92, v72, v72
    v_mul_f32 v93, v73, v73
    v_mfma_f32_16x16x32_bf16 v[48:51], v[204:207], a[144:147], v[48:51]
    v_mul_f32 v94, v74, v74
    v_mul_f32 v95, v75, v75
    v_mfma_f32_16x16x32_bf16 v[52:55], v[204:207], a[148:151], v[52:55]
    v_fma_f32 v92, v92, v86, v82
    v_fma_f32 v93, v93, v86, v82
    v_mfma_f32_16x16x32_bf16 v[56:59], v[204:207], a[152:155], v[56:59]
    v_fma_f32 v94, v94, v86, v82
    v_fma_f32 v95, v95, v86, v82
    v_mfma_f32_16x16x32_bf16 v[60:63], v[204:207], a[156:159], v[60:63]
    buffer_load_dwordx4 v[204:207], v4, s[8:11], s30 offen offset:1024 sc1
    ds_read_b128 a[144:147], v12 offset:9216
    ds_read_b128 a[148:151], v12 offset:27648
    ds_read_b128 a[152:155], v13 offset:9216
    ds_read_b128 a[156:159], v13 offset:27648
    v_mul_f32 v92, v92, v72
    v_mul_f32 v93, v93, v73
    s_waitcnt vmcnt(30)
    v_mfma_f32_16x16x32_bf16 v[48:51], v[208:211], a[160:163], v[48:51]
    v_mul_f32 v94, v94, v74
    v_mul_f32 v95, v95, v75
    v_mfma_f32_16x16x32_bf16 v[52:55], v[208:211], a[164:167], v[52:55]
    v_exp_f32 v92, v92
    v_exp_f32 v93, v93
    v_mfma_f32_16x16x32_bf16 v[56:59], v[208:211], a[168:171], v[56:59]
    v_exp_f32 v94, v94
    v_exp_f32 v95, v95
    v_mfma_f32_16x16x32_bf16 v[60:63], v[208:211], a[172:175], v[60:63]
    buffer_load_dwordx4 v[208:211], v4, s[8:11], s30 offen offset:2048 sc1
    ds_read_b128 a[160:163], v12 offset:10240
    ds_read_b128 a[164:167], v12 offset:28672
    ds_read_b128 a[168:171], v13 offset:10240
    ds_read_b128 a[172:175], v13 offset:28672
    v_fma_f32 v92, v92, v90, v90
    v_fma_f32 v93, v93, v90, v90
    v_mfma_f32_16x16x32_bf16 v[48:51], v[212:215], a[176:179], v[48:51]
    v_fma_f32 v94, v94, v90, v90
    v_fma_f32 v95, v95, v90, v90
    v_mfma_f32_16x16x32_bf16 v[52:55], v[212:215], a[180:183], v[52:55]
    v_rcp_f32 v92, v92
    v_rcp_f32 v93, v93
    v_mfma_f32_16x16x32_bf16 v[56:59], v[212:215], a[184:187], v[56:59]
    v_rcp_f32 v94, v94
    v_rcp_f32 v95, v95
    v_mfma_f32_16x16x32_bf16 v[60:63], v[212:215], a[188:191], v[60:63]
    buffer_load_dwordx4 v[212:215], v4, s[8:11], s30 offen offset:3072 sc1
    ds_read_b128 a[176:179], v12 offset:11264
    ds_read_b128 a[180:183], v12 offset:29696
    ds_read_b128 a[184:187], v13 offset:11264
    ds_read_b128 a[188:191], v13 offset:29696
    v_mul_f32 v92, v92, v72
    v_mul_f32 v93, v93, v73
    s_waitcnt vmcnt(30)
    v_mfma_f32_16x16x32_bf16 v[48:51], v[216:219], a[192:195], v[48:51]
    v_mul_f32 v94, v94, v74
    v_mul_f32 v95, v95, v75
    v_mfma_f32_16x16x32_bf16 v[52:55], v[216:219], a[196:199], v[52:55]
    v_cvt_pk_bf16_f32 v100, v92, v93
    v_cvt_pk_bf16_f32 v101, v94, v95
    v_mfma_f32_16x16x32_bf16 v[56:59], v[216:219], a[200:203], v[56:59]
    ds_write_b64 v9, v[100:101] offset:14336
    v_mul_f32 v92, v76, v76
    v_mfma_f32_16x16x32_bf16 v[60:63], v[216:219], a[204:207], v[60:63]
    s_add_u32 s30, s31, 63488
    buffer_load_dwordx4 v[216:219], v4, s[8:11], s30 offen offset:0 sc1
    ds_read_b128 a[192:195], v12 offset:12288
    ds_read_b128 a[196:199], v12 offset:30720
    ds_read_b128 a[200:203], v13 offset:12288
    ds_read_b128 a[204:207], v13 offset:30720
    v_mul_f32 v93, v77, v77
    v_mul_f32 v94, v78, v78
    v_mfma_f32_16x16x32_bf16 v[48:51], v[220:223], a[208:211], v[48:51]
    v_mul_f32 v95, v79, v79
    v_fma_f32 v92, v92, v87, v83
    v_mfma_f32_16x16x32_bf16 v[52:55], v[220:223], a[212:215], v[52:55]
    v_fma_f32 v93, v93, v87, v83
    v_fma_f32 v94, v94, v87, v83
    v_mfma_f32_16x16x32_bf16 v[56:59], v[220:223], a[216:219], v[56:59]
    v_fma_f32 v95, v95, v87, v83
    v_mul_f32 v92, v92, v76
    v_mfma_f32_16x16x32_bf16 v[60:63], v[220:223], a[220:223], v[60:63]
    buffer_load_dwordx4 v[220:223], v4, s[8:11], s30 offen offset:1024 sc1
    ds_read_b128 a[208:211], v12 offset:13312
    ds_read_b128 a[212:215], v12 offset:31744
    ds_read_b128 a[216:219], v13 offset:13312
    ds_read_b128 a[220:223], v13 offset:31744
    v_mul_f32 v93, v93, v77
    v_mul_f32 v94, v94, v78
    s_waitcnt vmcnt(30)
    v_mfma_f32_16x16x32_bf16 v[48:51], v[224:227], a[224:227], v[48:51]
    v_mul_f32 v95, v95, v79
    v_exp_f32 v92, v92
    v_mfma_f32_16x16x32_bf16 v[52:55], v[224:227], a[228:231], v[52:55]
    v_exp_f32 v93, v93
    v_exp_f32 v94, v94
    v_mfma_f32_16x16x32_bf16 v[56:59], v[224:227], a[232:235], v[56:59]
    v_exp_f32 v95, v95
    v_fma_f32 v92, v92, v91, v91
    v_mfma_f32_16x16x32_bf16 v[60:63], v[224:227], a[236:239], v[60:63]
    buffer_load_dwordx4 v[224:227], v4, s[8:11], s30 offen offset:2048 sc1
    v_fma_f32 v93, v93, v91, v91
    v_fma_f32 v94, v94, v91, v91
    v_mfma_f32_16x16x32_bf16 v[48:51], v[228:231], a[240:243], v[48:51]
    v_fma_f32 v95, v95, v91, v91
    v_rcp_f32 v92, v92
    v_mfma_f32_16x16x32_bf16 v[52:55], v[228:231], a[244:247], v[52:55]
    v_rcp_f32 v93, v93
    v_rcp_f32 v94, v94
    v_mfma_f32_16x16x32_bf16 v[56:59], v[228:231], a[248:251], v[56:59]
    v_rcp_f32 v95, v95
    v_mul_f32 v92, v92, v76
    v_mfma_f32_16x16x32_bf16 v[60:63], v[228:231], a[252:255], v[60:63]
    buffer_load_dwordx4 v[228:231], v4, s[8:11], s30 offen offset:3072 sc1
    v_mul_f32 v93, v93, v77
    v_mul_f32 v94, v94, v78
    s_waitcnt vmcnt(30)
    v_mfma_f32_16x16x32_bf16 v[48:51], v[104:107], v[16:19], v[48:51]
    v_mul_f32 v95, v95, v79
    v_cvt_pk_bf16_f32 v102, v92, v93
    v_mfma_f32_16x16x32_bf16 v[52:55], v[104:107], v[20:23], v[52:55]
    v_cvt_pk_bf16_f32 v103, v94, v95
    ds_write_b64 v9, v[102:103] offset:32768
    v_mfma_f32_16x16x32_bf16 v[56:59], v[104:107], v[24:27], v[56:59]
    v_mfma_f32_16x16x32_bf16 v[60:63], v[104:107], v[28:31], v[60:63]
    s_add_u32 s30, s31, 67584
    buffer_load_dwordx4 v[104:107], v4, s[8:11], s30 offen offset:0 sc1
    v_mfma_f32_16x16x32_bf16 v[64:67], v[108:111], v[32:35], v[48:51]
    v_mfma_f32_16x16x32_bf16 v[68:71], v[108:111], v[36:39], v[52:55]
    v_mfma_f32_16x16x32_bf16 v[72:75], v[108:111], v[40:43], v[56:59]
    v_mfma_f32_16x16x32_bf16 v[76:79], v[108:111], v[44:47], v[60:63]
    buffer_load_dwordx4 v[108:111], v4, s[8:11], s30 offen offset:1024 sc1
    s_waitcnt vmcnt(30) lgkmcnt(15)
    v_mfma_f32_16x16x32_bf16 v[48:51], v[112:115], a[0:3], 0
    v_mfma_f32_16x16x32_bf16 v[52:55], v[112:115], a[4:7], 0
    v_mfma_f32_16x16x32_bf16 v[56:59], v[112:115], a[8:11], 0
    v_mfma_f32_16x16x32_bf16 v[60:63], v[112:115], a[12:15], 0
    buffer_load_dwordx4 v[112:115], v4, s[8:11], s30 offen offset:2048 sc1
    v_mul_f32 v92, v64, v64
    v_mul_f32 v93, v65, v65
    v_mul_f32 v94, v66, v66
    v_mfma_f32_16x16x32_bf16 v[48:51], v[116:119], a[16:19], v[48:51]
    v_mul_f32 v95, v67, v67
    v_fma_f32 v92, v92, v84, v80
    v_fma_f32 v93, v93, v84, v80
    v_mfma_f32_16x16x32_bf16 v[52:55], v[116:119], a[20:23], v[52:55]
    v_fma_f32 v94, v94, v84, v80
    v_fma_f32 v95, v95, v84, v80
    v_mul_f32 v92, v92, v64
    v_mfma_f32_16x16x32_bf16 v[56:59], v[116:119], a[24:27], v[56:59]
    v_mul_f32 v93, v93, v65
    v_mul_f32 v94, v94, v66
    v_mul_f32 v95, v95, v67
    v_mfma_f32_16x16x32_bf16 v[60:63], v[116:119], a[28:31], v[60:63]
    buffer_load_dwordx4 v[116:119], v4, s[8:11], s30 offen offset:3072 sc1
    v_exp_f32 v92, v92
    v_exp_f32 v93, v93
    v_exp_f32 v94, v94
    s_waitcnt vmcnt(30)
    v_mfma_f32_16x16x32_bf16 v[48:51], v[120:123], a[32:35], v[48:51]
    v_exp_f32 v95, v95
    v_fma_f32 v92, v92, v88, v88
    v_fma_f32 v93, v93, v88, v88
    v_mfma_f32_16x16x32_bf16 v[52:55], v[120:123], a[36:39], v[52:55]
    v_fma_f32 v94, v94, v88, v88
    v_fma_f32 v95, v95, v88, v88
    v_rcp_f32 v92, v92
    v_mfma_f32_16x16x32_bf16 v[56:59], v[120:123], a[40:43], v[56:59]
    v_rcp_f32 v93, v93
    v_rcp_f32 v94, v94
    v_rcp_f32 v95, v95
    v_mfma_f32_16x16x32_bf16 v[60:63], v[120:123], a[44:47], v[60:63]
    s_add_u32 s30, s31, 71680
    buffer_load_dwordx4 v[120:123], v4, s[8:11], s30 offen offset:0 sc1
    v_mul_f32 v92, v92, v64
    v_mul_f32 v93, v93, v65
    v_mfma_f32_16x16x32_bf16 v[48:51], v[124:127], a[48:51], v[48:51]
    v_mul_f32 v94, v94, v66
    v_mul_f32 v95, v95, v67
    v_cvt_pk_bf16_f32 v96, v92, v93
    v_mfma_f32_16x16x32_bf16 v[52:55], v[124:127], a[52:55], v[52:55]
    v_cvt_pk_bf16_f32 v97, v94, v95
    ds_write_b64 v8, v[96:97] offset:16384
    v_mul_f32 v92, v68, v68
    v_mfma_f32_16x16x32_bf16 v[56:59], v[124:127], a[56:59], v[56:59]
    v_mul_f32 v93, v69, v69
    v_mul_f32 v94, v70, v70
    v_mul_f32 v95, v71, v71
    v_mfma_f32_16x16x32_bf16 v[60:63], v[124:127], a[60:63], v[60:63]
    buffer_load_dwordx4 v[124:127], v4, s[8:11], s30 offen offset:1024 sc1
    v_fma_f32 v92, v92, v85, v81
    v_fma_f32 v93, v93, v85, v81
    v_fma_f32 v94, v94, v85, v81
    s_waitcnt vmcnt(30)
    v_mfma_f32_16x16x32_bf16 v[48:51], v[128:131], a[64:67], v[48:51]
    v_fma_f32 v95, v95, v85, v81
    v_mul_f32 v92, v92, v68
    v_mul_f32 v93, v93, v69
    v_mfma_f32_16x16x32_bf16 v[52:55], v[128:131], a[68:71], v[52:55]
    v_mul_f32 v94, v94, v70
    v_mul_f32 v95, v95, v71
    v_exp_f32 v92, v92
    v_mfma_f32_16x16x32_bf16 v[56:59], v[128:131], a[72:75], v[56:59]
    v_exp_f32 v93, v93
    v_exp_f32 v94, v94
    v_exp_f32 v95, v95
    v_mfma_f32_16x16x32_bf16 v[60:63], v[128:131], a[76:79], v[60:63]
    s_add_u32 s30, s31, 110592
    buffer_load_dwordx4 v[128:131], v4, s[8:11], s30 offen offset:0 sc1
    v_fma_f32 v92, v92, v89, v89
    v_fma_f32 v93, v93, v89, v89
    v_fma_f32 v94, v94, v89, v89
    v_mfma_f32_16x16x32_bf16 v[48:51], v[132:135], a[80:83], v[48:51]
    v_fma_f32 v95, v95, v89, v89
    v_rcp_f32 v92, v92
    v_mfma_f32_16x16x32_bf16 v[52:55], v[132:135], a[84:87], v[52:55]
    v_rcp_f32 v93, v93
    v_rcp_f32 v94, v94
    v_rcp_f32 v95, v95
    v_mfma_f32_16x16x32_bf16 v[56:59], v[132:135], a[88:91], v[56:59]
    v_mul_f32 v92, v92, v68
    v_mul_f32 v93, v93, v69
    v_mul_f32 v94, v94, v70
    v_mfma_f32_16x16x32_bf16 v[60:63], v[132:135], a[92:95], v[60:63]
    buffer_load_dwordx4 v[132:135], v4, s[8:11], s30 offen offset:1024 sc1
    v_mul_f32 v95, v95, v71
    v_cvt_pk_bf16_f32 v98, v92, v93
    v_cvt_pk_bf16_f32 v99, v94, v95
    s_waitcnt vmcnt(30)
    v_mfma_f32_16x16x32_bf16 v[48:51], v[136:139], a[96:99], v[48:51]
    ds_write_b64 v8, v[98:99] offset:34816
    v_mul_f32 v92, v72, v72
    v_mul_f32 v93, v73, v73
    v_mfma_f32_16x16x32_bf16 v[52:55], v[136:139], a[100:103], v[52:55]
    v_mul_f32 v94, v74, v74
    v_mul_f32 v95, v75, v75
    v_fma_f32 v92, v92, v86, v82
    v_mfma_f32_16x16x32_bf16 v[56:59], v[136:139], a[104:107], v[56:59]
    v_fma_f32 v93, v93, v86, v82
    v_fma_f32 v94, v94, v86, v82
    v_fma_f32 v95, v95, v86, v82
    v_mfma_f32_16x16x32_bf16 v[60:63], v[136:139], a[108:111], v[60:63]
    buffer_load_dwordx4 v[136:139], v4, s[8:11], s30 offen offset:2048 sc1
    v_mul_f32 v92, v92, v72
    v_mul_f32 v93, v93, v73
    v_mul_f32 v94, v94, v74
    v_mfma_f32_16x16x32_bf16 v[48:51], v[140:143], a[112:115], v[48:51]
    v_mul_f32 v95, v95, v75
    v_exp_f32 v92, v92
    v_mfma_f32_16x16x32_bf16 v[52:55], v[140:143], a[116:119], v[52:55]
    v_exp_f32 v93, v93
    v_exp_f32 v94, v94
    v_exp_f32 v95, v95
    v_mfma_f32_16x16x32_bf16 v[56:59], v[140:143], a[120:123], v[56:59]
    v_fma_f32 v92, v92, v90, v90
    v_fma_f32 v93, v93, v90, v90
    v_fma_f32 v94, v94, v90, v90
    v_mfma_f32_16x16x32_bf16 v[60:63], v[140:143], a[124:127], v[60:63]
    buffer_load_dwordx4 v[140:143], v4, s[8:11], s30 offen offset:3072 sc1
    v_fma_f32 v95, v95, v90, v90
    v_rcp_f32 v92, v92
    v_rcp_f32 v93, v93
    s_waitcnt vmcnt(30)
    v_mfma_f32_16x16x32_bf16 v[48:51], v[144:147], a[128:131], v[48:51]
    v_rcp_f32 v94, v94
    v_rcp_f32 v95, v95
    v_mul_f32 v92, v92, v72
    v_mfma_f32_16x16x32_bf16 v[52:55], v[144:147], a[132:135], v[52:55]
    v_mul_f32 v93, v93, v73
    v_mul_f32 v94, v94, v74
    v_mul_f32 v95, v95, v75
    v_mfma_f32_16x16x32_bf16 v[56:59], v[144:147], a[136:139], v[56:59]
    v_cvt_pk_bf16_f32 v100, v92, v93
    v_cvt_pk_bf16_f32 v101, v94, v95
    ds_write_b64 v9, v[100:101] offset:16384
    v_mfma_f32_16x16x32_bf16 v[60:63], v[144:147], a[140:143], v[60:63]
    s_add_u32 s30, s31, 114688
    buffer_load_dwordx4 v[144:147], v4, s[8:11], s30 offen offset:0 sc1
    v_mul_f32 v92, v76, v76
    v_mul_f32 v93, v77, v77
    v_mul_f32 v94, v78, v78
    v_mfma_f32_16x16x32_bf16 v[48:51], v[148:151], a[144:147], v[48:51]
    v_mul_f32 v95, v79, v79
    v_fma_f32 v92, v92, v87, v83
    v_fma_f32 v93, v93, v87, v83
    v_mfma_f32_16x16x32_bf16 v[52:55], v[148:151], a[148:151], v[52:55]
    v_fma_f32 v94, v94, v87, v83
    v_fma_f32 v95, v95, v87, v83
    v_mfma_f32_16x16x32_bf16 v[56:59], v[148:151], a[152:155], v[56:59]
    v_mul_f32 v92, v92, v76
    v_mul_f32 v93, v93, v77
    v_mul_f32 v94, v94, v78
    v_mfma_f32_16x16x32_bf16 v[60:63], v[148:151], a[156:159], v[60:63]
    buffer_load_dwordx4 v[148:151], v4, s[8:11], s30 offen offset:1024 sc1
    v_mul_f32 v95, v95, v79
    v_exp_f32 v92, v92
    v_exp_f32 v93, v93
    s_waitcnt vmcnt(30) lgkmcnt(15)
    v_mfma_f32_16x16x32_bf16 v[48:51], v[152:155], a[160:163], v[48:51]
    v_exp_f32 v94, v94
    v_exp_f32 v95, v95
    v_fma_f32 v92, v92, v91, v91
    v_mfma_f32_16x16x32_bf16 v[52:55], v[152:155], a[164:167], v[52:55]
    v_fma_f32 v93, v93, v91, v91
    v_fma_f32 v94, v94, v91, v91
    v_fma_f32 v95, v95, v91, v91
    v_mfma_f32_16x16x32_bf16 v[56:59], v[152:155], a[168:171], v[56:59]
    v_rcp_f32 v92, v92
    v_rcp_f32 v93, v93
    v_rcp_f32 v94, v94
    v_mfma_f32_16x16x32_bf16 v[60:63], v[152:155], a[172:175], v[60:63]
    buffer_load_dwordx4 v[152:155], v4, s[8:11], s30 offen offset:2048 sc1
    v_rcp_f32 v95, v95
    v_mul_f32 v92, v92, v76
    v_mul_f32 v93, v93, v77
    s_waitcnt lgkmcnt(13)
    v_mfma_f32_16x16x32_bf16 v[48:51], v[156:159], a[176:179], v[48:51]
    v_mul_f32 v94, v94, v78
    v_mul_f32 v95, v95, v79
    v_cvt_pk_bf16_f32 v102, v92, v93
    v_mfma_f32_16x16x32_bf16 v[52:55], v[156:159], a[180:183], v[52:55]
    v_cvt_pk_bf16_f32 v103, v94, v95
    ds_write_b64 v9, v[102:103] offset:34816
    v_mfma_f32_16x16x32_bf16 v[56:59], v[156:159], a[184:187], v[56:59]
    v_mfma_f32_16x16x32_bf16 v[60:63], v[156:159], a[188:191], v[60:63]
    buffer_load_dwordx4 v[156:159], v4, s[8:11], s30 offen offset:3072 sc1
    s_waitcnt lgkmcnt(0)
    s_barrier
    ds_read_b128 a[224:227], v12 offset:14336
    ds_read_b128 a[228:231], v12 offset:32768
    ds_read_b128 a[232:235], v13 offset:14336
    ds_read_b128 a[236:239], v13 offset:32768
    ds_read_b128 a[240:243], v12 offset:15360
    ds_read_b128 a[244:247], v12 offset:33792
    ds_read_b128 a[248:251], v13 offset:15360
    ds_read_b128 a[252:255], v13 offset:33792
    s_waitcnt vmcnt(30)
    v_mfma_f32_16x16x32_bf16 v[48:51], v[160:163], a[192:195], v[48:51]
    v_mfma_f32_16x16x32_bf16 v[52:55], v[160:163], a[196:199], v[52:55]
    v_mfma_f32_16x16x32_bf16 v[56:59], v[160:163], a[200:203], v[56:59]
    v_mfma_f32_16x16x32_bf16 v[60:63], v[160:163], a[204:207], v[60:63]
    s_add_u32 s30, s31, 118784
    buffer_load_dwordx4 v[160:163], v4, s[8:11], s30 offen offset:0 sc1
    ds_read_b128 v[16:19], v12 offset:16384
    ds_read_b128 v[20:23], v12 offset:34816
    ds_read_b128 v[24:27], v13 offset:16384
    ds_read_b128 v[28:31], v13 offset:34816
    ds_read_b128 v[32:35], v12 offset:17408
    ds_read_b128 v[36:39], v12 offset:35840
    ds_read_b128 v[40:43], v13 offset:17408
    ds_read_b128 v[44:47], v13 offset:35840
    v_mfma_f32_16x16x32_bf16 v[48:51], v[164:167], a[208:211], v[48:51]
    v_mfma_f32_16x16x32_bf16 v[52:55], v[164:167], a[212:215], v[52:55]
    v_mfma_f32_16x16x32_bf16 v[56:59], v[164:167], a[216:219], v[56:59]
    v_mfma_f32_16x16x32_bf16 v[60:63], v[164:167], a[220:223], v[60:63]
    buffer_load_dwordx4 v[164:167], v4, s[8:11], s30 offen offset:1024 sc1
    s_waitcnt vmcnt(30) lgkmcnt(12)
    v_mfma_f32_16x16x32_bf16 v[48:51], v[168:171], a[224:227], v[48:51]
    v_mfma_f32_16x16x32_bf16 v[52:55], v[168:171], a[228:231], v[52:55]
    v_mfma_f32_16x16x32_bf16 v[56:59], v[168:171], a[232:235], v[56:59]
    v_mfma_f32_16x16x32_bf16 v[60:63], v[168:171], a[236:239], v[60:63]
    buffer_load_dwordx4 v[168:171], v4, s[8:11], s30 offen offset:2048 sc1
    s_waitcnt lgkmcnt(8)
    v_mfma_f32_16x16x32_bf16 v[48:51], v[172:175], a[240:243], v[48:51]
    v_mfma_f32_16x16x32_bf16 v[52:55], v[172:175], a[244:247], v[52:55]
    v_mfma_f32_16x16x32_bf16 v[56:59], v[172:175], a[248:251], v[56:59]
    v_mfma_f32_16x16x32_bf16 v[60:63], v[172:175], a[252:255], v[60:63]
    buffer_load_dwordx4 v[172:175], v4, s[8:11], s30 offen offset:3072 sc1
    s_waitcnt vmcnt(30) lgkmcnt(4)
    v_mfma_f32_16x16x32_bf16 v[48:51], v[176:179], v[16:19], v[48:51]
    v_mfma_f32_16x16x32_bf16 v[52:55], v[176:179], v[20:23], v[52:55]
    v_mfma_f32_16x16x32_bf16 v[56:59], v[176:179], v[24:27], v[56:59]
    v_mfma_f32_16x16x32_bf16 v[60:63], v[176:179], v[28:31], v[60:63]
    s_add_u32 s30, s31, 122880
    buffer_load_dwordx4 v[176:179], v4, s[8:11], s30 offen offset:0 sc1
    s_waitcnt lgkmcnt(0)
    v_mfma_f32_16x16x32_bf16 v[64:67], v[180:183], v[32:35], v[48:51]
    v_mfma_f32_16x16x32_bf16 v[68:71], v[180:183], v[36:39], v[52:55]
    v_mfma_f32_16x16x32_bf16 v[72:75], v[180:183], v[40:43], v[56:59]
    v_mfma_f32_16x16x32_bf16 v[76:79], v[180:183], v[44:47], v[60:63]
    buffer_load_dwordx4 v[180:183], v4, s[8:11], s30 offen offset:1024 sc1
    s_waitcnt vmcnt(30)
    v_mfma_f32_16x16x32_bf16 v[48:51], v[184:187], a[0:3], 0
    v_mfma_f32_16x16x32_bf16 v[52:55], v[184:187], a[4:7], 0
    v_mfma_f32_16x16x32_bf16 v[56:59], v[184:187], a[8:11], 0
    v_mfma_f32_16x16x32_bf16 v[60:63], v[184:187], a[12:15], 0
    buffer_load_dwordx4 v[184:187], v4, s[8:11], s30 offen offset:2048 sc1
    v_mfma_f32_16x16x32_bf16 v[48:51], v[188:191], a[16:19], v[48:51]
    s_add_u32 s35, s34, 0
    v_cvt_pk_bf16_f32 v96, v64, v65
    v_mfma_f32_16x16x32_bf16 v[52:55], v[188:191], a[20:23], v[52:55]
    v_cvt_pk_bf16_f32 v97, v66, v67
    v_mfma_f32_16x16x32_bf16 v[56:59], v[188:191], a[24:27], v[56:59]
    v_cvt_pk_bf16_f32 v98, v68, v69
    v_cvt_pk_bf16_f32 v99, v70, v71
    v_mfma_f32_16x16x32_bf16 v[60:63], v[188:191], a[28:31], v[60:63]
    buffer_load_dwordx4 v[188:191], v4, s[8:11], s30 offen offset:3072 sc1
    buffer_store_dwordx4 v[96:99], v4, s[8:11], s35 offen offset:0 sc1
    s_waitcnt vmcnt(31)
    v_mfma_f32_16x16x32_bf16 v[48:51], v[192:195], a[32:35], v[48:51]
    ds_write_b128 v14, v[96:99] offset:0
    v_cvt_pk_bf16_f32 v100, v72, v73
    v_mfma_f32_16x16x32_bf16 v[52:55], v[192:195], a[36:39], v[52:55]
    v_cvt_pk_bf16_f32 v101, v74, v75
    v_mfma_f32_16x16x32_bf16 v[56:59], v[192:195], a[40:43], v[56:59]
    v_cvt_pk_bf16_f32 v102, v76, v77
    v_cvt_pk_bf16_f32 v103, v78, v79
    v_mfma_f32_16x16x32_bf16 v[60:63], v[192:195], a[44:47], v[60:63]
    s_add_u32 s30, s31, 126976
    buffer_load_dwordx4 v[192:195], v4, s[8:11], s30 offen offset:0 sc1
    buffer_store_dwordx4 v[100:103], v4, s[8:11], s35 offen offset:1024 sc1
    v_mfma_f32_16x16x32_bf16 v[48:51], v[196:199], a[48:51], v[48:51]
    ds_write_b128 v14, v[100:103] offset:1024
    s_mov_b32 s12, s22
    v_mfma_f32_16x16x32_bf16 v[52:55], v[196:199], a[52:55], v[52:55]
    s_and_b32 s13, s23, 0xffff
    v_mfma_f32_16x16x32_bf16 v[56:59], v[196:199], a[56:59], v[56:59]
    s_mov_b32 s14, 2359296
    s_mov_b32 s15, 0x00020000
    v_mfma_f32_16x16x32_bf16 v[60:63], v[196:199], a[60:63], v[60:63]
    buffer_load_dwordx4 v[196:199], v4, s[8:11], s30 offen offset:1024 sc1
    s_lshl_b32 s38, s26, 2
    s_waitcnt vmcnt(32)
    v_mfma_f32_16x16x32_bf16 v[48:51], v[200:203], a[64:67], v[48:51]
    s_add_u32 s38, s38, s24
    s_mul_i32 s38, s38, 9
    v_mfma_f32_16x16x32_bf16 v[52:55], v[200:203], a[68:71], v[52:55]
    s_mul_i32 s39, s3, 3
    v_mfma_f32_16x16x32_bf16 v[56:59], v[200:203], a[72:75], v[56:59]
    s_add_u32 s38, s38, s39
    s_lshl_b32 s38, s38, 1
    v_mfma_f32_16x16x32_bf16 v[60:63], v[200:203], a[76:79], v[60:63]
    s_add_u32 s30, s31, 18432
    buffer_load_dwordx4 v[200:203], v4, s[8:11], s30 offen offset:0 sc1
    s_add_u32 s38, s38, s29
    v_mfma_f32_16x16x32_bf16 v[48:51], v[204:207], a[80:83], v[48:51]
    s_lshl_b32 s38, s38, 10
    v_mfma_f32_16x16x32_bf16 v[52:55], v[204:207], a[84:87], v[52:55]
    s_add_u32 s38, s38, 14155776
    s_mul_i32 s40, s25, 36864
    v_mfma_f32_16x16x32_bf16 v[56:59], v[204:207], a[88:91], v[56:59]
    s_lshl_b32 s36, s27, 5
    v_mfma_f32_16x16x32_bf16 v[60:63], v[204:207], a[92:95], v[60:63]
    buffer_load_dwordx4 v[204:207], v4, s[8:11], s30 offen offset:1024 sc1
    s_add_u32 s40, s40, s36
    v_bfe_u32 v5, v3, 2, 1
    s_waitcnt vmcnt(32)
    v_mfma_f32_16x16x32_bf16 v[48:51], v[208:211], a[96:99], v[48:51]
    v_lshlrev_b32 v5, 4, v5
    v_mfma_f32_16x16x32_bf16 v[52:55], v[208:211], a[100:103], v[52:55]
    v_lshrrev_b32 v7, 3, v3
    v_lshl_add_u32 v5, v7, 2, v5
    v_mfma_f32_16x16x32_bf16 v[56:59], v[208:211], a[104:107], v[56:59]
    v_and_b32 v7, 3, v3
    v_mfma_f32_16x16x32_bf16 v[60:63], v[208:211], a[108:111], v[60:63]
    buffer_load_dwordx4 v[208:211], v4, s[8:11], s30 offen offset:2048 sc1
    v_add_u32 v5, v5, v7
    v_mul_u32_u24 v6, 1152, v5
    v_mfma_f32_16x16x32_bf16 v[48:51], v[212:215], a[112:115], v[48:51]
    v_lshl_add_u32 v6, v2, 3, v6
    v_mfma_f32_16x16x32_bf16 v[52:55], v[212:215], a[116:119], v[52:55]
    v_add_u32 v7, 9216, v6
    v_add_u32 v11, 4096, v4
    v_mfma_f32_16x16x32_bf16 v[56:59], v[212:215], a[120:123], v[56:59]
    s_mul_i32 s41, s24, 18432
    v_mfma_f32_16x16x32_bf16 v[60:63], v[212:215], a[124:127], v[60:63]
    buffer_load_dwordx4 v[212:215], v4, s[8:11], s30 offen offset:3072 sc1
    s_mul_i32 s42, s3, 6144
    s_add_u32 s41, s41, s42
    s_waitcnt vmcnt(32)
    v_mfma_f32_16x16x32_bf16 v[48:51], v[216:219], a[128:131], v[48:51]
    s_lshl_b32 s42, s29, 10
    v_mfma_f32_16x16x32_bf16 v[52:55], v[216:219], a[132:135], v[52:55]
    s_add_u32 s41, s41, s42
    v_add_u32 v9, s41, v4
    v_mfma_f32_16x16x32_bf16 v[56:59], v[216:219], a[136:139], v[56:59]
    v_mov_b32 v250, 1
    v_mfma_f32_16x16x32_bf16 v[60:63], v[216:219], a[140:143], v[60:63]
    s_add_u32 s30, s31, 22528
    buffer_load_dwordx4 v[216:219], v4, s[8:11], s30 offen offset:0 sc1
    v_mov_b32 v251, 0
    v_mfma_f32_16x16x32_bf16 v[48:51], v[220:223], a[144:147], v[48:51]
    s_lshl_b32 s44, s26, 9
    s_lshl_b32 s45, s24, 5
    v_mfma_f32_16x16x32_bf16 v[52:55], v[220:223], a[148:151], v[52:55]
    s_add_u32 s45, s45, s44
    v_mfma_f32_16x16x32_bf16 v[56:59], v[220:223], a[152:155], v[56:59]
    v_and_b32 v247, 7, v1
    v_lshlrev_b32 v247, 2, v247
    v_mfma_f32_16x16x32_bf16 v[60:63], v[220:223], a[156:159], v[60:63]
    buffer_load_dwordx4 v[220:223], v4, s[8:11], s30 offen offset:1024 sc1
    v_add_u32 v247, s45, v247
    s_waitcnt vmcnt(32)
    v_mfma_f32_16x16x32_bf16 v[48:51], v[224:227], a[160:163], v[48:51]
    s_lshl_b32 s45, s3, 5
    s_add_u32 s44, s44, s45
    v_mfma_f32_16x16x32_bf16 v[52:55], v[224:227], a[164:167], v[52:55]
    s_lshl_b32 s45, s28, 2
    v_mfma_f32_16x16x32_bf16 v[56:59], v[224:227], a[168:171], v[56:59]
    s_add_u32 s44, s44, s45
    s_add_u32 s44, s44, 47646720
    v_mfma_f32_16x16x32_bf16 v[60:63], v[224:227], a[172:175], v[60:63]
    buffer_load_dwordx4 v[224:227], v4, s[8:11], s30 offen offset:2048 sc1
    s_mov_b32 s45, 47646720
    v_mfma_f32_16x16x32_bf16 v[48:51], v[228:231], a[176:179], v[48:51]
    s_mov_b32 s48, s8
    s_mov_b32 s49, s9
    v_mfma_f32_16x16x32_bf16 v[52:55], v[228:231], a[180:183], v[52:55]
    s_mov_b32 s51, 0x00020000
    v_mfma_f32_16x16x32_bf16 v[56:59], v[228:231], a[184:187], v[56:59]
    s_add_u32 s42, s28, 1
    s_and_b32 s42, s42, 7
    v_mfma_f32_16x16x32_bf16 v[60:63], v[228:231], a[188:191], v[60:63]
    buffer_load_dwordx4 v[228:231], v4, s[8:11], s30 offen offset:3072 sc1
    s_mul_i32 s42, s42, 2359296
    s_waitcnt vmcnt(32)
    v_mfma_f32_16x16x32_bf16 v[48:51], v[104:107], a[192:195], v[48:51]
    s_add_u32 s52, s42, s38
    s_add_u32 s42, s28, 2
    v_mfma_f32_16x16x32_bf16 v[52:55], v[104:107], a[196:199], v[52:55]
    s_and_b32 s42, s42, 7
    v_mfma_f32_16x16x32_bf16 v[56:59], v[104:107], a[200:203], v[56:59]
    s_mul_i32 s42, s42, 2359296
    v_mfma_f32_16x16x32_bf16 v[60:63], v[104:107], a[204:207], v[60:63]
    s_add_u32 s30, s31, 26624
    buffer_load_dwordx4 v[104:107], v4, s[8:11], s30 offen offset:0 sc1
    s_add_u32 s53, s42, s38
    s_add_u32 s42, s28, 3
    v_mfma_f32_16x16x32_bf16 v[48:51], v[108:111], a[208:211], v[48:51]
    s_and_b32 s42, s42, 7
    v_mfma_f32_16x16x32_bf16 v[52:55], v[108:111], a[212:215], v[52:55]
    s_mul_i32 s42, s42, 2359296
    s_add_u32 s54, s42, s38
    v_mfma_f32_16x16x32_bf16 v[56:59], v[108:111], a[216:219], v[56:59]
    s_add_u32 s42, s28, 4
    v_mfma_f32_16x16x32_bf16 v[60:63], v[108:111], a[220:223], v[60:63]
    buffer_load_dwordx4 v[108:111], v4, s[8:11], s30 offen offset:1024 sc1
    s_and_b32 s42, s42, 7
    s_mul_i32 s42, s42, 2359296
    s_waitcnt vmcnt(32)
    v_mfma_f32_16x16x32_bf16 v[48:51], v[112:115], a[224:227], v[48:51]
    s_add_u32 s55, s42, s38
    v_mfma_f32_16x16x32_bf16 v[52:55], v[112:115], a[228:231], v[52:55]
    s_add_u32 s42, s28, 5
    s_and_b32 s42, s42, 7
    v_mfma_f32_16x16x32_bf16 v[56:59], v[112:115], a[232:235], v[56:59]
    s_mul_i32 s42, s42, 2359296
    v_mfma_f32_16x16x32_bf16 v[60:63], v[112:115], a[236:239], v[60:63]
    buffer_load_dwordx4 v[112:115], v4, s[8:11], s30 offen offset:2048 sc1
    s_add_u32 s56, s42, s38
    s_add_u32 s42, s28, 6
    v_mfma_f32_16x16x32_bf16 v[48:51], v[116:119], a[240:243], v[48:51]
    s_and_b32 s42, s42, 7
    v_mfma_f32_16x16x32_bf16 v[52:55], v[116:119], a[244:247], v[52:55]
    s_mul_i32 s42, s42, 2359296
    s_add_u32 s57, s42, s38
    v_mfma_f32_16x16x32_bf16 v[56:59], v[116:119], a[248:251], v[56:59]
    s_add_u32 s42, s28, 7
    v_mfma_f32_16x16x32_bf16 v[60:63], v[116:119], a[252:255], v[60:63]
    buffer_load_dwordx4 v[116:119], v4, s[8:11], s30 offen offset:3072 sc1
    s_and_b32 s42, s42, 7
    s_mul_i32 s42, s42, 2359296
    s_waitcnt vmcnt(32)
    v_mfma_f32_16x16x32_bf16 v[48:51], v[120:123], v[16:19], v[48:51]
    s_add_u32 s58, s42, s38
    v_mfma_f32_16x16x32_bf16 v[52:55], v[120:123], v[20:23], v[52:55]
    s_cmp_eq_u32 s3, 3
    s_cselect_b32 s50, 0, 268435456
    v_mfma_f32_16x16x32_bf16 v[56:59], v[120:123], v[24:27], v[56:59]
    v_mfma_f32_16x16x32_bf16 v[60:63], v[120:123], v[28:31], v[60:63]
    s_add_u32 s30, s31, 30720
    buffer_load_dwordx4 v[120:123], v4, s[8:11], s30 offen offset:0 sc1
    v_mfma_f32_16x16x32_bf16 v[64:67], v[124:127], v[32:35], v[48:51]
    v_mfma_f32_16x16x32_bf16 v[68:71], v[124:127], v[36:39], v[52:55]
    v_mfma_f32_16x16x32_bf16 v[72:75], v[124:127], v[40:43], v[56:59]
    v_mfma_f32_16x16x32_bf16 v[76:79], v[124:127], v[44:47], v[60:63]
    buffer_load_dwordx4 v[124:127], v4, s[8:11], s30 offen offset:1024 sc1
    s_waitcnt vmcnt(32)
    v_mfma_f32_16x16x32_bf16 v[48:51], v[128:131], a[0:3], 0
    v_mfma_f32_16x16x32_bf16 v[52:55], v[128:131], a[4:7], 0
    v_mfma_f32_16x16x32_bf16 v[56:59], v[128:131], a[8:11], 0
    v_mfma_f32_16x16x32_bf16 v[60:63], v[128:131], a[12:15], 0
    buffer_load_dwordx4 v[128:131], v4, s[8:11], s30 offen offset:2048 sc1
    v_mfma_f32_16x16x32_bf16 v[48:51], v[132:135], a[16:19], v[48:51]
    s_add_u32 s35, s34, 6144
    v_mfma_f32_16x16x32_bf16 v[52:55], v[132:135], a[20:23], v[52:55]
    v_cvt_pk_bf16_f32 v96, v64, v65
    v_mfma_f32_16x16x32_bf16 v[56:59], v[132:135], a[24:27], v[56:59]
    v_mfma_f32_16x16x32_bf16 v[60:63], v[132:135], a[28:31], v[60:63]
    buffer_load_dwordx4 v[132:135], v4, s[8:11], s30 offen offset:3072 sc1
    v_cvt_pk_bf16_f32 v97, v66, v67
    s_waitcnt vmcnt(32)
    v_mfma_f32_16x16x32_bf16 v[48:51], v[136:139], a[32:35], v[48:51]
    v_mfma_f32_16x16x32_bf16 v[52:55], v[136:139], a[36:39], v[52:55]
    v_cvt_pk_bf16_f32 v98, v68, v69
    v_mfma_f32_16x16x32_bf16 v[56:59], v[136:139], a[40:43], v[56:59]
    v_mfma_f32_16x16x32_bf16 v[60:63], v[136:139], a[44:47], v[60:63]
    s_add_u32 s30, s31, 34816
    buffer_load_dwordx4 v[136:139], v4, s[8:11], s30 offen offset:0 sc1
    v_cvt_pk_bf16_f32 v99, v70, v71
    v_mfma_f32_16x16x32_bf16 v[48:51], v[140:143], a[48:51], v[48:51]
    v_mfma_f32_16x16x32_bf16 v[52:55], v[140:143], a[52:55], v[52:55]
    buffer_store_dwordx4 v[96:99], v4, s[8:11], s35 offen offset:0 sc1
    v_mfma_f32_16x16x32_bf16 v[56:59], v[140:143], a[56:59], v[56:59]
    v_mfma_f32_16x16x32_bf16 v[60:63], v[140:143], a[60:63], v[60:63]
    buffer_load_dwordx4 v[140:143], v4, s[8:11], s30 offen offset:1024 sc1
    ds_write_b128 v14, v[96:99] offset:6144
    s_waitcnt vmcnt(33)
    v_mfma_f32_16x16x32_bf16 v[48:51], v[144:147], a[64:67], v[48:51]
    v_cvt_pk_bf16_f32 v100, v72, v73
    v_mfma_f32_16x16x32_bf16 v[52:55], v[144:147], a[68:71], v[52:55]
    v_mfma_f32_16x16x32_bf16 v[56:59], v[144:147], a[72:75], v[56:59]
    v_cvt_pk_bf16_f32 v101, v74, v75
    v_mfma_f32_16x16x32_bf16 v[60:63], v[144:147], a[76:79], v[60:63]
    s_add_u32 s30, s31, 73728
    buffer_load_dwordx4 v[144:147], v4, s[8:11], s30 offen offset:0 sc1
    v_mfma_f32_16x16x32_bf16 v[48:51], v[148:151], a[80:83], v[48:51]
    v_cvt_pk_bf16_f32 v102, v76, v77
    v_mfma_f32_16x16x32_bf16 v[52:55], v[148:151], a[84:87], v[52:55]
    v_mfma_f32_16x16x32_bf16 v[56:59], v[148:151], a[88:91], v[56:59]
    v_cvt_pk_bf16_f32 v103, v78, v79
    v_mfma_f32_16x16x32_bf16 v[60:63], v[148:151], a[92:95], v[60:63]
    buffer_load_dwordx4 v[148:151], v4, s[8:11], s30 offen offset:1024 sc1
    s_waitcnt vmcnt(33)
    v_mfma_f32_16x16x32_bf16 v[48:51], v[152:155], a[96:99], v[48:51]
    buffer_store_dwordx4 v[100:103], v4, s[8:11], s35 offen offset:1024 sc1
    v_mfma_f32_16x16x32_bf16 v[52:55], v[152:155], a[100:103], v[52:55]
    v_mfma_f32_16x16x32_bf16 v[56:59], v[152:155], a[104:107], v[56:59]
    ds_write_b128 v14, v[100:103] offset:7168
    v_mfma_f32_16x16x32_bf16 v[60:63], v[152:155], a[108:111], v[60:63]
    buffer_load_dwordx4 v[152:155], v4, s[8:11], s30 offen offset:2048 sc1
    v_mfma_f32_16x16x32_bf16 v[48:51], v[156:159], a[112:115], v[48:51]
    v_mfma_f32_16x16x32_bf16 v[52:55], v[156:159], a[116:119], v[52:55]
    v_mfma_f32_16x16x32_bf16 v[56:59], v[156:159], a[120:123], v[56:59]
    v_mfma_f32_16x16x32_bf16 v[60:63], v[156:159], a[124:127], v[60:63]
    buffer_load_dwordx4 v[156:159], v4, s[8:11], s30 offen offset:3072 sc1
    s_waitcnt vmcnt(34)
    v_mfma_f32_16x16x32_bf16 v[48:51], v[160:163], a[128:131], v[48:51]
    v_mfma_f32_16x16x32_bf16 v[52:55], v[160:163], a[132:135], v[52:55]
    v_mfma_f32_16x16x32_bf16 v[56:59], v[160:163], a[136:139], v[56:59]
    v_mfma_f32_16x16x32_bf16 v[60:63], v[160:163], a[140:143], v[60:63]
    s_add_u32 s30, s31, 77824
    buffer_load_dwordx4 v[160:163], v4, s[8:11], s30 offen offset:0 sc1
    v_mfma_f32_16x16x32_bf16 v[48:51], v[164:167], a[144:147], v[48:51]
    v_mfma_f32_16x16x32_bf16 v[52:55], v[164:167], a[148:151], v[52:55]
    v_mfma_f32_16x16x32_bf16 v[56:59], v[164:167], a[152:155], v[56:59]
    v_mfma_f32_16x16x32_bf16 v[60:63], v[164:167], a[156:159], v[60:63]
    buffer_load_dwordx4 v[164:167], v4, s[8:11], s30 offen offset:1024 sc1
    s_waitcnt vmcnt(34)
    v_mfma_f32_16x16x32_bf16 v[48:51], v[168:171], a[160:163], v[48:51]
    v_mfma_f32_16x16x32_bf16 v[52:55], v[168:171], a[164:167], v[52:55]
    v_mfma_f32_16x16x32_bf16 v[56:59], v[168:171], a[168:171], v[56:59]
    v_mfma_f32_16x16x32_bf16 v[60:63], v[168:171], a[172:175], v[60:63]
    buffer_load_dwordx4 v[168:171], v4, s[8:11], s30 offen offset:2048 sc1
    v_mfma_f32_16x16x32_bf16 v[48:51], v[172:175], a[176:179], v[48:51]
    v_mfma_f32_16x16x32_bf16 v[52:55], v[172:175], a[180:183], v[52:55]
    v_mfma_f32_16x16x32_bf16 v[56:59], v[172:175], a[184:187], v[56:59]
    v_mfma_f32_16x16x32_bf16 v[60:63], v[172:175], a[188:191], v[60:63]
    buffer_load_dwordx4 v[172:175], v4, s[8:11], s30 offen offset:3072 sc1
    s_waitcnt vmcnt(34)
    v_mfma_f32_16x16x32_bf16 v[48:51], v[176:179], a[192:195], v[48:51]
    v_mfma_f32_16x16x32_bf16 v[52:55], v[176:179], a[196:199], v[52:55]
    v_mfma_f32_16x16x32_bf16 v[56:59], v[176:179], a[200:203], v[56:59]
    v_mfma_f32_16x16x32_bf16 v[60:63], v[176:179], a[204:207], v[60:63]
    s_add_u32 s30, s31, 81920
    buffer_load_dwordx4 v[176:179], v4, s[8:11], s30 offen offset:0 sc1
    v_mfma_f32_16x16x32_bf16 v[48:51], v[180:183], a[208:211], v[48:51]
    v_mfma_f32_16x16x32_bf16 v[52:55], v[180:183], a[212:215], v[52:55]
    v_mfma_f32_16x16x32_bf16 v[56:59], v[180:183], a[216:219], v[56:59]
    v_mfma_f32_16x16x32_bf16 v[60:63], v[180:183], a[220:223], v[60:63]
    buffer_load_dwordx4 v[180:183], v4, s[8:11], s30 offen offset:1024 sc1
    s_waitcnt vmcnt(34)
    v_mfma_f32_16x16x32_bf16 v[48:51], v[184:187], a[224:227], v[48:51]
    v_mfma_f32_16x16x32_bf16 v[52:55], v[184:187], a[228:231], v[52:55]
    v_mfma_f32_16x16x32_bf16 v[56:59], v[184:187], a[232:235], v[56:59]
    v_mfma_f32_16x16x32_bf16 v[60:63], v[184:187], a[236:239], v[60:63]
    buffer_load_dwordx4 v[184:187], v4, s[8:11], s30 offen offset:2048 sc1
    v_mfma_f32_16x16x32_bf16 v[48:51], v[188:191], a[240:243], v[48:51]
    v_mfma_f32_16x16x32_bf16 v[52:55], v[188:191], a[244:247], v[52:55]
    v_mfma_f32_16x16x32_bf16 v[56:59], v[188:191], a[248:251], v[56:59]
    v_mfma_f32_16x16x32_bf16 v[60:63], v[188:191], a[252:255], v[60:63]
    buffer_load_dwordx4 v[188:191], v4, s[8:11], s30 offen offset:3072 sc1
    s_waitcnt vmcnt(32)
    v_mfma_f32_16x16x32_bf16 v[48:51], v[192:195], v[16:19], v[48:51]
    v_mfma_f32_16x16x32_bf16 v[52:55], v[192:195], v[20:23], v[52:55]
    v_mfma_f32_16x16x32_bf16 v[56:59], v[192:195], v[24:27], v[56:59]
    v_mfma_f32_16x16x32_bf16 v[60:63], v[192:195], v[28:31], v[60:63]
    s_add_u32 s30, s31, 86016
    buffer_load_dwordx4 v[192:195], v4, s[8:11], s30 offen offset:0 sc1
    v_mfma_f32_16x16x32_bf16 v[64:67], v[196:199], v[32:35], v[48:51]
    v_mfma_f32_16x16x32_bf16 v[68:71], v[196:199], v[36:39], v[52:55]
    v_mfma_f32_16x16x32_bf16 v[72:75], v[196:199], v[40:43], v[56:59]
    v_mfma_f32_16x16x32_bf16 v[76:79], v[196:199], v[44:47], v[60:63]
    buffer_load_dwordx4 v[196:199], v4, s[8:11], s30 offen offset:1024 sc1
    s_waitcnt vmcnt(32)
    v_mfma_f32_16x16x32_bf16 v[48:51], v[200:203], a[0:3], 0
    v_mfma_f32_16x16x32_bf16 v[52:55], v[200:203], a[4:7], 0
    v_mfma_f32_16x16x32_bf16 v[56:59], v[200:203], a[8:11], 0
    v_mfma_f32_16x16x32_bf16 v[60:63], v[200:203], a[12:15], 0
    buffer_load_dwordx4 v[200:203], v4, s[8:11], s30 offen offset:2048 sc1
    v_mfma_f32_16x16x32_bf16 v[48:51], v[204:207], a[16:19], v[48:51]
    s_add_u32 s35, s34, 12288
    v_mfma_f32_16x16x32_bf16 v[52:55], v[204:207], a[20:23], v[52:55]
    v_cvt_pk_bf16_f32 v96, v64, v65
    v_mfma_f32_16x16x32_bf16 v[56:59], v[204:207], a[24:27], v[56:59]
    v_mfma_f32_16x16x32_bf16 v[60:63], v[204:207], a[28:31], v[60:63]
    buffer_load_dwordx4 v[204:207], v4, s[8:11], s30 offen offset:3072 sc1
    v_cvt_pk_bf16_f32 v97, v66, v67
    s_waitcnt vmcnt(32)
    v_mfma_f32_16x16x32_bf16 v[48:51], v[208:211], a[32:35], v[48:51]
    v_mfma_f32_16x16x32_bf16 v[52:55], v[208:211], a[36:39], v[52:55]
    v_cvt_pk_bf16_f32 v98, v68, v69
    v_mfma_f32_16x16x32_bf16 v[56:59], v[208:211], a[40:43], v[56:59]
    v_mfma_f32_16x16x32_bf16 v[60:63], v[208:211], a[44:47], v[60:63]
    s_add_u32 s30, s31, 90112
    buffer_load_dwordx4 v[208:211], v4, s[8:11], s30 offen offset:0 sc1
    v_cvt_pk_bf16_f32 v99, v70, v71
    v_mfma_f32_16x16x32_bf16 v[48:51], v[212:215], a[48:51], v[48:51]
    v_mfma_f32_16x16x32_bf16 v[52:55], v[212:215], a[52:55], v[52:55]
    buffer_store_dwordx4 v[96:99], v4, s[8:11], s35 offen offset:0 sc1
    v_mfma_f32_16x16x32_bf16 v[56:59], v[212:215], a[56:59], v[56:59]
    v_mfma_f32_16x16x32_bf16 v[60:63], v[212:215], a[60:63], v[60:63]
    buffer_load_dwordx4 v[212:215], v4, s[8:11], s30 offen offset:1024 sc1
    ds_write_b128 v14, v[96:99] offset:12288
    s_waitcnt vmcnt(33)
    v_mfma_f32_16x16x32_bf16 v[48:51], v[216:219], a[64:67], v[48:51]
    v_cvt_pk_bf16_f32 v100, v72, v73
    v_mfma_f32_16x16x32_bf16 v[52:55], v[216:219], a[68:71], v[52:55]
    v_mfma_f32_16x16x32_bf16 v[56:59], v[216:219], a[72:75], v[56:59]
    v_cvt_pk_bf16_f32 v101, v74, v75
    v_mfma_f32_16x16x32_bf16 v[60:63], v[216:219], a[76:79], v[60:63]
    s_add_u32 s30, s31, 129024
    buffer_load_dwordx4 v[216:219], v4, s[8:11], s30 offen offset:0 sc1
    v_mfma_f32_16x16x32_bf16 v[48:51], v[220:223], a[80:83], v[48:51]
    v_cvt_pk_bf16_f32 v102, v76, v77
    v_mfma_f32_16x16x32_bf16 v[52:55], v[220:223], a[84:87], v[52:55]
    v_mfma_f32_16x16x32_bf16 v[56:59], v[220:223], a[88:91], v[56:59]
    v_cvt_pk_bf16_f32 v103, v78, v79
    v_mfma_f32_16x16x32_bf16 v[60:63], v[220:223], a[92:95], v[60:63]
    buffer_load_dwordx4 v[220:223], v4, s[8:11], s30 offen offset:1024 sc1
    s_waitcnt vmcnt(33)
    v_mfma_f32_16x16x32_bf16 v[48:51], v[224:227], a[96:99], v[48:51]
    buffer_store_dwordx4 v[100:103], v4, s[8:11], s35 offen offset:1024 sc1
    v_mfma_f32_16x16x32_bf16 v[52:55], v[224:227], a[100:103], v[52:55]
    v_mfma_f32_16x16x32_bf16 v[56:59], v[224:227], a[104:107], v[56:59]
    ds_write_b128 v14, v[100:103] offset:13312
    v_mfma_f32_16x16x32_bf16 v[60:63], v[224:227], a[108:111], v[60:63]
    buffer_load_dwordx4 v[224:227], v4, s[8:11], s30 offen offset:2048 sc1
    v_mfma_f32_16x16x32_bf16 v[48:51], v[228:231], a[112:115], v[48:51]
    v_mfma_f32_16x16x32_bf16 v[52:55], v[228:231], a[116:119], v[52:55]
    v_mfma_f32_16x16x32_bf16 v[56:59], v[228:231], a[120:123], v[56:59]
    v_mfma_f32_16x16x32_bf16 v[60:63], v[228:231], a[124:127], v[60:63]
    buffer_load_dwordx4 v[228:231], v4, s[8:11], s30 offen offset:3072 sc1
    s_waitcnt vmcnt(34)
    v_mfma_f32_16x16x32_bf16 v[48:51], v[104:107], a[128:131], v[48:51]
    v_mfma_f32_16x16x32_bf16 v[52:55], v[104:107], a[132:135], v[52:55]
    v_mfma_f32_16x16x32_bf16 v[56:59], v[104:107], a[136:139], v[56:59]
    v_mfma_f32_16x16x32_bf16 v[60:63], v[104:107], a[140:143], v[60:63]
    s_add_u32 s30, s31, 133120
    buffer_load_dwordx4 v[104:107], v4, s[8:11], s30 offen offset:0 sc1
    v_mfma_f32_16x16x32_bf16 v[48:51], v[108:111], a[144:147], v[48:51]
    v_mfma_f32_16x16x32_bf16 v[52:55], v[108:111], a[148:151], v[52:55]
    v_mfma_f32_16x16x32_bf16 v[56:59], v[108:111], a[152:155], v[56:59]
    v_mfma_f32_16x16x32_bf16 v[60:63], v[108:111], a[156:159], v[60:63]
    buffer_load_dwordx4 v[108:111], v4, s[8:11], s30 offen offset:1024 sc1
    s_waitcnt vmcnt(34)
    v_mfma_f32_16x16x32_bf16 v[48:51], v[112:115], a[160:163], v[48:51]
    v_mfma_f32_16x16x32_bf16 v[52:55], v[112:115], a[164:167], v[52:55]
    v_mfma_f32_16x16x32_bf16 v[56:59], v[112:115], a[168:171], v[56:59]
    v_mfma_f32_16x16x32_bf16 v[60:63], v[112:115], a[172:175], v[60:63]
    buffer_load_dwordx4 v[112:115], v4, s[8:11], s30 offen offset:2048 sc1
    v_mfma_f32_16x16x32_bf16 v[48:51], v[116:119], a[176:179], v[48:51]
    v_mfma_f32_16x16x32_bf16 v[52:55], v[116:119], a[180:183], v[52:55]
    v_mfma_f32_16x16x32_bf16 v[56:59], v[116:119], a[184:187], v[56:59]
    v_mfma_f32_16x16x32_bf16 v[60:63], v[116:119], a[188:191], v[60:63]
    buffer_load_dwordx4 v[116:119], v4, s[8:11], s30 offen offset:3072 sc1
    s_waitcnt vmcnt(34)
    v_mfma_f32_16x16x32_bf16 v[48:51], v[120:123], a[192:195], v[48:51]
    v_mfma_f32_16x16x32_bf16 v[52:55], v[120:123], a[196:199], v[52:55]
    v_mfma_f32_16x16x32_bf16 v[56:59], v[120:123], a[200:203], v[56:59]
    v_mfma_f32_16x16x32_bf16 v[60:63], v[120:123], a[204:207], v[60:63]
    s_add_u32 s30, s31, 137216
    buffer_load_dwordx4 v[120:123], v4, s[8:11], s30 offen offset:0 sc1
    v_mfma_f32_16x16x32_bf16 v[48:51], v[124:127], a[208:211], v[48:51]
    v_mfma_f32_16x16x32_bf16 v[52:55], v[124:127], a[212:215], v[52:55]
    v_mfma_f32_16x16x32_bf16 v[56:59], v[124:127], a[216:219], v[56:59]
    v_mfma_f32_16x16x32_bf16 v[60:63], v[124:127], a[220:223], v[60:63]
    buffer_load_dwordx4 v[124:127], v4, s[8:11], s30 offen offset:1024 sc1
    s_waitcnt vmcnt(34)
    v_mfma_f32_16x16x32_bf16 v[48:51], v[128:131], a[224:227], v[48:51]
    v_mfma_f32_16x16x32_bf16 v[52:55], v[128:131], a[228:231], v[52:55]
    v_mfma_f32_16x16x32_bf16 v[56:59], v[128:131], a[232:235], v[56:59]
    v_mfma_f32_16x16x32_bf16 v[60:63], v[128:131], a[236:239], v[60:63]
    buffer_load_dwordx4 v[128:131], v4, s[8:11], s30 offen offset:2048 sc1
    v_mfma_f32_16x16x32_bf16 v[48:51], v[132:135], a[240:243], v[48:51]
    v_mfma_f32_16x16x32_bf16 v[52:55], v[132:135], a[244:247], v[52:55]
    v_mfma_f32_16x16x32_bf16 v[56:59], v[132:135], a[248:251], v[56:59]
    v_mfma_f32_16x16x32_bf16 v[60:63], v[132:135], a[252:255], v[60:63]
    buffer_load_dwordx4 v[132:135], v4, s[8:11], s30 offen offset:3072 sc1
    s_waitcnt vmcnt(33)
    v_mfma_f32_16x16x32_bf16 v[48:51], v[136:139], v[16:19], v[48:51]
    v_mfma_f32_16x16x32_bf16 v[52:55], v[136:139], v[20:23], v[52:55]
    v_mfma_f32_16x16x32_bf16 v[56:59], v[136:139], v[24:27], v[56:59]
    v_mfma_f32_16x16x32_bf16 v[60:63], v[136:139], v[28:31], v[60:63]
    s_add_u32 s30, s31, 141312
    buffer_load_dwordx4 v[136:139], v4, s[8:11], s30 offen offset:0 sc1
    v_mfma_f32_16x16x32_bf16 v[64:67], v[140:143], v[32:35], v[48:51]
    v_mfma_f32_16x16x32_bf16 v[68:71], v[140:143], v[36:39], v[52:55]
    v_mfma_f32_16x16x32_bf16 v[72:75], v[140:143], v[40:43], v[56:59]
    v_mfma_f32_16x16x32_bf16 v[76:79], v[140:143], v[44:47], v[60:63]
    buffer_load_dwordx4 v[140:143], v4, s[8:11], s30 offen offset:1024 sc1
    s_waitcnt vmcnt(33)
    v_mfma_f32_16x16x32_bf16 v[48:51], v[144:147], a[0:3], 0
    v_mfma_f32_16x16x32_bf16 v[52:55], v[144:147], a[4:7], 0
    v_mfma_f32_16x16x32_bf16 v[56:59], v[144:147], a[8:11], 0
    v_mfma_f32_16x16x32_bf16 v[60:63], v[144:147], a[12:15], 0
    buffer_load_dwordx4 v[144:147], v4, s[8:11], s30 offen offset:2048 sc1
    s_waitcnt vmcnt(13)
    s_mov_b64 exec, 1
    buffer_store_dword v250, v251, s[8:11], s44 offen offset:0 sc1
    s_mov_b64 exec, -1
    v_mfma_f32_16x16x32_bf16 v[48:51], v[148:151], a[16:19], v[48:51]
    s_add_u32 s35, s34, 2048
    v_mfma_f32_16x16x32_bf16 v[52:55], v[148:151], a[20:23], v[52:55]
    v_cvt_pk_bf16_f32 v96, v64, v65
    v_mfma_f32_16x16x32_bf16 v[56:59], v[148:151], a[24:27], v[56:59]
    v_mfma_f32_16x16x32_bf16 v[60:63], v[148:151], a[28:31], v[60:63]
    buffer_load_dwordx4 v[148:151], v4, s[8:11], s30 offen offset:3072 sc1
    v_cvt_pk_bf16_f32 v97, v66, v67
    v_mfma_f32_16x16x32_bf16 v[48:51], v[152:155], a[32:35], v[48:51]
    v_mfma_f32_16x16x32_bf16 v[52:55], v[152:155], a[36:39], v[52:55]
    v_cvt_pk_bf16_f32 v98, v68, v69
    v_mfma_f32_16x16x32_bf16 v[56:59], v[152:155], a[40:43], v[56:59]
    v_mfma_f32_16x16x32_bf16 v[60:63], v[152:155], a[44:47], v[60:63]
    s_add_u32 s30, s31, 145408
    buffer_load_dwordx4 v[152:155], v4, s[8:11], s30 offen offset:0 sc1
    v_cvt_pk_bf16_f32 v99, v70, v71
    v_mfma_f32_16x16x32_bf16 v[48:51], v[156:159], a[48:51], v[48:51]
    v_mfma_f32_16x16x32_bf16 v[52:55], v[156:159], a[52:55], v[52:55]
    buffer_store_dwordx4 v[96:99], v4, s[8:11], s35 offen offset:0 sc1
    v_mfma_f32_16x16x32_bf16 v[56:59], v[156:159], a[56:59], v[56:59]
    v_mfma_f32_16x16x32_bf16 v[60:63], v[156:159], a[60:63], v[60:63]
    buffer_load_dwordx4 v[156:159], v4, s[8:11], s30 offen offset:1024 sc1
    ds_write_b128 v14, v[96:99] offset:2048
    v_mfma_f32_16x16x32_bf16 v[48:51], v[160:163], a[64:67], v[48:51]
    v_cvt_pk_bf16_f32 v100, v72, v73
    v_mfma_f32_16x16x32_bf16 v[52:55], v[160:163], a[68:71], v[52:55]
    v_mfma_f32_16x16x32_bf16 v[56:59], v[160:163], a[72:75], v[56:59]
    v_cvt_pk_bf16_f32 v101, v74, v75
    v_mfma_f32_16x16x32_bf16 v[60:63], v[160:163], a[76:79], v[60:63]
    s_add_u32 s30, s31, 36864
    buffer_load_dwordx4 v[160:163], v4, s[8:11], s30 offen offset:0 sc1
    v_mfma_f32_16x16x32_bf16 v[48:51], v[164:167], a[80:83], v[48:51]
    v_cvt_pk_bf16_f32 v102, v76, v77
    v_mfma_f32_16x16x32_bf16 v[52:55], v[164:167], a[84:87], v[52:55]
    v_mfma_f32_16x16x32_bf16 v[56:59], v[164:167], a[88:91], v[56:59]
    v_cvt_pk_bf16_f32 v103, v78, v79
    v_mfma_f32_16x16x32_bf16 v[60:63], v[164:167], a[92:95], v[60:63]
    buffer_load_dwordx4 v[164:167], v4, s[8:11], s30 offen offset:1024 sc1
    v_mfma_f32_16x16x32_bf16 v[48:51], v[168:171], a[96:99], v[48:51]
    buffer_store_dwordx4 v[100:103], v4, s[8:11], s35 offen offset:1024 sc1
    v_mfma_f32_16x16x32_bf16 v[52:55], v[168:171], a[100:103], v[52:55]
    v_mfma_f32_16x16x32_bf16 v[56:59], v[168:171], a[104:107], v[56:59]
    ds_write_b128 v14, v[100:103] offset:3072
    v_mfma_f32_16x16x32_bf16 v[60:63], v[168:171], a[108:111], v[60:63]
    buffer_load_dwordx4 v[168:171], v4, s[8:11], s30 offen offset:2048 sc1
    v_mfma_f32_16x16x32_bf16 v[48:51], v[172:175], a[112:115], v[48:51]
    v_mfma_f32_16x16x32_bf16 v[52:55], v[172:175], a[116:119], v[52:55]
    v_mfma_f32_16x16x32_bf16 v[56:59], v[172:175], a[120:123], v[56:59]
    v_mfma_f32_16x16x32_bf16 v[60:63], v[172:175], a[124:127], v[60:63]
    buffer_load_dwordx4 v[172:175], v4, s[8:11], s30 offen offset:3072 sc1
    v_mfma_f32_16x16x32_bf16 v[48:51], v[176:179], a[128:131], v[48:51]
    v_mfma_f32_16x16x32_bf16 v[52:55], v[176:179], a[132:135], v[52:55]
    v_mfma_f32_16x16x32_bf16 v[56:59], v[176:179], a[136:139], v[56:59]
    v_mfma_f32_16x16x32_bf16 v[60:63], v[176:179], a[140:143], v[60:63]
    s_add_u32 s30, s31, 40960
    buffer_load_dwordx4 v[176:179], v4, s[8:11], s30 offen offset:0 sc1
    v_mfma_f32_16x16x32_bf16 v[48:51], v[180:183], a[144:147], v[48:51]
    v_mfma_f32_16x16x32_bf16 v[52:55], v[180:183], a[148:151], v[52:55]
    v_mfma_f32_16x16x32_bf16 v[56:59], v[180:183], a[152:155], v[56:59]
    v_mfma_f32_16x16x32_bf16 v[60:63], v[180:183], a[156:159], v[60:63]
    buffer_load_dwordx4 v[180:183], v4, s[8:11], s30 offen offset:1024 sc1
    v_mfma_f32_16x16x32_bf16 v[48:51], v[184:187], a[160:163], v[48:51]
    v_mfma_f32_16x16x32_bf16 v[52:55], v[184:187], a[164:167], v[52:55]
    v_mfma_f32_16x16x32_bf16 v[56:59], v[184:187], a[168:171], v[56:59]
    v_mfma_f32_16x16x32_bf16 v[60:63], v[184:187], a[172:175], v[60:63]
    buffer_load_dwordx4 v[184:187], v4, s[8:11], s30 offen offset:2048 sc1
    v_mfma_f32_16x16x32_bf16 v[48:51], v[188:191], a[176:179], v[48:51]
    v_mfma_f32_16x16x32_bf16 v[52:55], v[188:191], a[180:183], v[52:55]
    v_mfma_f32_16x16x32_bf16 v[56:59], v[188:191], a[184:187], v[56:59]
    v_mfma_f32_16x16x32_bf16 v[60:63], v[188:191], a[188:191], v[60:63]
    buffer_load_dwordx4 v[188:191], v4, s[8:11], s30 offen offset:3072 sc1
    v_mfma_f32_16x16x32_bf16 v[48:51], v[192:195], a[192:195], v[48:51]
    v_mfma_f32_16x16x32_bf16 v[52:55], v[192:195], a[196:199], v[52:55]
    v_mfma_f32_16x16x32_bf16 v[56:59], v[192:195], a[200:203], v[56:59]
    v_mfma_f32_16x16x32_bf16 v[60:63], v[192:195], a[204:207], v[60:63]
    s_add_u32 s30, s31, 45056
    buffer_load_dwordx4 v[192:195], v4, s[8:11], s30 offen offset:0 sc1
    v_mfma_f32_16x16x32_bf16 v[48:51], v[196:199], a[208:211], v[48:51]
    v_mfma_f32_16x16x32_bf16 v[52:55], v[196:199], a[212:215], v[52:55]
    v_mfma_f32_16x16x32_bf16 v[56:59], v[196:199], a[216:219], v[56:59]
    v_mfma_f32_16x16x32_bf16 v[60:63], v[196:199], a[220:223], v[60:63]
    buffer_load_dwordx4 v[196:199], v4, s[8:11], s30 offen offset:1024 sc1
    v_mfma_f32_16x16x32_bf16 v[48:51], v[200:203], a[224:227], v[48:51]
    v_mfma_f32_16x16x32_bf16 v[52:55], v[200:203], a[228:231], v[52:55]
    v_mfma_f32_16x16x32_bf16 v[56:59], v[200:203], a[232:235], v[56:59]
    v_mfma_f32_16x16x32_bf16 v[60:63], v[200:203], a[236:239], v[60:63]
    buffer_load_dwordx4 v[200:203], v4, s[8:11], s30 offen offset:2048 sc1
    v_mfma_f32_16x16x32_bf16 v[48:51], v[204:207], a[240:243], v[48:51]
    v_mfma_f32_16x16x32_bf16 v[52:55], v[204:207], a[244:247], v[52:55]
    v_mfma_f32_16x16x32_bf16 v[56:59], v[204:207], a[248:251], v[56:59]
    v_mfma_f32_16x16x32_bf16 v[60:63], v[204:207], a[252:255], v[60:63]
    buffer_load_dwordx4 v[204:207], v4, s[8:11], s30 offen offset:3072 sc1
    v_mfma_f32_16x16x32_bf16 v[48:51], v[208:211], v[16:19], v[48:51]
    v_mfma_f32_16x16x32_bf16 v[52:55], v[208:211], v[20:23], v[52:55]
    v_mfma_f32_16x16x32_bf16 v[56:59], v[208:211], v[24:27], v[56:59]
    v_mfma_f32_16x16x32_bf16 v[60:63], v[208:211], v[28:31], v[60:63]
    s_add_u32 s30, s31, 49152
    buffer_load_dwordx4 v[208:211], v4, s[8:11], s30 offen offset:0 sc1
    v_mfma_f32_16x16x32_bf16 v[64:67], v[212:215], v[32:35], v[48:51]
    v_mfma_f32_16x16x32_bf16 v[68:71], v[212:215], v[36:39], v[52:55]
    v_mfma_f32_16x16x32_bf16 v[72:75], v[212:215], v[40:43], v[56:59]
    v_mfma_f32_16x16x32_bf16 v[76:79], v[212:215], v[44:47], v[60:63]
    buffer_load_dwordx4 v[212:215], v4, s[8:11], s30 offen offset:1024 sc1
    v_mfma_f32_16x16x32_bf16 v[48:51], v[216:219], a[0:3], 0
    v_mfma_f32_16x16x32_bf16 v[52:55], v[216:219], a[4:7], 0
    v_mfma_f32_16x16x32_bf16 v[56:59], v[216:219], a[8:11], 0
    v_mfma_f32_16x16x32_bf16 v[60:63], v[216:219], a[12:15], 0
    buffer_load_dwordx4 v[216:219], v4, s[8:11], s30 offen offset:2048 sc1
    v_mfma_f32_16x16x32_bf16 v[48:51], v[220:223], a[16:19], v[48:51]
    s_add_u32 s35, s34, 8192
    v_mfma_f32_16x16x32_bf16 v[52:55], v[220:223], a[20:23], v[52:55]
    v_cvt_pk_bf16_f32 v96, v64, v65
    v_mfma_f32_16x16x32_bf16 v[56:59], v[220:223], a[24:27], v[56:59]
    v_mfma_f32_16x16x32_bf16 v[60:63], v[220:223], a[28:31], v[60:63]
    buffer_load_dwordx4 v[220:223], v4, s[8:11], s30 offen offset:3072 sc1
    v_cvt_pk_bf16_f32 v97, v66, v67
    s_waitcnt vmcnt(33)
    v_mfma_f32_16x16x32_bf16 v[48:51], v[224:227], a[32:35], v[48:51]
    v_mfma_f32_16x16x32_bf16 v[52:55], v[224:227], a[36:39], v[52:55]
    v_cvt_pk_bf16_f32 v98, v68, v69
    v_mfma_f32_16x16x32_bf16 v[56:59], v[224:227], a[40:43], v[56:59]
    v_mfma_f32_16x16x32_bf16 v[60:63], v[224:227], a[44:47], v[60:63]
    s_add_u32 s30, s31, 53248
    buffer_load_dwordx4 v[224:227], v4, s[8:11], s30 offen offset:0 sc1
    v_cvt_pk_bf16_f32 v99, v70, v71
    v_mfma_f32_16x16x32_bf16 v[48:51], v[228:231], a[48:51], v[48:51]
    v_mfma_f32_16x16x32_bf16 v[52:55], v[228:231], a[52:55], v[52:55]
    buffer_store_dwordx4 v[96:99], v4, s[8:11], s35 offen offset:0 sc1
    v_mfma_f32_16x16x32_bf16 v[56:59], v[228:231], a[56:59], v[56:59]
    v_mfma_f32_16x16x32_bf16 v[60:63], v[228:231], a[60:63], v[60:63]
    buffer_load_dwordx4 v[228:231], v4, s[8:11], s30 offen offset:1024 sc1
    ds_write_b128 v14, v[96:99] offset:8192
    s_waitcnt vmcnt(34)
    v_mfma_f32_16x16x32_bf16 v[48:51], v[104:107], a[64:67], v[48:51]
    v_cvt_pk_bf16_f32 v100, v72, v73
    v_mfma_f32_16x16x32_bf16 v[52:55], v[104:107], a[68:71], v[52:55]
    v_mfma_f32_16x16x32_bf16 v[56:59], v[104:107], a[72:75], v[56:59]
    v_cvt_pk_bf16_f32 v101, v74, v75
    v_mfma_f32_16x16x32_bf16 v[60:63], v[104:107], a[76:79], v[60:63]
    s_add_u32 s30, s31, 92160
    buffer_load_dwordx4 v[104:107], v4, s[8:11], s30 offen offset:0 sc1
    v_mfma_f32_16x16x32_bf16 v[48:51], v[108:111], a[80:83], v[48:51]
    v_cvt_pk_bf16_f32 v102, v76, v77
    v_mfma_f32_16x16x32_bf16 v[52:55], v[108:111], a[84:87], v[52:55]
    v_mfma_f32_16x16x32_bf16 v[56:59], v[108:111], a[88:91], v[56:59]
    v_cvt_pk_bf16_f32 v103, v78, v79
    v_mfma_f32_16x16x32_bf16 v[60:63], v[108:111], a[92:95], v[60:63]
    buffer_load_dwordx4 v[108:111], v4, s[8:11], s30 offen offset:1024 sc1
    s_waitcnt vmcnt(34)
    v_mfma_f32_16x16x32_bf16 v[48:51], v[112:115], a[96:99], v[48:51]
    buffer_store_dwordx4 v[100:103], v4, s[8:11], s35 offen offset:1024 sc1
    v_mfma_f32_16x16x32_bf16 v[52:55], v[112:115], a[100:103], v[52:55]
    v_mfma_f32_16x16x32_bf16 v[56:59], v[112:115], a[104:107], v[56:59]
    ds_write_b128 v14, v[100:103] offset:9216
    v_mfma_f32_16x16x32_bf16 v[60:63], v[112:115], a[108:111], v[60:63]
    buffer_load_dwordx4 v[112:115], v4, s[8:11], s30 offen offset:2048 sc1
    v_mfma_f32_16x16x32_bf16 v[48:51], v[116:119], a[112:115], v[48:51]
    v_mfma_f32_16x16x32_bf16 v[52:55], v[116:119], a[116:119], v[52:55]
    v_mfma_f32_16x16x32_bf16 v[56:59], v[116:119], a[120:123], v[56:59]
    v_mfma_f32_16x16x32_bf16 v[60:63], v[116:119], a[124:127], v[60:63]
    buffer_load_dwordx4 v[116:119], v4, s[8:11], s30 offen offset:3072 sc1
    s_waitcnt vmcnt(35)
    v_mfma_f32_16x16x32_bf16 v[48:51], v[120:123], a[128:131], v[48:51]
    v_mfma_f32_16x16x32_bf16 v[52:55], v[120:123], a[132:135], v[52:55]
    v_mfma_f32_16x16x32_bf16 v[56:59], v[120:123], a[136:139], v[56:59]
    v_mfma_f32_16x16x32_bf16 v[60:63], v[120:123], a[140:143], v[60:63]
    s_add_u32 s30, s31, 96256
    buffer_load_dwordx4 v[120:123], v4, s[8:11], s30 offen offset:0 sc1
    v_mfma_f32_16x16x32_bf16 v[48:51], v[124:127], a[144:147], v[48:51]
    v_mfma_f32_16x16x32_bf16 v[52:55], v[124:127], a[148:151], v[52:55]
    v_mfma_f32_16x16x32_bf16 v[56:59], v[124:127], a[152:155], v[56:59]
    v_mfma_f32_16x16x32_bf16 v[60:63], v[124:127], a[156:159], v[60:63]
    buffer_load_dwordx4 v[124:127], v4, s[8:11], s30 offen offset:1024 sc1
    s_waitcnt vmcnt(35)
    v_mfma_f32_16x16x32_bf16 v[48:51], v[128:131], a[160:163], v[48:51]
    v_mfma_f32_16x16x32_bf16 v[52:55], v[128:131], a[164:167], v[52:55]
    v_mfma_f32_16x16x32_bf16 v[56:59], v[128:131], a[168:171], v[56:59]
    v_mfma_f32_16x16x32_bf16 v[60:63], v[128:131], a[172:175], v[60:63]
    buffer_load_dwordx4 v[128:131], v4, s[8:11], s30 offen offset:2048 sc1
    v_mfma_f32_16x16x32_bf16 v[48:51], v[132:135], a[176:179], v[48:51]
    v_mfma_f32_16x16x32_bf16 v[52:55], v[132:135], a[180:183], v[52:55]
    v_mfma_f32_16x16x32_bf16 v[56:59], v[132:135], a[184:187], v[56:59]
    v_mfma_f32_16x16x32_bf16 v[60:63], v[132:135], a[188:191], v[60:63]
    buffer_load_dwordx4 v[132:135], v4, s[8:11], s30 offen offset:3072 sc1
    s_waitcnt vmcnt(35)
    v_mfma_f32_16x16x32_bf16 v[48:51], v[136:139], a[192:195], v[48:51]
    v_mfma_f32_16x16x32_bf16 v[52:55], v[136:139], a[196:199], v[52:55]
    v_mfma_f32_16x16x32_bf16 v[56:59], v[136:139], a[200:203], v[56:59]
    v_mfma_f32_16x16x32_bf16 v[60:63], v[136:139], a[204:207], v[60:63]
    s_add_u32 s30, s31, 100352
    buffer_load_dwordx4 v[136:139], v4, s[8:11], s30 offen offset:0 sc1
    v_mfma_f32_16x16x32_bf16 v[48:51], v[140:143], a[208:211], v[48:51]
    v_mfma_f32_16x16x32_bf16 v[52:55], v[140:143], a[212:215], v[52:55]
    v_mfma_f32_16x16x32_bf16 v[56:59], v[140:143], a[216:219], v[56:59]
    v_mfma_f32_16x16x32_bf16 v[60:63], v[140:143], a[220:223], v[60:63]
    buffer_load_dwordx4 v[140:143], v4, s[8:11], s30 offen offset:1024 sc1
    s_waitcnt vmcnt(34)
    v_mfma_f32_16x16x32_bf16 v[48:51], v[144:147], a[224:227], v[48:51]
    v_mfma_f32_16x16x32_bf16 v[52:55], v[144:147], a[228:231], v[52:55]
    v_mfma_f32_16x16x32_bf16 v[56:59], v[144:147], a[232:235], v[56:59]
    v_mfma_f32_16x16x32_bf16 v[60:63], v[144:147], a[236:239], v[60:63]
    buffer_load_dwordx4 v[144:147], v4, s[8:11], s30 offen offset:2048 sc1
    v_mfma_f32_16x16x32_bf16 v[48:51], v[148:151], a[240:243], v[48:51]
    v_mfma_f32_16x16x32_bf16 v[52:55], v[148:151], a[244:247], v[52:55]
    v_mfma_f32_16x16x32_bf16 v[56:59], v[148:151], a[248:251], v[56:59]
    v_mfma_f32_16x16x32_bf16 v[60:63], v[148:151], a[252:255], v[60:63]
    buffer_load_dwordx4 v[148:151], v4, s[8:11], s30 offen offset:3072 sc1
    s_waitcnt vmcnt(33)
    v_mfma_f32_16x16x32_bf16 v[48:51], v[152:155], v[16:19], v[48:51]
    v_mfma_f32_16x16x32_bf16 v[52:55], v[152:155], v[20:23], v[52:55]
    v_mfma_f32_16x16x32_bf16 v[56:59], v[152:155], v[24:27], v[56:59]
    v_mfma_f32_16x16x32_bf16 v[60:63], v[152:155], v[28:31], v[60:63]
    s_add_u32 s30, s31, 104448
    buffer_load_dwordx4 v[152:155], v4, s[8:11], s30 offen offset:0 sc1
    v_mfma_f32_16x16x32_bf16 v[64:67], v[156:159], v[32:35], v[48:51]
    v_mfma_f32_16x16x32_bf16 v[68:71], v[156:159], v[36:39], v[52:55]
    v_mfma_f32_16x16x32_bf16 v[72:75], v[156:159], v[40:43], v[56:59]
    v_mfma_f32_16x16x32_bf16 v[76:79], v[156:159], v[44:47], v[60:63]
    buffer_load_dwordx4 v[156:159], v4, s[8:11], s30 offen offset:1024 sc1
    s_waitcnt vmcnt(33)
    v_mfma_f32_16x16x32_bf16 v[48:51], v[160:163], a[0:3], 0
    v_mfma_f32_16x16x32_bf16 v[52:55], v[160:163], a[4:7], 0
    v_mfma_f32_16x16x32_bf16 v[56:59], v[160:163], a[8:11], 0
    v_mfma_f32_16x16x32_bf16 v[60:63], v[160:163], a[12:15], 0
    buffer_load_dwordx4 v[160:163], v4, s[8:11], s30 offen offset:2048 sc1
    v_mfma_f32_16x16x32_bf16 v[48:51], v[164:167], a[16:19], v[48:51]
    s_add_u32 s35, s34, 14336
    v_mfma_f32_16x16x32_bf16 v[52:55], v[164:167], a[20:23], v[52:55]
    v_cvt_pk_bf16_f32 v96, v64, v65
    v_mfma_f32_16x16x32_bf16 v[56:59], v[164:167], a[24:27], v[56:59]
    v_mfma_f32_16x16x32_bf16 v[60:63], v[164:167], a[28:31], v[60:63]
    buffer_load_dwordx4 v[164:167], v4, s[8:11], s30 offen offset:3072 sc1
    v_cvt_pk_bf16_f32 v97, v66, v67
    s_waitcnt vmcnt(32)
    v_mfma_f32_16x16x32_bf16 v[48:51], v[168:171], a[32:35], v[48:51]
    v_mfma_f32_16x16x32_bf16 v[52:55], v[168:171], a[36:39], v[52:55]
    v_cvt_pk_bf16_f32 v98, v68, v69
    v_mfma_f32_16x16x32_bf16 v[56:59], v[168:171], a[40:43], v[56:59]
    v_mfma_f32_16x16x32_bf16 v[60:63], v[168:171], a[44:47], v[60:63]
    s_add_u32 s30, s31, 108544
    buffer_load_dwordx4 v[168:171], v4, s[8:11], s30 offen offset:0 sc1
    v_cvt_pk_bf16_f32 v99, v70, v71
    v_mfma_f32_16x16x32_bf16 v[48:51], v[172:175], a[48:51], v[48:51]
    v_mfma_f32_16x16x32_bf16 v[52:55], v[172:175], a[52:55], v[52:55]
    buffer_store_dwordx4 v[96:99], v4, s[8:11], s35 offen offset:0 sc1
    v_mfma_f32_16x16x32_bf16 v[56:59], v[172:175], a[56:59], v[56:59]
    v_mfma_f32_16x16x32_bf16 v[60:63], v[172:175], a[60:63], v[60:63]
    buffer_load_dwordx4 v[172:175], v4, s[8:11], s30 offen offset:1024 sc1
    ds_write_b128 v14, v[96:99] offset:14336
    s_waitcnt vmcnt(33)
    v_mfma_f32_16x16x32_bf16 v[48:51], v[176:179], a[64:67], v[48:51]
    v_cvt_pk_bf16_f32 v100, v72, v73
    v_mfma_f32_16x16x32_bf16 v[52:55], v[176:179], a[68:71], v[52:55]
    v_mfma_f32_16x16x32_bf16 v[56:59], v[176:179], a[72:75], v[56:59]
    v_cvt_pk_bf16_f32 v101, v74, v75
    v_mfma_f32_16x16x32_bf16 v[60:63], v[176:179], a[76:79], v[60:63]
    s_add_u32 s30, s31, 147456
    buffer_load_dwordx4 v[176:179], v4, s[8:11], s30 offen offset:0 sc1
    v_mfma_f32_16x16x32_bf16 v[48:51], v[180:183], a[80:83], v[48:51]
    v_cvt_pk_bf16_f32 v102, v76, v77
    v_mfma_f32_16x16x32_bf16 v[52:55], v[180:183], a[84:87], v[52:55]
    v_mfma_f32_16x16x32_bf16 v[56:59], v[180:183], a[88:91], v[56:59]
    v_cvt_pk_bf16_f32 v103, v78, v79
    v_mfma_f32_16x16x32_bf16 v[60:63], v[180:183], a[92:95], v[60:63]
    buffer_load_dwordx4 v[180:183], v4, s[8:11], s30 offen offset:1024 sc1
    s_waitcnt vmcnt(33)
    v_mfma_f32_16x16x32_bf16 v[48:51], v[184:187], a[96:99], v[48:51]
    buffer_store_dwordx4 v[100:103], v4, s[8:11], s35 offen offset:1024 sc1
    v_mfma_f32_16x16x32_bf16 v[52:55], v[184:187], a[100:103], v[52:55]
    v_mfma_f32_16x16x32_bf16 v[56:59], v[184:187], a[104:107], v[56:59]
    ds_write_b128 v14, v[100:103] offset:15360
    v_mfma_f32_16x16x32_bf16 v[60:63], v[184:187], a[108:111], v[60:63]
    buffer_load_dwordx4 v[184:187], v4, s[8:11], s30 offen offset:2048 sc1
    v_mfma_f32_16x16x32_bf16 v[48:51], v[188:191], a[112:115], v[48:51]
    v_mfma_f32_16x16x32_bf16 v[52:55], v[188:191], a[116:119], v[52:55]
    v_mfma_f32_16x16x32_bf16 v[56:59], v[188:191], a[120:123], v[56:59]
    v_mfma_f32_16x16x32_bf16 v[60:63], v[188:191], a[124:127], v[60:63]
    buffer_load_dwordx4 v[188:191], v4, s[8:11], s30 offen offset:3072 sc1
    s_waitcnt vmcnt(34)
    v_mfma_f32_16x16x32_bf16 v[48:51], v[192:195], a[128:131], v[48:51]
    v_mfma_f32_16x16x32_bf16 v[52:55], v[192:195], a[132:135], v[52:55]
    v_mfma_f32_16x16x32_bf16 v[56:59], v[192:195], a[136:139], v[56:59]
    v_mfma_f32_16x16x32_bf16 v[60:63], v[192:195], a[140:143], v[60:63]
    s_add_u32 s30, s31, 151552
    buffer_load_dwordx4 v[192:195], v4, s[8:11], s30 offen offset:0 sc1
    v_mfma_f32_16x16x32_bf16 v[48:51], v[196:199], a[144:147], v[48:51]
    v_mfma_f32_16x16x32_bf16 v[52:55], v[196:199], a[148:151], v[52:55]
    v_mfma_f32_16x16x32_bf16 v[56:59], v[196:199], a[152:155], v[56:59]
    v_mfma_f32_16x16x32_bf16 v[60:63], v[196:199], a[156:159], v[60:63]
    buffer_load_dwordx4 v[196:199], v4, s[8:11], s30 offen offset:1024 sc1
    buffer_load_dword v252, v247, s[8:11], s45 offen offset:0 sc1
    s_waitcnt vmcnt(35)
    v_mfma_f32_16x16x32_bf16 v[48:51], v[200:203], a[160:163], v[48:51]
    v_mfma_f32_16x16x32_bf16 v[52:55], v[200:203], a[164:167], v[52:55]
    v_mfma_f32_16x16x32_bf16 v[56:59], v[200:203], a[168:171], v[56:59]
    v_mfma_f32_16x16x32_bf16 v[60:63], v[200:203], a[172:175], v[60:63]
    buffer_load_dwordx4 v[200:203], v4, s[8:11], s30 offen offset:2048 sc1
    v_mfma_f32_16x16x32_bf16 v[48:51], v[204:207], a[176:179], v[48:51]
    v_mfma_f32_16x16x32_bf16 v[52:55], v[204:207], a[180:183], v[52:55]
    v_mfma_f32_16x16x32_bf16 v[56:59], v[204:207], a[184:187], v[56:59]
    v_mfma_f32_16x16x32_bf16 v[60:63], v[204:207], a[188:191], v[60:63]
    buffer_load_dwordx4 v[204:207], v4, s[8:11], s30 offen offset:3072 sc1
    s_waitcnt vmcnt(35)
    v_mfma_f32_16x16x32_bf16 v[48:51], v[208:211], a[192:195], v[48:51]
    v_mfma_f32_16x16x32_bf16 v[52:55], v[208:211], a[196:199], v[52:55]
    v_mfma_f32_16x16x32_bf16 v[56:59], v[208:211], a[200:203], v[56:59]
    v_mfma_f32_16x16x32_bf16 v[60:63], v[208:211], a[204:207], v[60:63]
    s_add_u32 s30, s31, 155648
    buffer_load_dwordx4 v[208:211], v4, s[8:11], s30 offen offset:0 sc1
    v_mfma_f32_16x16x32_bf16 v[48:51], v[212:215], a[208:211], v[48:51]
    v_mfma_f32_16x16x32_bf16 v[52:55], v[212:215], a[212:215], v[52:55]
    v_mfma_f32_16x16x32_bf16 v[56:59], v[212:215], a[216:219], v[56:59]
    v_mfma_f32_16x16x32_bf16 v[60:63], v[212:215], a[220:223], v[60:63]
    buffer_load_dwordx4 v[212:215], v4, s[8:11], s30 offen offset:1024 sc1
    s_waitcnt vmcnt(35)
    v_mfma_f32_16x16x32_bf16 v[48:51], v[216:219], a[224:227], v[48:51]
    v_mfma_f32_16x16x32_bf16 v[52:55], v[216:219], a[228:231], v[52:55]
    v_mfma_f32_16x16x32_bf16 v[56:59], v[216:219], a[232:235], v[56:59]
    v_mfma_f32_16x16x32_bf16 v[60:63], v[216:219], a[236:239], v[60:63]
    buffer_load_dwordx4 v[216:219], v4, s[8:11], s30 offen offset:2048 sc1
    v_mfma_f32_16x16x32_bf16 v[48:51], v[220:223], a[240:243], v[48:51]
    v_mfma_f32_16x16x32_bf16 v[52:55], v[220:223], a[244:247], v[52:55]
    v_mfma_f32_16x16x32_bf16 v[56:59], v[220:223], a[248:251], v[56:59]
    v_mfma_f32_16x16x32_bf16 v[60:63], v[220:223], a[252:255], v[60:63]
    buffer_load_dwordx4 v[220:223], v4, s[8:11], s30 offen offset:3072 sc1
    s_waitcnt vmcnt(34)
    v_mfma_f32_16x16x32_bf16 v[48:51], v[224:227], v[16:19], v[48:51]
    v_mfma_f32_16x16x32_bf16 v[52:55], v[224:227], v[20:23], v[52:55]
    v_mfma_f32_16x16x32_bf16 v[56:59], v[224:227], v[24:27], v[56:59]
    v_mfma_f32_16x16x32_bf16 v[60:63], v[224:227], v[28:31], v[60:63]
    s_add_u32 s30, s31, 159744
    buffer_load_dwordx4 v[224:227], v4, s[8:11], s30 offen offset:0 sc1
    v_mfma_f32_16x16x32_bf16 v[64:67], v[228:231], v[32:35], v[48:51]
    v_mfma_f32_16x16x32_bf16 v[68:71], v[228:231], v[36:39], v[52:55]
    v_mfma_f32_16x16x32_bf16 v[72:75], v[228:231], v[40:43], v[56:59]
    v_mfma_f32_16x16x32_bf16 v[76:79], v[228:231], v[44:47], v[60:63]
    buffer_load_dwordx4 v[228:231], v4, s[8:11], s30 offen offset:1024 sc1
    s_waitcnt vmcnt(8)
    v_cmp_ne_u32 vcc, 1, v252
    s_cbranch_vccz L_pd_39
    s_mov_b32 s47, 0x40000
L_poll_38:
    buffer_load_dword v252, v247, s[8:11], s45 offen offset:0 sc1
    s_waitcnt vmcnt(0)
    v_cmp_ne_u32 vcc, 1, v252
    s_cbranch_vccz L_pd_39
    s_sub_u32 s47, s47, 1
    s_cbranch_scc0 L_poll_38
L_pd_39:
    v_mfma_f32_16x16x32_bf16 v[48:51], v[104:107], a[0:3], 0
    v_mfma_f32_16x16x32_bf16 v[52:55], v[104:107], a[4:7], 0
    v_mfma_f32_16x16x32_bf16 v[56:59], v[104:107], a[8:11], 0
    v_mfma_f32_16x16x32_bf16 v[60:63], v[104:107], a[12:15], 0
    buffer_load_dwordx4 v[104:107], v4, s[8:11], s30 offen offset:2048 sc1
    s_mov_b64 exec, 1
    buffer_store_dword v250, v251, s[8:11], s44 offen offset:128 sc1
    s_mov_b64 exec, -1
    v_mfma_f32_16x16x32_bf16 v[48:51], v[108:111], a[16:19], v[48:51]
    s_add_u32 s35, s34, 4096
    v_mfma_f32_16x16x32_bf16 v[52:55], v[108:111], a[20:23], v[52:55]
    v_cvt_pk_bf16_f32 v96, v64, v65
    v_mfma_f32_16x16x32_bf16 v[56:59], v[108:111], a[24:27], v[56:59]
    v_mfma_f32_16x16x32_bf16 v[60:63], v[108:111], a[28:31], v[60:63]
    buffer_load_dwordx4 v[108:111], v4, s[8:11], s30 offen offset:3072 sc1
    v_cvt_pk_bf16_f32 v97, v66, v67
    v_mfma_f32_16x16x32_bf16 v[48:51], v[112:115], a[32:35], v[48:51]
    v_mfma_f32_16x16x32_bf16 v[52:55], v[112:115], a[36:39], v[52:55]
    v_cvt_pk_bf16_f32 v98, v68, v69
    v_mfma_f32_16x16x32_bf16 v[56:59], v[112:115], a[40:43], v[56:59]
    v_mfma_f32_16x16x32_bf16 v[60:63], v[112:115], a[44:47], v[60:63]
    s_add_u32 s30, s31, 163840
    buffer_load_dwordx4 v[112:115], v4, s[8:11], s30 offen offset:0 sc1
    v_cvt_pk_bf16_f32 v99, v70, v71
    v_mfma_f32_16x16x32_bf16 v[48:51], v[116:119], a[48:51], v[48:51]
    v_mfma_f32_16x16x32_bf16 v[52:55], v[116:119], a[52:55], v[52:55]
    buffer_store_dwordx4 v[96:99], v4, s[8:11], s35 offen offset:0 sc1
    v_mfma_f32_16x16x32_bf16 v[56:59], v[116:119], a[56:59], v[56:59]
    v_mfma_f32_16x16x32_bf16 v[60:63], v[116:119], a[60:63], v[60:63]
    buffer_load_dwordx4 v[116:119], v4, s[8:11], s30 offen offset:1024 sc1
    ds_write_b128 v14, v[96:99] offset:4096
    v_mfma_f32_16x16x32_bf16 v[48:51], v[120:123], a[64:67], v[48:51]
    v_cvt_pk_bf16_f32 v100, v72, v73
    v_mfma_f32_16x16x32_bf16 v[52:55], v[120:123], a[68:71], v[52:55]
    v_mfma_f32_16x16x32_bf16 v[56:59], v[120:123], a[72:75], v[56:59]
    v_cvt_pk_bf16_f32 v101, v74, v75
    v_mfma_f32_16x16x32_bf16 v[60:63], v[120:123], a[76:79], v[60:63]
    buffer_load_dwordx4 v[120:123], v4, s[48:51], s52 offen offset:0 sc1
    v_mfma_f32_16x16x32_bf16 v[48:51], v[124:127], a[80:83], v[48:51]
    v_cvt_pk_bf16_f32 v102, v76, v77
    v_mfma_f32_16x16x32_bf16 v[52:55], v[124:127], a[84:87], v[52:55]
    v_mfma_f32_16x16x32_bf16 v[56:59], v[124:127], a[88:91], v[56:59]
    v_cvt_pk_bf16_f32 v103, v78, v79
    v_mfma_f32_16x16x32_bf16 v[60:63], v[124:127], a[92:95], v[60:63]
    buffer_load_dwordx4 v[124:127], v4, s[48:51], s53 offen offset:0 sc1
    v_mfma_f32_16x16x32_bf16 v[48:51], v[128:131], a[96:99], v[48:51]
    buffer_store_dwordx4 v[100:103], v4, s[8:11], s35 offen offset:1024 sc1
    v_mfma_f32_16x16x32_bf16 v[52:55], v[128:131], a[100:103], v[52:55]
    v_mfma_f32_16x16x32_bf16 v[56:59], v[128:131], a[104:107], v[56:59]
    ds_write_b128 v14, v[100:103] offset:5120
    v_mfma_f32_16x16x32_bf16 v[60:63], v[128:131], a[108:111], v[60:63]
    buffer_load_dwordx4 v[128:131], v4, s[48:51], s54 offen offset:0 sc1
    v_mfma_f32_16x16x32_bf16 v[48:51], v[132:135], a[112:115], v[48:51]
    v_mfma_f32_16x16x32_bf16 v[52:55], v[132:135], a[116:119], v[52:55]
    v_mfma_f32_16x16x32_bf16 v[56:59], v[132:135], a[120:123], v[56:59]
    v_mfma_f32_16x16x32_bf16 v[60:63], v[132:135], a[124:127], v[60:63]
    buffer_load_dwordx4 v[132:135], v4, s[48:51], s55 offen offset:0 sc1
    v_mfma_f32_16x16x32_bf16 v[48:51], v[136:139], a[128:131], v[48:51]
    v_mfma_f32_16x16x32_bf16 v[52:55], v[136:139], a[132:135], v[52:55]
    v_mfma_f32_16x16x32_bf16 v[56:59], v[136:139], a[136:139], v[56:59]
    v_mfma_f32_16x16x32_bf16 v[60:63], v[136:139], a[140:143], v[60:63]
    buffer_load_dwordx4 v[136:139], v4, s[48:51], s56 offen offset:0 sc1
    v_mfma_f32_16x16x32_bf16 v[48:51], v[140:143], a[144:147], v[48:51]
    v_mfma_f32_16x16x32_bf16 v[52:55], v[140:143], a[148:151], v[52:55]
    v_mfma_f32_16x16x32_bf16 v[56:59], v[140:143], a[152:155], v[56:59]
    v_mfma_f32_16x16x32_bf16 v[60:63], v[140:143], a[156:159], v[60:63]
    buffer_load_dwordx4 v[140:143], v4, s[48:51], s57 offen offset:0 sc1
    v_mfma_f32_16x16x32_bf16 v[48:51], v[144:147], a[160:163], v[48:51]
    v_mfma_f32_16x16x32_bf16 v[52:55], v[144:147], a[164:167], v[52:55]
    v_mfma_f32_16x16x32_bf16 v[56:59], v[144:147], a[168:171], v[56:59]
    v_mfma_f32_16x16x32_bf16 v[60:63], v[144:147], a[172:175], v[60:63]
    buffer_load_dwordx4 v[144:147], v4, s[48:51], s58 offen offset:0 sc1
    v_mfma_f32_16x16x32_bf16 v[48:51], v[148:151], a[176:179], v[48:51]
    v_mfma_f32_16x16x32_bf16 v[52:55], v[148:151], a[180:183], v[52:55]
    v_mfma_f32_16x16x32_bf16 v[56:59], v[148:151], a[184:187], v[56:59]
    v_mfma_f32_16x16x32_bf16 v[60:63], v[148:151], a[188:191], v[60:63]
    v_mfma_f32_16x16x32_bf16 v[48:51], v[152:155], a[192:195], v[48:51]
    v_mfma_f32_16x16x32_bf16 v[52:55], v[152:155], a[196:199], v[52:55]
    v_mfma_f32_16x16x32_bf16 v[56:59], v[152:155], a[200:203], v[56:59]
    v_mfma_f32_16x16x32_bf16 v[60:63], v[152:155], a[204:207], v[60:63]
    v_mfma_f32_16x16x32_bf16 v[48:51], v[156:159], a[208:211], v[48:51]
    v_mfma_f32_16x16x32_bf16 v[52:55], v[156:159], a[212:215], v[52:55]
    v_mfma_f32_16x16x32_bf16 v[56:59], v[156:159], a[216:219], v[56:59]
    v_mfma_f32_16x16x32_bf16 v[60:63], v[156:159], a[220:223], v[60:63]
    buffer_load_dword v252, v247, s[8:11], s45 offen offset:128 sc1
    v_mfma_f32_16x16x32_bf16 v[48:51], v[160:163], a[224:227], v[48:51]
    v_mfma_f32_16x16x32_bf16 v[52:55], v[160:163], a[228:231], v[52:55]
    v_mfma_f32_16x16x32_bf16 v[56:59], v[160:163], a[232:235], v[56:59]
    v_mfma_f32_16x16x32_bf16 v[60:63], v[160:163], a[236:239], v[60:63]
    v_mfma_f32_16x16x32_bf16 v[48:51], v[164:167], a[240:243], v[48:51]
    v_mfma_f32_16x16x32_bf16 v[52:55], v[164:167], a[244:247], v[52:55]
    v_mfma_f32_16x16x32_bf16 v[56:59], v[164:167], a[248:251], v[56:59]
    v_mfma_f32_16x16x32_bf16 v[60:63], v[164:167], a[252:255], v[60:63]
    v_mfma_f32_16x16x32_bf16 v[48:51], v[168:171], v[16:19], v[48:51]
    v_mfma_f32_16x16x32_bf16 v[52:55], v[168:171], v[20:23], v[52:55]
    v_mfma_f32_16x16x32_bf16 v[56:59], v[168:171], v[24:27], v[56:59]
    v_mfma_f32_16x16x32_bf16 v[60:63], v[168:171], v[28:31], v[60:63]
    v_mfma_f32_16x16x32_bf16 v[64:67], v[172:175], v[32:35], v[48:51]
    v_mfma_f32_16x16x32_bf16 v[68:71], v[172:175], v[36:39], v[52:55]
    v_mfma_f32_16x16x32_bf16 v[72:75], v[172:175], v[40:43], v[56:59]
    v_mfma_f32_16x16x32_bf16 v[76:79], v[172:175], v[44:47], v[60:63]
    s_waitcnt vmcnt(0)
    v_cmp_ne_u32 vcc, 1, v252
    s_cbranch_vccz L_pd_41
    s_mov_b32 s47, 0x40000
L_poll_40:
    buffer_load_dword v252, v247, s[8:11], s45 offen offset:128 sc1
    s_waitcnt vmcnt(0)
    v_cmp_ne_u32 vcc, 1, v252
    s_cbranch_vccz L_pd_41
    s_sub_u32 s47, s47, 1
    s_cbranch_scc0 L_poll_40
L_pd_41:
    v_mfma_f32_16x16x32_bf16 v[48:51], v[176:179], a[0:3], 0
    v_mfma_f32_16x16x32_bf16 v[52:55], v[176:179], a[4:7], 0
    v_mfma_f32_16x16x32_bf16 v[56:59], v[176:179], a[8:11], 0
    v_mfma_f32_16x16x32_bf16 v[60:63], v[176:179], a[12:15], 0
    buffer_load_dwordx4 v[148:151], v4, s[48:51], s52 offen offset:2048 sc1
    v_mfma_f32_16x16x32_bf16 v[48:51], v[180:183], a[16:19], v[48:51]
    s_add_u32 s35, s34, 10240
    v_mfma_f32_16x16x32_bf16 v[52:55], v[180:183], a[20:23], v[52:55]
    v_cvt_pk_bf16_f32 v96, v64, v65
    v_mfma_f32_16x16x32_bf16 v[56:59], v[180:183], a[24:27], v[56:59]
    v_mfma_f32_16x16x32_bf16 v[60:63], v[180:183], a[28:31], v[60:63]
    v_cvt_pk_bf16_f32 v97, v66, v67
    v_mfma_f32_16x16x32_bf16 v[48:51], v[184:187], a[32:35], v[48:51]
    v_mfma_f32_16x16x32_bf16 v[52:55], v[184:187], a[36:39], v[52:55]
    v_cvt_pk_bf16_f32 v98, v68, v69
    v_mfma_f32_16x16x32_bf16 v[56:59], v[184:187], a[40:43], v[56:59]
    v_mfma_f32_16x16x32_bf16 v[60:63], v[184:187], a[44:47], v[60:63]
    buffer_load_dwordx4 v[152:155], v4, s[48:51], s53 offen offset:2048 sc1
    v_cvt_pk_bf16_f32 v99, v70, v71
    v_mfma_f32_16x16x32_bf16 v[48:51], v[188:191], a[48:51], v[48:51]
    v_mfma_f32_16x16x32_bf16 v[52:55], v[188:191], a[52:55], v[52:55]
    buffer_store_dwordx4 v[96:99], v4, s[8:11], s35 offen offset:0 sc1
    v_mfma_f32_16x16x32_bf16 v[56:59], v[188:191], a[56:59], v[56:59]
    v_mfma_f32_16x16x32_bf16 v[60:63], v[188:191], a[60:63], v[60:63]
    ds_write_b128 v14, v[96:99] offset:10240
    v_mfma_f32_16x16x32_bf16 v[48:51], v[192:195], a[64:67], v[48:51]
    v_cvt_pk_bf16_f32 v100, v72, v73
    v_mfma_f32_16x16x32_bf16 v[52:55], v[192:195], a[68:71], v[52:55]
    v_mfma_f32_16x16x32_bf16 v[56:59], v[192:195], a[72:75], v[56:59]
    v_cvt_pk_bf16_f32 v101, v74, v75
    v_mfma_f32_16x16x32_bf16 v[60:63], v[192:195], a[76:79], v[60:63]
    buffer_load_dwordx4 v[156:159], v4, s[48:51], s54 offen offset:2048 sc1
    v_mfma_f32_16x16x32_bf16 v[48:51], v[196:199], a[80:83], v[48:51]
    v_cvt_pk_bf16_f32 v102, v76, v77
    v_mfma_f32_16x16x32_bf16 v[52:55], v[196:199], a[84:87], v[52:55]
    v_mfma_f32_16x16x32_bf16 v[56:59], v[196:199], a[88:91], v[56:59]
    v_cvt_pk_bf16_f32 v103, v78, v79
    v_mfma_f32_16x16x32_bf16 v[60:63], v[196:199], a[92:95], v[60:63]
    v_mfma_f32_16x16x32_bf16 v[48:51], v[200:203], a[96:99], v[48:51]
    buffer_store_dwordx4 v[100:103], v4, s[8:11], s35 offen offset:1024 sc1
    v_mfma_f32_16x16x32_bf16 v[52:55], v[200:203], a[100:103], v[52:55]
    v_mfma_f32_16x16x32_bf16 v[56:59], v[200:203], a[104:107], v[56:59]
    ds_write_b128 v14, v[100:103] offset:11264
    v_mfma_f32_16x16x32_bf16 v[60:63], v[200:203], a[108:111], v[60:63]
    buffer_load_dwordx4 v[160:163], v4, s[48:51], s55 offen offset:2048 sc1
    v_mfma_f32_16x16x32_bf16 v[48:51], v[204:207], a[112:115], v[48:51]
    v_mfma_f32_16x16x32_bf16 v[52:55], v[204:207], a[116:119], v[52:55]
    v_mfma_f32_16x16x32_bf16 v[56:59], v[204:207], a[120:123], v[56:59]
    v_mfma_f32_16x16x32_bf16 v[60:63], v[204:207], a[124:127], v[60:63]
    v_mfma_f32_16x16x32_bf16 v[48:51], v[208:211], a[128:131], v[48:51]
    v_mfma_f32_16x16x32_bf16 v[52:55], v[208:211], a[132:135], v[52:55]
    v_mfma_f32_16x16x32_bf16 v[56:59], v[208:211], a[136:139], v[56:59]
    v_mfma_f32_16x16x32_bf16 v[60:63], v[208:211], a[140:143], v[60:63]
    buffer_load_dwordx4 v[164:167], v4, s[48:51], s56 offen offset:2048 sc1
    v_mfma_f32_16x16x32_bf16 v[48:51], v[212:215], a[144:147], v[48:51]
    v_mfma_f32_16x16x32_bf16 v[52:55], v[212:215], a[148:151], v[52:55]
    v_mfma_f32_16x16x32_bf16 v[56:59], v[212:215], a[152:155], v[56:59]
    v_mfma_f32_16x16x32_bf16 v[60:63], v[212:215], a[156:159], v[60:63]
    v_mfma_f32_16x16x32_bf16 v[48:51], v[216:219], a[160:163], v[48:51]
    v_mfma_f32_16x16x32_bf16 v[52:55], v[216:219], a[164:167], v[52:55]
    v_mfma_f32_16x16x32_bf16 v[56:59], v[216:219], a[168:171], v[56:59]
    v_mfma_f32_16x16x32_bf16 v[60:63], v[216:219], a[172:175], v[60:63]
    buffer_load_dwordx4 v[168:171], v4, s[48:51], s57 offen offset:2048 sc1
    v_mfma_f32_16x16x32_bf16 v[48:51], v[220:223], a[176:179], v[48:51]
    v_mfma_f32_16x16x32_bf16 v[52:55], v[220:223], a[180:183], v[52:55]
    v_mfma_f32_16x16x32_bf16 v[56:59], v[220:223], a[184:187], v[56:59]
    v_mfma_f32_16x16x32_bf16 v[60:63], v[220:223], a[188:191], v[60:63]
    v_mfma_f32_16x16x32_bf16 v[48:51], v[224:227], a[192:195], v[48:51]
    v_mfma_f32_16x16x32_bf16 v[52:55], v[224:227], a[196:199], v[52:55]
    v_mfma_f32_16x16x32_bf16 v[56:59], v[224:227], a[200:203], v[56:59]
    v_mfma_f32_16x16x32_bf16 v[60:63], v[224:227], a[204:207], v[60:63]
    buffer_load_dwordx4 v[172:175], v4, s[48:51], s58 offen offset:2048 sc1
    v_mfma_f32_16x16x32_bf16 v[48:51], v[228:231], a[208:211], v[48:51]
    v_mfma_f32_16x16x32_bf16 v[52:55], v[228:231], a[212:215], v[52:55]
    v_mfma_f32_16x16x32_bf16 v[56:59], v[228:231], a[216:219], v[56:59]
    v_mfma_f32_16x16x32_bf16 v[60:63], v[228:231], a[220:223], v[60:63]
    v_mfma_f32_16x16x32_bf16 v[48:51], v[104:107], a[224:227], v[48:51]
    v_mfma_f32_16x16x32_bf16 v[52:55], v[104:107], a[228:231], v[52:55]
    v_mfma_f32_16x16x32_bf16 v[56:59], v[104:107], a[232:235], v[56:59]
    v_mfma_f32_16x16x32_bf16 v[60:63], v[104:107], a[236:239], v[60:63]
    v_mfma_f32_16x16x32_bf16 v[48:51], v[108:111], a[240:243], v[48:51]
    v_mfma_f32_16x16x32_bf16 v[52:55], v[108:111], a[244:247], v[52:55]
    v_mfma_f32_16x16x32_bf16 v[56:59], v[108:111], a[248:251], v[56:59]
    v_mfma_f32_16x16x32_bf16 v[60:63], v[108:111], a[252:255], v[60:63]
    v_mfma_f32_16x16x32_bf16 v[48:51], v[112:115], v[16:19], v[48:51]
    v_mfma_f32_16x16x32_bf16 v[52:55], v[112:115], v[20:23], v[52:55]
    v_mfma_f32_16x16x32_bf16 v[56:59], v[112:115], v[24:27], v[56:59]
    v_mfma_f32_16x16x32_bf16 v[60:63], v[112:115], v[28:31], v[60:63]
    v_mfma_f32_16x16x32_bf16 v[64:67], v[116:119], v[32:35], v[48:51]
    v_mfma_f32_16x16x32_bf16 v[68:71], v[116:119], v[36:39], v[52:55]
    v_mfma_f32_16x16x32_bf16 v[72:75], v[116:119], v[40:43], v[56:59]
    v_mfma_f32_16x16x32_bf16 v[76:79], v[116:119], v[44:47], v[60:63]
    s_nop 7
    s_add_u32 s35, s34, 16384
    v_cvt_pk_bf16_f32 v96, v64, v65
    v_cvt_pk_bf16_f32 v97, v66, v67
    v_cvt_pk_bf16_f32 v98, v68, v69
    v_cvt_pk_bf16_f32 v99, v70, v71
    buffer_store_dwordx4 v[96:99], v4, s[8:11], s35 offen offset:0 sc1
    ds_write_b128 v14, v[96:99] offset:16384
    v_cvt_pk_bf16_f32 v100, v72, v73
    v_cvt_pk_bf16_f32 v101, v74, v75
    v_cvt_pk_bf16_f32 v102, v76, v77
    v_cvt_pk_bf16_f32 v103, v78, v79
    buffer_store_dwordx4 v[100:103], v4, s[8:11], s35 offen offset:1024 sc1
    ds_write_b128 v14, v[100:103] offset:17408
    v_lshlrev_b32 v16, 16, v232
    v_and_b32 v17, 0xffff0000, v232
    v_lshlrev_b32 v18, 16, v233
    v_and_b32 v19, 0xffff0000, v233
    v_lshlrev_b32 v20, 16, v234
    v_and_b32 v21, 0xffff0000, v234
    v_lshlrev_b32 v22, 16, v235
    v_and_b32 v23, 0xffff0000, v235
    v_lshlrev_b32 v24, 16, v236
    v_and_b32 v25, 0xffff0000, v236
    v_lshlrev_b32 v26, 16, v237
    v_and_b32 v27, 0xffff0000, v237
    v_lshlrev_b32 v28, 16, v238
    v_and_b32 v29, 0xffff0000, v238
    v_lshlrev_b32 v30, 16, v239
    v_and_b32 v31, 0xffff0000, v239
    v_lshlrev_b32 v32, 16, v240
    v_and_b32 v33, 0xffff0000, v240
    v_lshlrev_b32 v34, 16, v241
    v_and_b32 v35, 0xffff0000, v241
    v_lshlrev_b32 v36, 16, v242
    v_and_b32 v37, 0xffff0000, v242
    v_lshlrev_b32 v38, 16, v243
    v_and_b32 v39, 0xffff0000, v243
    s_waitcnt vmcnt(0) lgkmcnt(0)
    s_mov_b64 exec, 1
    buffer_store_dword v250, v251, s[8:11], s44 offen offset:256 sc1
    s_mov_b64 exec, -1
    s_barrier
    s_cmp_eq_u32 s3, 3
    s_cbranch_scc1 L_ep_42
    ds_read_b128 v[48:51], v9 offset:0
    ds_read_b128 v[52:55], v9 offset:2048
    ds_read_b128 v[56:59], v9 offset:4096
    v_lshlrev_b32 v8, 16, v120
    v_and_b32 v5, 0xffff0000, v120
    v_add_f32 v16, v16, v8
    v_add_f32 v17, v17, v5
    v_lshlrev_b32 v8, 16, v121
    v_and_b32 v5, 0xffff0000, v121
    v_add_f32 v18, v18, v8
    v_add_f32 v19, v19, v5
    v_lshlrev_b32 v8, 16, v122
    v_and_b32 v5, 0xffff0000, v122
    v_add_f32 v20, v20, v8
    v_add_f32 v21, v21, v5
    v_lshlrev_b32 v8, 16, v123
    v_and_b32 v5, 0xffff0000, v123
    v_add_f32 v22, v22, v8
    v_add_f32 v23, v23, v5
    v_lshlrev_b32 v8, 16, v124
    v_and_b32 v5, 0xffff0000, v124
    v_add_f32 v16, v16, v8
    v_add_f32 v17, v17, v5
    v_lshlrev_b32 v8, 16, v125
    v_and_b32 v5, 0xffff0000, v125
    v_add_f32 v18, v18, v8
    v_add_f32 v19, v19, v5
    v_lshlrev_b32 v8, 16, v126
    v_and_b32 v5, 0xffff0000, v126
    v_add_f32 v20, v20, v8
    v_add_f32 v21, v21, v5
    v_lshlrev_b32 v8, 16, v127
    v_and_b32 v5, 0xffff0000, v127
    v_add_f32 v22, v22, v8
    v_add_f32 v23, v23, v5
    v_lshlrev_b32 v8, 16, v128
    v_and_b32 v5, 0xffff0000, v128
    v_add_f32 v16, v16, v8
    v_add_f32 v17, v17, v5
    v_lshlrev_b32 v8, 16, v129
    v_and_b32 v5, 0xffff0000, v129
    v_add_f32 v18, v18, v8
    v_add_f32 v19, v19, v5
    v_lshlrev_b32 v8, 16, v130
    v_and_b32 v5, 0xffff0000, v130
    v_add_f32 v20, v20, v8
    v_add_f32 v21, v21, v5
    v_lshlrev_b32 v8, 16, v131
    v_and_b32 v5, 0xffff0000, v131
    v_add_f32 v22, v22, v8
    v_add_f32 v23, v23, v5
    v_lshlrev_b32 v8, 16, v132
    v_and_b32 v5, 0xffff0000, v132
    v_add_f32 v16, v16, v8
    v_add_f32 v17, v17, v5
    v_lshlrev_b32 v8, 16, v133
    v_and_b32 v5, 0xffff0000, v133
    v_add_f32 v18, v18, v8
    v_add_f32 v19, v19, v5
    v_lshlrev_b32 v8, 16, v134
    v_and_b32 v5, 0xffff0000, v134
    v_add_f32 v20, v20, v8
    v_add_f32 v21, v21, v5
    v_lshlrev_b32 v8, 16, v135
    v_and_b32 v5, 0xffff0000, v135
    v_add_f32 v22, v22, v8
    v_add_f32 v23, v23, v5
    v_lshlrev_b32 v8, 16, v136
    v_and_b32 v5, 0xffff0000, v136
    v_add_f32 v16, v16, v8
    v_add_f32 v17, v17, v5
    v_lshlrev_b32 v8, 16, v137
    v_and_b32 v5, 0xffff0000, v137
    v_add_f32 v18, v18, v8
    v_add_f32 v19, v19, v5
    v_lshlrev_b32 v8, 16, v138
    v_and_b32 v5, 0xffff0000, v138
    v_add_f32 v20, v20, v8
    v_add_f32 v21, v21, v5
    v_lshlrev_b32 v8, 16, v139
    v_and_b32 v5, 0xffff0000, v139
    v_add_f32 v22, v22, v8
    v_add_f32 v23, v23, v5
    v_lshlrev_b32 v8, 16, v140
    v_and_b32 v5, 0xffff0000, v140
    v_add_f32 v16, v16, v8
    v_add_f32 v17, v17, v5
    v_lshlrev_b32 v8, 16, v141
    v_and_b32 v5, 0xffff0000, v141
    v_add_f32 v18, v18, v8
    v_add_f32 v19, v19, v5
    v_lshlrev_b32 v8, 16, v142
    v_and_b32 v5, 0xffff0000, v142
    v_add_f32 v20, v20, v8
    v_add_f32 v21, v21, v5
    v_lshlrev_b32 v8, 16, v143
    v_and_b32 v5, 0xffff0000, v143
    v_add_f32 v22, v22, v8
    v_add_f32 v23, v23, v5
    v_lshlrev_b32 v8, 16, v144
    v_and_b32 v5, 0xffff0000, v144
    v_add_f32 v16, v16, v8
    v_add_f32 v17, v17, v5
    v_lshlrev_b32 v8, 16, v145
    v_and_b32 v5, 0xffff0000, v145
    v_add_f32 v18, v18, v8
    v_add_f32 v19, v19, v5
    v_lshlrev_b32 v8, 16, v146
    v_and_b32 v5, 0xffff0000, v146
    v_add_f32 v20, v20, v8
    v_add_f32 v21, v21, v5
    v_lshlrev_b32 v8, 16, v147
    v_and_b32 v5, 0xffff0000, v147
    v_add_f32 v22, v22, v8
    v_add_f32 v23, v23, v5
    v_lshlrev_b32 v8, 16, v148
    v_and_b32 v5, 0xffff0000, v148
    v_add_f32 v24, v24, v8
    v_add_f32 v25, v25, v5
    v_lshlrev_b32 v8, 16, v149
    v_and_b32 v5, 0xffff0000, v149
    v_add_f32 v26, v26, v8
    v_add_f32 v27, v27, v5
    v_lshlrev_b32 v8, 16, v150
    v_and_b32 v5, 0xffff0000, v150
    v_add_f32 v28, v28, v8
    v_add_f32 v29, v29, v5
    v_lshlrev_b32 v8, 16, v151
    v_and_b32 v5, 0xffff0000, v151
    v_add_f32 v30, v30, v8
    v_add_f32 v31, v31, v5
    v_lshlrev_b32 v8, 16, v152
    v_and_b32 v5, 0xffff0000, v152
    v_add_f32 v24, v24, v8
    v_add_f32 v25, v25, v5
    v_lshlrev_b32 v8, 16, v153
    v_and_b32 v5, 0xffff0000, v153
    v_add_f32 v26, v26, v8
    v_add_f32 v27, v27, v5
    v_lshlrev_b32 v8, 16, v154
    v_and_b32 v5, 0xffff0000, v154
    v_add_f32 v28, v28, v8
    v_add_f32 v29, v29, v5
    v_lshlrev_b32 v8, 16, v155
    v_and_b32 v5, 0xffff0000, v155
    v_add_f32 v30, v30, v8
    v_add_f32 v31, v31, v5
    v_lshlrev_b32 v8, 16, v156
    v_and_b32 v5, 0xffff0000, v156
    v_add_f32 v24, v24, v8
    v_add_f32 v25, v25, v5
    v_lshlrev_b32 v8, 16, v157
    v_and_b32 v5, 0xffff0000, v157
    v_add_f32 v26, v26, v8
    v_add_f32 v27, v27, v5
    v_lshlrev_b32 v8, 16, v158
    v_and_b32 v5, 0xffff0000, v158
    v_add_f32 v28, v28, v8
    v_add_f32 v29, v29, v5
    v_lshlrev_b32 v8, 16, v159
    v_and_b32 v5, 0xffff0000, v159
    v_add_f32 v30, v30, v8
    v_add_f32 v31, v31, v5
    v_lshlrev_b32 v8, 16, v160
    v_and_b32 v5, 0xffff0000, v160
    v_add_f32 v24, v24, v8
    v_add_f32 v25, v25, v5
    v_lshlrev_b32 v8, 16, v161
    v_and_b32 v5, 0xffff0000, v161
    v_add_f32 v26, v26, v8
    v_add_f32 v27, v27, v5
    v_lshlrev_b32 v8, 16, v162
    v_and_b32 v5, 0xffff0000, v162
    v_add_f32 v28, v28, v8
    v_add_f32 v29, v29, v5
    v_lshlrev_b32 v8, 16, v163
    v_and_b32 v5, 0xffff0000, v163
    v_add_f32 v30, v30, v8
    v_add_f32 v31, v31, v5
    v_lshlrev_b32 v8, 16, v164
    v_and_b32 v5, 0xffff0000, v164
    v_add_f32 v24, v24, v8
    v_add_f32 v25, v25, v5
    v_lshlrev_b32 v8, 16, v165
    v_and_b32 v5, 0xffff0000, v165
    v_add_f32 v26, v26, v8
    v_add_f32 v27, v27, v5
    v_lshlrev_b32 v8, 16, v166
    v_and_b32 v5, 0xffff0000, v166
    v_add_f32 v28, v28, v8
    v_add_f32 v29, v29, v5
    v_lshlrev_b32 v8, 16, v167
    v_and_b32 v5, 0xffff0000, v167
    v_add_f32 v30, v30, v8
    v_add_f32 v31, v31, v5
    v_lshlrev_b32 v8, 16, v168
    v_and_b32 v5, 0xffff0000, v168
    v_add_f32 v24, v24, v8
    v_add_f32 v25, v25, v5
    v_lshlrev_b32 v8, 16, v169
    v_and_b32 v5, 0xffff0000, v169
    v_add_f32 v26, v26, v8
    v_add_f32 v27, v27, v5
    v_lshlrev_b32 v8, 16, v170
    v_and_b32 v5, 0xffff0000, v170
    v_add_f32 v28, v28, v8
    v_add_f32 v29, v29, v5
    v_lshlrev_b32 v8, 16, v171
    v_and_b32 v5, 0xffff0000, v171
    v_add_f32 v30, v30, v8
    v_add_f32 v31, v31, v5
    v_lshlrev_b32 v8, 16, v172
    v_and_b32 v5, 0xffff0000, v172
    v_add_f32 v24, v24, v8
    v_add_f32 v25, v25, v5
    v_lshlrev_b32 v8, 16, v173
    v_and_b32 v5, 0xffff0000, v173
    v_add_f32 v26, v26, v8
    v_add_f32 v27, v27, v5
    v_lshlrev_b32 v8, 16, v174
    v_and_b32 v5, 0xffff0000, v174
    v_add_f32 v28, v28, v8
    v_add_f32 v29, v29, v5
    v_lshlrev_b32 v8, 16, v175
    v_and_b32 v5, 0xffff0000, v175
    v_add_f32 v30, v30, v8
    v_add_f32 v31, v31, v5
    s_waitcnt lgkmcnt(0)
    v_lshlrev_b32 v8, 16, v48
    v_and_b32 v5, 0xffff0000, v48
    v_add_f32 v16, v16, v8
    v_add_f32 v17, v17, v5
    v_lshlrev_b32 v8, 16, v49
    v_and_b32 v5, 0xffff0000, v49
    v_add_f32 v18, v18, v8
    v_add_f32 v19, v19, v5
    v_lshlrev_b32 v8, 16, v50
    v_and_b32 v5, 0xffff0000, v50
    v_add_f32 v20, v20, v8
    v_add_f32 v21, v21, v5
    v_lshlrev_b32 v8, 16, v51
    v_and_b32 v5, 0xffff0000, v51
    v_add_f32 v22, v22, v8
    v_add_f32 v23, v23, v5
    v_lshlrev_b32 v8, 16, v52
    v_and_b32 v5, 0xffff0000, v52
    v_add_f32 v24, v24, v8
    v_add_f32 v25, v25, v5
    v_lshlrev_b32 v8, 16, v53
    v_and_b32 v5, 0xffff0000, v53
    v_add_f32 v26, v26, v8
    v_add_f32 v27, v27, v5
    v_lshlrev_b32 v8, 16, v54
    v_and_b32 v5, 0xffff0000, v54
    v_add_f32 v28, v28, v8
    v_add_f32 v29, v29, v5
    v_lshlrev_b32 v8, 16, v55
    v_and_b32 v5, 0xffff0000, v55
    v_add_f32 v30, v30, v8
    v_add_f32 v31, v31, v5
    v_lshlrev_b32 v8, 16, v56
    v_and_b32 v5, 0xffff0000, v56
    v_add_f32 v32, v32, v8
    v_add_f32 v33, v33, v5
    v_lshlrev_b32 v8, 16, v57
    v_and_b32 v5, 0xffff0000, v57
    v_add_f32 v34, v34, v8
    v_add_f32 v35, v35, v5
    v_lshlrev_b32 v8, 16, v58
    v_and_b32 v5, 0xffff0000, v58
    v_add_f32 v36, v36, v8
    v_add_f32 v37, v37, v5
    v_lshlrev_b32 v8, 16, v59
    v_and_b32 v5, 0xffff0000, v59
    v_add_f32 v38, v38, v8
    v_add_f32 v39, v39, v5
    s_mov_b32 s47, 0x40000
L_poll_43:
    buffer_load_dword v252, v247, s[8:11], s45 offen offset:256 sc1
    s_waitcnt vmcnt(0)
    v_cmp_ne_u32 vcc, 1, v252
    s_cbranch_vccz L_pd_44
    s_sub_u32 s47, s47, 1
    s_cbranch_scc0 L_poll_43
L_pd_44:
    buffer_load_dwordx4 v[64:67], v11, s[8:11], s52 offen sc1
    buffer_load_dwordx4 v[68:71], v11, s[8:11], s53 offen sc1
    buffer_load_dwordx4 v[72:75], v11, s[8:11], s54 offen sc1
    buffer_load_dwordx4 v[76:79], v11, s[8:11], s55 offen sc1
    buffer_load_dwordx4 v[80:83], v11, s[8:11], s56 offen sc1
    buffer_load_dwordx4 v[84:87], v11, s[8:11], s57 offen sc1
    buffer_load_dwordx4 v[88:91], v11, s[8:11], s58 offen sc1
    v_cvt_pk_bf16_f32 v48, v16, v17
    v_cvt_pk_bf16_f32 v49, v18, v19
    v_cvt_pk_bf16_f32 v50, v20, v21
    v_cvt_pk_bf16_f32 v51, v22, v23
    buffer_store_dwordx2 v[48:49], v6, s[12:15], s40 offen offset:0
    buffer_store_dwordx2 v[50:51], v7, s[12:15], s40 offen offset:0
    v_cvt_pk_bf16_f32 v52, v24, v25
    v_cvt_pk_bf16_f32 v53, v26, v27
    v_cvt_pk_bf16_f32 v54, v28, v29
    v_cvt_pk_bf16_f32 v55, v30, v31
    buffer_store_dwordx2 v[52:53], v6, s[12:15], s40 offen offset:32
    buffer_store_dwordx2 v[54:55], v7, s[12:15], s40 offen offset:32
    s_waitcnt vmcnt(10)
    v_lshlrev_b32 v8, 16, v64
    v_and_b32 v5, 0xffff0000, v64
    v_add_f32 v32, v32, v8
    v_add_f32 v33, v33, v5
    v_lshlrev_b32 v8, 16, v65
    v_and_b32 v5, 0xffff0000, v65
    v_add_f32 v34, v34, v8
    v_add_f32 v35, v35, v5
    v_lshlrev_b32 v8, 16, v66
    v_and_b32 v5, 0xffff0000, v66
    v_add_f32 v36, v36, v8
    v_add_f32 v37, v37, v5
    v_lshlrev_b32 v8, 16, v67
    v_and_b32 v5, 0xffff0000, v67
    v_add_f32 v38, v38, v8
    v_add_f32 v39, v39, v5
    s_waitcnt vmcnt(9)
    v_lshlrev_b32 v8, 16, v68
    v_and_b32 v5, 0xffff0000, v68
    v_add_f32 v32, v32, v8
    v_add_f32 v33, v33, v5
    v_lshlrev_b32 v8, 16, v69
    v_and_b32 v5, 0xffff0000, v69
    v_add_f32 v34, v34, v8
    v_add_f32 v35, v35, v5
    v_lshlrev_b32 v8, 16, v70
    v_and_b32 v5, 0xffff0000, v70
    v_add_f32 v36, v36, v8
    v_add_f32 v37, v37, v5
    v_lshlrev_b32 v8, 16, v71
    v_and_b32 v5, 0xffff0000, v71
    v_add_f32 v38, v38, v8
    v_add_f32 v39, v39, v5
    s_waitcnt vmcnt(8)
    v_lshlrev_b32 v8, 16, v72
    v_and_b32 v5, 0xffff0000, v72
    v_add_f32 v32, v32, v8
    v_add_f32 v33, v33, v5
    v_lshlrev_b32 v8, 16, v73
    v_and_b32 v5, 0xffff0000, v73
    v_add_f32 v34, v34, v8
    v_add_f32 v35, v35, v5
    v_lshlrev_b32 v8, 16, v74
    v_and_b32 v5, 0xffff0000, v74
    v_add_f32 v36, v36, v8
    v_add_f32 v37, v37, v5
    v_lshlrev_b32 v8, 16, v75
    v_and_b32 v5, 0xffff0000, v75
    v_add_f32 v38, v38, v8
    v_add_f32 v39, v39, v5
    s_waitcnt vmcnt(7)
    v_lshlrev_b32 v8, 16, v76
    v_and_b32 v5, 0xffff0000, v76
    v_add_f32 v32, v32, v8
    v_add_f32 v33, v33, v5
    v_lshlrev_b32 v8, 16, v77
    v_and_b32 v5, 0xffff0000, v77
    v_add_f32 v34, v34, v8
    v_add_f32 v35, v35, v5
    v_lshlrev_b32 v8, 16, v78
    v_and_b32 v5, 0xffff0000, v78
    v_add_f32 v36, v36, v8
    v_add_f32 v37, v37, v5
    v_lshlrev_b32 v8, 16, v79
    v_and_b32 v5, 0xffff0000, v79
    v_add_f32 v38, v38, v8
    v_add_f32 v39, v39, v5
    s_waitcnt vmcnt(6)
    v_lshlrev_b32 v8, 16, v80
    v_and_b32 v5, 0xffff0000, v80
    v_add_f32 v32, v32, v8
    v_add_f32 v33, v33, v5
    v_lshlrev_b32 v8, 16, v81
    v_and_b32 v5, 0xffff0000, v81
    v_add_f32 v34, v34, v8
    v_add_f32 v35, v35, v5
    v_lshlrev_b32 v8, 16, v82
    v_and_b32 v5, 0xffff0000, v82
    v_add_f32 v36, v36, v8
    v_add_f32 v37, v37, v5
    v_lshlrev_b32 v8, 16, v83
    v_and_b32 v5, 0xffff0000, v83
    v_add_f32 v38, v38, v8
    v_add_f32 v39, v39, v5
    s_waitcnt vmcnt(5)
    v_lshlrev_b32 v8, 16, v84
    v_and_b32 v5, 0xffff0000, v84
    v_add_f32 v32, v32, v8
    v_add_f32 v33, v33, v5
    v_lshlrev_b32 v8, 16, v85
    v_and_b32 v5, 0xffff0000, v85
    v_add_f32 v34, v34, v8
    v_add_f32 v35, v35, v5
    v_lshlrev_b32 v8, 16, v86
    v_and_b32 v5, 0xffff0000, v86
    v_add_f32 v36, v36, v8
    v_add_f32 v37, v37, v5
    v_lshlrev_b32 v8, 16, v87
    v_and_b32 v5, 0xffff0000, v87
    v_add_f32 v38, v38, v8
    v_add_f32 v39, v39, v5
    s_waitcnt vmcnt(4)
    v_lshlrev_b32 v8, 16, v88
    v_and_b32 v5, 0xffff0000, v88
    v_add_f32 v32, v32, v8
    v_add_f32 v33, v33, v5
    v_lshlrev_b32 v8, 16, v89
    v_and_b32 v5, 0xffff0000, v89
    v_add_f32 v34, v34, v8
    v_add_f32 v35, v35, v5
    v_lshlrev_b32 v8, 16, v90
    v_and_b32 v5, 0xffff0000, v90
    v_add_f32 v36, v36, v8
    v_add_f32 v37, v37, v5
    v_lshlrev_b32 v8, 16, v91
    v_and_b32 v5, 0xffff0000, v91
    v_add_f32 v38, v38, v8
    v_add_f32 v39, v39, v5
    v_cvt_pk_bf16_f32 v56, v32, v33
    v_cvt_pk_bf16_f32 v57, v34, v35
    v_cvt_pk_bf16_f32 v58, v36, v37
    v_cvt_pk_bf16_f32 v59, v38, v39
    buffer_store_dwordx2 v[56:57], v6, s[12:15], s40 offen offset:64
    buffer_store_dwordx2 v[58:59], v7, s[12:15], s40 offen offset:64
L_ep_42:
L_end_15:
    s_endpgm
code_end:
s_nop 0
.section .rodata,"a"
.p2align 6
.amdhsa_kernel k1_kernel
  .amdhsa_next_free_vgpr 200
  .amdhsa_next_free_sgpr 96
  .amdhsa_accum_offset 200
  .amdhsa_group_segment_fixed_size 0
  .amdhsa_kernarg_size 88
  .amdhsa_user_sgpr_count 2
  .amdhsa_user_sgpr_kernarg_segment_ptr 1
  .amdhsa_system_sgpr_workgroup_id_x 1
  .amdhsa_float_denorm_mode_32 3
.end_amdhsa_kernel
.p2align 6
.amdhsa_kernel k3_kernel
  .amdhsa_next_free_vgpr 512
  .amdhsa_next_free_sgpr 96
  .amdhsa_accum_offset 256
  .amdhsa_group_segment_fixed_size 0
  .amdhsa_kernarg_size 88
  .amdhsa_user_sgpr_count 2
  .amdhsa_user_sgpr_kernarg_segment_ptr 1
  .amdhsa_system_sgpr_workgroup_id_x 1
  .amdhsa_float_denorm_mode_32 3
.end_amdhsa_kernel
```
